```python
import torch

def _softmax(x, axis=-1):
    return torch.softmax(x, dim=axis)
def _gelu(x):
    return torch.nn.functional.gelu(x, approximate="tanh")
def _silu(x):
    return torch.nn.functional.silu(x)
def _sigmoid(x):
    return torch.sigmoid(x)
def _layernorm(x, axis=-1, eps=1e-5):
    m = x.mean(dim=axis, keepdim=True)
    v = x.var(dim=axis, keepdim=True, unbiased=False)
    return (x - m) / torch.sqrt(v + eps)
def _scatter_add(tgt, idx, src, axis=0):
    return tgt.clone().index_add_(axis, idx, src)
def _segment_sum(src, seg, n):
    out = torch.zeros((n,) + src.shape[1:], dtype=src.dtype)
    return out.index_add_(0, seg, src)
def _pad(x, pw):
    flat = tuple(v for pair in reversed(pw) for v in pair)
    return torch.nn.functional.pad(x, flat)

kernel_name = 'sequential_preLN__ssm_conv_s4__glu_gated_swiglu__prompt'

def setup_inputs():

    _w = (lambda a: (lambda t: t.to(torch.bfloat16) if t.is_floating_point() else t)(torch.as_tensor(a)))
    def _A_setup():
        B, L, D, N = 1, 2048, 640, 192
        A_re = -(lambda _x: torch.exp(torch.as_tensor(_x)))((lambda *s: torch.randn(*s, dtype=torch.bfloat16) * 3.2)(D, N))
        A_im = torch.pi * (lambda *s: torch.randn(*s, dtype=torch.bfloat16) * 0.05)(D, N)
        B_re = (lambda *s: torch.randn(*s, dtype=torch.bfloat16) * 0.05)(D, N)
        B_im = (lambda *s: torch.randn(*s, dtype=torch.bfloat16) * 0.05)(D, N)
        C_re = (lambda *s: torch.randn(*s, dtype=torch.bfloat16) * 0.05)(D, N)
        C_im = (lambda *s: torch.randn(*s, dtype=torch.bfloat16) * 0.05)(D, N)
        log_dt = (lambda *s: torch.randn(*s, dtype=torch.bfloat16) * 0.05)(D) * 0.5 - 4.0
        Dskip = (lambda *s: torch.randn(*s, dtype=torch.bfloat16) * 0.05)(D)
        return {
            "u": _w((lambda *s: torch.randn(*s, dtype=torch.bfloat16) * 0.05)(B, L, D)),
            "A_re": _w(A_re),
            "A_im": _w(A_im),
            "B_re": _w(B_re),
            "B_im": _w(B_im),
            "C_re": _w(C_re),
            "C_im": _w(C_im),
            "log_dt": _w(log_dt),
            "Dskip": _w(Dskip),
        }
    _A_in = _A_setup()

    def _B_setup():
        B, S, D, F = 1, 2048, 640, 1536
        return {
            "x": _w((lambda *s: torch.randn(*s, dtype=torch.bfloat16) * 0.05)(B, S, D)),
            "w1": _w((lambda *s: torch.randn(*s, dtype=torch.bfloat16) * 0.4)(D, F) * (2.0 / D) ** 0.5),
            "w3": _w((lambda *s: torch.randn(*s, dtype=torch.bfloat16) * 0.4)(D, F) * (2.0 / D) ** 0.5),
            "w2": _w((lambda *s: torch.randn(*s, dtype=torch.bfloat16) * 0.4)(F, D) * (2.0 / F) ** 0.5),
        }
    _B_in = _B_setup()

    return {
        "A_u": _A_in["u"],
        "A_A_re": _A_in["A_re"],
        "A_A_im": _A_in["A_im"],
        "A_B_re": _A_in["B_re"],
        "A_B_im": _A_in["B_im"],
        "A_C_re": _A_in["C_re"],
        "A_C_im": _A_in["C_im"],
        "A_log_dt": _A_in["log_dt"],
        "A_Dskip": _A_in["Dskip"],
        "B_x": _B_in["x"],
        "B_w1": _B_in["w1"],
        "B_w3": _B_in["w3"],
        "B_w2": _B_in["w2"],
    }

def reference(A_u, A_A_re, A_A_im, A_B_re, A_B_im, A_C_re, A_C_im, A_log_dt, A_Dskip, B_x, B_w1, B_w3, B_w2):
    def _A_ref(u, A_re, A_im, B_re, B_im, C_re, C_im, log_dt, Dskip):
        Bsz, L, D = u.shape
        dt = torch.exp(log_dt)[:, None]
        A = A_re + 1j * A_im
        Bc = B_re + 1j * B_im
        Cc = C_re + 1j * C_im
        logdA = dt * A
        dB = dt * Bc
        l = (lambda x, dt: x.to(dt))(torch.arange(L), A_re.dtype)
        P = torch.exp(logdA[:, :, None] * l[None, None, :])
        K = torch.einsum("dn,dnl,dn->dl", Cc, P, dB).real
        L2 = 2 * L
        Kp = _pad(K, ((0, 0), (0, L)))
        up = (lambda x, *d: x.permute(*d))(u, 0, 2, 1)
        up = _pad(up, ((0, 0), (0, 0), (0, L)))
        Kf = (lambda x, axes=(-2,-1): torch.fft.rfft2(x.float(), dim=axes))(Kp[:, None, :], axes=(-2, -1))
        Uf = (lambda x, axes=(-2,-1): torch.fft.rfft2(x.float(), dim=axes))(up[:, :, None, :], axes=(-2, -1))
        Yf = Uf * Kf[None, :, :, :]
        y = (lambda x, s, axes=(-2,-1): torch.fft.irfft2(x, s=s, dim=axes).to(torch.bfloat16))(Yf, (1, L2), axes=(-2, -1))[:, :, 0, :L]
        y = (lambda x, *d: x.permute(*d))(y, 0, 2, 1) + u * Dskip[None, None, :]
        return y

    def _B_ref(x, w1, w3, w2):
        gate = torch.einsum("bsd,df->bsf", x, w1)
        up = torch.einsum("bsd,df->bsf", x, w3)
        h = _silu(gate) * up
        out = torch.einsum("bsf,fd->bsd", h, w2)
        return out

    x = A_u
    h = x + _A_ref(_layernorm(x, axis=-1), A_A_re, A_A_im, A_B_re, A_B_im, A_C_re, A_C_im, A_log_dt, A_Dskip)
    h2 = h + _B_ref(_layernorm(h, axis=-1), B_w1, B_w3, B_w2)
    return h2
```

```asm
; @launch kernel=kA_kernel grid=(256,1,1) block=(768,1,1) lds=151360
; @launch kernel=kB_kernel grid=(256,1,1) block=(256,1,1) lds=163840
.amdgcn_target "amdgcn-amd-amdhsa--gfx950"
.text
.globl kA_kernel
.p2align 8
.type kA_kernel,@function
kA_kernel:
    s_cmp_ge_u32 s2, 0x100
    s_cbranch_scc1 LA_exit
    s_load_dwordx16 s[16:31], s[0:1], 0
    s_load_dwordx16 s[32:47], s[0:1], 64
    v_lshrrev_b32 v2, 6, v0
    v_and_b32 v1, 63, v0
    s_and_b32 s49, s2, 7
    s_lshr_b32 s50, s2, 3
    v_readfirstlane_b32 s48, v2
    s_mov_b32 s53, 0xffff0000
    s_mov_b32 s54, 0x3f803f80
    s_cmp_ge_u32 s50, 20
    s_cbranch_scc1 LA_side
    s_and_b32 s55, s48, 3
    s_mul_i32 s51, s49, 20
    s_add_u32 s51, s51, s50
    s_lshl_b32 s52, s51, 2
    s_add_u32 s52, s52, s55
    s_lshl_b32 s57, s51, 3
    v_mov_b32 v8, 148224
    v_mov_b32 v4, 0
    v_mov_b32 v5, 0
    v_mov_b32 v6, 0
    v_mov_b32 v7, 0
    ds_write_b128 v8, v[4:7]
    ds_write_b128 v8, v[4:7] offset:16
    ds_write_b128 v8, v[4:7] offset:32
    s_cmp_ge_u32 s48, 8
    s_cbranch_scc1 LA_x0
    s_mul_i32 s56, s52, 384
    v_lshl_add_u32 v3, v1, 1, s56
    v_mov_b32 v10, 0
    v_mov_b32 v11, 0
    v_mov_b32 v12, 0
    v_mov_b32 v13, 0
    v_mov_b32 v14, 0
    v_mov_b32 v15, 0
    v_mov_b32 v16, 0
    v_mov_b32 v17, 0
    v_mov_b32 v18, 0
    v_mov_b32 v19, 0
    v_mov_b32 v20, 0
    v_mov_b32 v21, 0
    v_mov_b32 v22, 0
    v_mov_b32 v23, 0
    v_mov_b32 v24, 0
    v_mov_b32 v25, 0
    v_mov_b32 v26, 0
    v_mov_b32 v27, 0
    s_waitcnt lgkmcnt(0)
    s_barrier
    global_load_short_d16_hi v10, v3, s[18:19] offset:0
    global_load_short_d16_hi v11, v3, s[20:21] offset:0
    global_load_short_d16_hi v16, v3, s[18:19] offset:128
    global_load_short_d16_hi v17, v3, s[20:21] offset:128
    global_load_short_d16_hi v22, v3, s[18:19] offset:256
    global_load_short_d16_hi v23, v3, s[20:21] offset:256
    s_add_u32 s58, s30, s57
    s_addc_u32 s59, s31, 0
    s_load_dwordx2 s[62:63], s[58:59], 0
    s_cmp_ge_u32 s48, 4
    s_cbranch_scc1 LA_pq
    s_add_u32 s60, s32, s57
    s_addc_u32 s61, s33, 0
    s_load_dwordx2 s[64:65], s[60:61], 0
    global_load_short_d16_hi v12, v3, s[22:23] offset:0
    global_load_short_d16_hi v13, v3, s[24:25] offset:0
    global_load_short_d16_hi v14, v3, s[26:27] offset:0
    global_load_short_d16_hi v15, v3, s[28:29] offset:0
    global_load_short_d16_hi v18, v3, s[22:23] offset:128
    global_load_short_d16_hi v19, v3, s[24:25] offset:128
    global_load_short_d16_hi v20, v3, s[26:27] offset:128
    global_load_short_d16_hi v21, v3, s[28:29] offset:128
    global_load_short_d16_hi v24, v3, s[22:23] offset:256
    global_load_short_d16_hi v25, v3, s[24:25] offset:256
    global_load_short_d16_hi v26, v3, s[26:27] offset:256
    global_load_short_d16_hi v27, v3, s[28:29] offset:256
    s_branch LA_pq
LA_x0:
    s_mul_i32 s56, s55, 655360
    s_add_u32 s56, s56, s57
    s_movk_i32 s58, 10240
    v_mul_lo_u32 v4, v1, s58
    v_add_u32 v4, s56, v4
    v_add_u32 v5, 5120, v4
    s_getpc_b64 s[70:71]
LA_pc:
    s_sub_u32 s70, s70, LA_pc-kA_kernel
    s_subb_u32 s71, s71, 0
    s_lshl_b32 s56, s55, 14
    v_lshl_add_u32 v9, v1, 7, s56
    v_add_u32 v10, 8192, v9
    v_min_u32 v9, L_code_end-kA_kernel-4, v9
    v_min_u32 v10, L_code_end-kA_kernel-4, v10
    s_waitcnt lgkmcnt(0)
    s_barrier
    s_cmp_ge_u32 s50, 2
    s_cbranch_scc1 LA_nocw
    global_load_dword v12, v9, s[70:71]
    global_load_dword v13, v10, s[70:71]
LA_nocw:
    global_load_dwordx2 v[28:29], v4, s[16:17] offset:0
    global_load_dwordx2 v[30:31], v4, s[16:17] offset:1280
    global_load_dwordx2 v[32:33], v4, s[16:17] offset:2560
    global_load_dwordx2 v[34:35], v4, s[16:17] offset:3840
    global_load_dwordx2 v[36:37], v5, s[16:17] offset:0
    global_load_dwordx2 v[38:39], v5, s[16:17] offset:1280
    global_load_dwordx2 v[40:41], v5, s[16:17] offset:2560
    global_load_dwordx2 v[42:43], v5, s[16:17] offset:3840
    s_branch LA_x
LA_side:
    s_cmp_ge_u32 s50, 28
    s_cbranch_scc1 LA_w13
    s_sub_u32 s55, s50, 20
    s_lshl_b32 s55, s55, 3
    s_add_u32 s55, s55, s49
    s_cmp_ge_u32 s48, 8
    s_cbranch_scc1 LA_init
    s_lshl_b32 s56, s55, 5
    s_lshl_b32 s57, s48, 2
    s_add_u32 s56, s56, s57
    s_mul_i32 s56, s56, 1280
    v_lshrrev_b32 v3, 4, v1
    v_mul_u32_u24 v4, 1280, v3
    v_and_b32 v5, 15, v1
    v_lshl_add_u32 v4, v5, 4, v4
    v_add_u32 v4, s56, v4
    v_mov_b32 v50, 0
    v_mov_b32 v51, 0
    v_mov_b32 v9, 0
    s_waitcnt lgkmcnt(0)
    global_load_dwordx4 v[10:13], v4, s[16:17] offset:0
    global_load_dwordx4 v[14:17], v4, s[16:17] offset:256
    global_load_dwordx4 v[18:21], v4, s[16:17] offset:512
    global_load_dwordx4 v[22:25], v4, s[16:17] offset:768
    global_load_dwordx4 v[26:29], v4, s[16:17] offset:1024
    s_lshl_b32 s57, s57, 2
    v_lshl_add_u32 v7, v3, 2, s57
    s_branch LA_stb
LA_stb:
    s_waitcnt vmcnt(4)
    v_dot2c_f32_bf16 v50, s54, v10
    v_dot2c_f32_bf16 v51, v10, v10
    v_dot2c_f32_bf16 v50, s54, v11
    v_dot2c_f32_bf16 v51, v11, v11
    v_dot2c_f32_bf16 v50, s54, v12
    v_dot2c_f32_bf16 v51, v12, v12
    v_dot2c_f32_bf16 v50, s54, v13
    v_dot2c_f32_bf16 v51, v13, v13
    s_waitcnt vmcnt(3)
    v_dot2c_f32_bf16 v50, s54, v14
    v_dot2c_f32_bf16 v51, v14, v14
    v_dot2c_f32_bf16 v50, s54, v15
    v_dot2c_f32_bf16 v51, v15, v15
    v_dot2c_f32_bf16 v50, s54, v16
    v_dot2c_f32_bf16 v51, v16, v16
    v_dot2c_f32_bf16 v50, s54, v17
    v_dot2c_f32_bf16 v51, v17, v17
    s_waitcnt vmcnt(2)
    v_dot2c_f32_bf16 v50, s54, v18
    v_dot2c_f32_bf16 v51, v18, v18
    v_dot2c_f32_bf16 v50, s54, v19
    v_dot2c_f32_bf16 v51, v19, v19
    v_dot2c_f32_bf16 v50, s54, v20
    v_dot2c_f32_bf16 v51, v20, v20
    v_dot2c_f32_bf16 v50, s54, v21
    v_dot2c_f32_bf16 v51, v21, v21
    s_waitcnt vmcnt(1)
    v_dot2c_f32_bf16 v50, s54, v22
    v_dot2c_f32_bf16 v51, v22, v22
    v_dot2c_f32_bf16 v50, s54, v23
    v_dot2c_f32_bf16 v51, v23, v23
    v_dot2c_f32_bf16 v50, s54, v24
    v_dot2c_f32_bf16 v51, v24, v24
    v_dot2c_f32_bf16 v50, s54, v25
    v_dot2c_f32_bf16 v51, v25, v25
    s_waitcnt vmcnt(0)
    v_dot2c_f32_bf16 v50, s54, v26
    v_dot2c_f32_bf16 v51, v26, v26
    v_dot2c_f32_bf16 v50, s54, v27
    v_dot2c_f32_bf16 v51, v27, v27
    v_dot2c_f32_bf16 v50, s54, v28
    v_dot2c_f32_bf16 v51, v28, v28
    v_dot2c_f32_bf16 v50, s54, v29
    v_dot2c_f32_bf16 v51, v29, v29
    s_nop 1
    v_add_f32_dpp v50, v50, v50 row_ror:8 row_mask:0xf bank_mask:0xf
    v_add_f32_dpp v51, v51, v51 row_ror:8 row_mask:0xf bank_mask:0xf
    s_nop 0
    v_add_f32_dpp v50, v50, v50 row_ror:4 row_mask:0xf bank_mask:0xf
    v_add_f32_dpp v51, v51, v51 row_ror:4 row_mask:0xf bank_mask:0xf
    s_nop 0
    v_add_f32_dpp v50, v50, v50 row_ror:2 row_mask:0xf bank_mask:0xf
    v_add_f32_dpp v51, v51, v51 row_ror:2 row_mask:0xf bank_mask:0xf
    s_nop 0
    v_add_f32_dpp v50, v50, v50 row_ror:1 row_mask:0xf bank_mask:0xf
    v_add_f32_dpp v51, v51, v51 row_ror:1 row_mask:0xf bank_mask:0xf
    v_mul_f32 v50, 0x3acccccd, v50
    v_mul_f32 v51, 0x3acccccd, v51
    v_fma_f32 v51, -v50, v50, v51
    v_max_f32 v51, 0, v51
    v_cvt_pk_bf16_f32 v51, v51, v51
    v_and_b32 v51, s53, v51
    v_add_f32 v51, 0x3727c5ac, v51
    v_cvt_pk_bf16_f32 v51, v51, v51
    v_and_b32 v51, s53, v51
    v_sqrt_f32 v51, v51
    s_nop 0
    v_cvt_pk_bf16_f32 v54, v50, v51
    ds_write_b32 v7, v54
    s_waitcnt lgkmcnt(0)
    s_barrier
    s_cmp_ge_u32 s55, 48
    s_cbranch_scc1 LA_side_end
    s_mov_b32 s60, s40
    s_mov_b32 s61, s41
    s_mov_b32 s62, 1966080
    s_mov_b32 s63, 0x20000
    s_mul_hi_u32 s58, s55, 0x55555556
    s_mul_i32 s59, s58, 3
    s_sub_u32 s59, s55, s59
    s_mul_i32 s58, s58, 96
    s_lshl_b32 s59, s59, 4
    s_add_u32 s58, s58, s59
    s_lshr_b32 s59, s48, 2
    s_mul_i32 s59, s59, 48
    s_add_u32 s58, s58, s59
    s_and_b32 s59, s48, 3
    s_lshl_b32 s59, s59, 2
    s_add_u32 s58, s58, s59
    s_mul_i32 s57, s58, 1280
    s_mul_i32 s56, s48, 5120
    s_add_u32 m0, s56, 1024
    v_lshlrev_b32 v6, 4, v1
    buffer_load_dwordx4 v6, s[60:63], s57 offen offset:0 lds
    buffer_load_dwordx4 v6, s[60:63], s57 offen offset:1024 lds
    buffer_load_dwordx4 v6, s[60:63], s57 offen offset:2048 lds
    buffer_load_dwordx4 v6, s[60:63], s57 offen offset:3072 lds
    s_add_u32 m0, s56, 5120
    s_add_u32 s57, s57, 4096
    buffer_load_dwordx4 v6, s[60:63], s57 offen lds
    v_lshrrev_b32 v15, 1, v3
    v_lshlrev_b32 v15, 4, v15
    v_and_b32 v16, 1, v3
    v_lshl_add_u32 v15, v16, 3, v15
    v_bfe_u32 v16, v1, 2, 2
    v_add_u32 v15, v15, v16
    v_mul_u32_u24 v15, 1280, v15
    v_and_b32 v16, 3, v1
    v_lshl_add_u32 v15, v16, 3, v15
    s_mul_i32 s56, s48, 160
    s_add_u32 s56, s56, 1024
    v_add_u32 v15, s56, v15
    s_mul_i32 s56, s48, 48
    s_add_u32 s56, s56, s55
    s_mul_i32 s56, s56, 5120
    s_add_u32 s56, s56, 14680064
    v_add_u32 v16, s56, v6
    v_add_u32 v17, 4096, v16
    s_waitcnt vmcnt(0)
    s_barrier
    ds_read_b64_tr_b16 v[20:21], v15 offset:0
    ds_read_b64_tr_b16 v[22:23], v15 offset:5120
    ds_read_b64_tr_b16 v[24:25], v15 offset:32
    ds_read_b64_tr_b16 v[26:27], v15 offset:5152
    ds_read_b64_tr_b16 v[28:29], v15 offset:64
    ds_read_b64_tr_b16 v[30:31], v15 offset:5184
    ds_read_b64_tr_b16 v[32:33], v15 offset:96
    ds_read_b64_tr_b16 v[34:35], v15 offset:5216
    ds_read_b64_tr_b16 v[36:37], v15 offset:128
    ds_read_b64_tr_b16 v[38:39], v15 offset:5248
    s_waitcnt lgkmcnt(8)
    global_store_dwordx4 v16, v[20:23], s[46:47] offset:0 sc1
    s_waitcnt lgkmcnt(6)
    global_store_dwordx4 v16, v[24:27], s[46:47] offset:1024 sc1
    s_waitcnt lgkmcnt(4)
    global_store_dwordx4 v16, v[28:31], s[46:47] offset:2048 sc1
    s_waitcnt lgkmcnt(2)
    global_store_dwordx4 v16, v[32:35], s[46:47] offset:3072 sc1
    s_waitcnt lgkmcnt(0)
    global_store_dwordx4 v17, v[36:39], s[46:47] offset:0 sc1
LA_side_end:
    s_endpgm
LA_init:
    s_cmp_lg_u32 s48, 8
    s_cbranch_scc1 LA_nonon
    s_memrealtime s[66:67]
    v_mov_b32 v9, 0
    v_mov_b32 v53, 0
    s_waitcnt lgkmcnt(0)
    s_or_b32 s66, s66, 1
    v_mov_b32 v52, s66
    s_mov_b64 exec, 1
    global_atomic_cmpswap v56, v9, v[52:53], s[44:45] sc0 sc1
    s_mov_b64 exec, -1
LA_nonon:
    s_lshl_b32 s57, s55, 2
    s_add_u32 s57, s57, s48
    s_sub_u32 s57, s57, 8
    s_lshl_b32 s58, s57, 9
    s_add_u32 s58, s58, 2752512
    s_mul_i32 s59, s57, 640
    s_add_u32 s59, s59, 2949120
    v_lshl_add_u32 v11, v1, 3, s58
    v_min_u32 v12, 39, v1
    v_lshl_add_u32 v12, v12, 4, s59
    v_mov_b32 v14, 0
    v_mov_b32 v15, 0
    v_mov_b32 v16, -1
    v_mov_b32 v17, -1
    v_mov_b32 v18, -1
    v_mov_b32 v19, -1
    s_waitcnt lgkmcnt(0)
    global_store_dwordx4 v12, v[16:19], s[46:47] sc1
    s_cmp_lg_u32 s48, 8
    s_cbranch_scc1 LA_bg
    v_and_b32 v5, 15, v1
    v_lshlrev_b32 v7, 3, v5
    s_lshl_b32 s57, s55, 8
    s_add_u32 s57, s57, 2686976
    v_lshl_add_u32 v8, v5, 4, s57
    v_mov_b32 v14, 2879488
    s_waitcnt vmcnt(1)
    v_readfirstlane_b32 s58, v56
    s_nop 0
    s_cmp_eq_u32 s58, 0
    s_cselect_b32 s58, s66, s58
    v_mov_b32 v11, s58
    v_mov_b32 v13, s58
    s_barrier
    ds_read2_b32 v[20:21], v7 offset0:0 offset1:1
    s_mov_b64 exec, 0xffff
    s_waitcnt lgkmcnt(0)
    v_mov_b32 v10, v20
    v_mov_b32 v12, v21
    global_store_dwordx4 v8, v[10:13], s[46:47] sc1
    s_cmp_lg_u32 s55, 0
    s_cbranch_scc1 LA_nn
    global_store_dword v14, v11, s[46:47] sc1
LA_nn:
    s_mov_b64 exec, -1
LA_bg:
    s_sub_u32 s57, s50, 20
    s_lshl_b32 s57, s57, 3
    s_add_u32 s57, s57, s49
    s_lshl_b32 s57, s57, 2
    s_add_u32 s57, s57, s48
    s_sub_u32 s57, s57, 8
    s_waitcnt lgkmcnt(0)
    s_endpgm
LA_pq:
    s_mul_i32 s68, s55, 14416
    s_add_u32 s69, s68, 57664
    s_mul_i32 s70, s55, 8320
    s_add_u32 s70, s70, 57664
    s_lshl_b32 s56, s55, 2
    v_add_u32 v4, s56, v8
    v_add_u32 v5, 16, v4
    s_cmp_ge_u32 s48, 4
    s_cbranch_scc1 LA_q
    v_and_b32 v2, 31, v1
    v_mul_u32_u24 v6, 272, v2
    v_lshrrev_b32 v9, 5, v1
    v_lshl_add_u32 v6, v9, 4, v6
    v_add_u32 v7, s69, v6
    v_add_u32 v6, s68, v6
    v_lshlrev_b32 v28, 5, v2
    v_lshl_add_u32 v28, v9, 4, v28
    v_add_u32 v28, s68, v28
    v_cmp_gt_u32 s[74:75], 32, v1
    v_lshlrev_b32 v37, 4, v2
    v_add_u32 v37, 1024, v37
    v_lshlrev_b32 v38, 3, v2
    v_add_u32 v29, 1536, v38
    v_add_u32 v30, 8, v37
    v_add_u32 v31, 1792, v38
    v_cndmask_b32 v29, v29, v37, s[74:75]
    v_cndmask_b32 v30, v31, v30, s[74:75]
    v_add_u32 v29, s68, v29
    v_add_u32 v30, s68, v30
    v_lshlrev_b32 v31, 2, v2
    v_lshl_add_u32 v31, v9, 9, v31
    v_add_u32 v31, s68, v31
    v_lshlrev_b32 v32, 5, v1
    v_cndmask_b32 v32, v37, v32, s[74:75]
    v_add_u32 v32, s68, v32
    v_lshl_add_u32 v33, v1, 3, s68
    v_lshl_add_u32 v34, v1, 2, s68
    v_add_u32 v34, 2048, v34
    v_lshlrev_b32 v35, 4, v1
    v_sub_u32 v35, s70, v35
    v_add_u32 v35, 1008, v35
    v_and_b32 v37, 1, v1
    v_cmp_eq_u32 s[72:73], 1, v37
    v_lshlrev_b32 v36, 4, v37
    v_bfe_u32 v38, v1, 1, 1
    v_mul_u32_u24 v38, 4160, v38
    v_add3_u32 v36, v36, v38, s70
    v_and_b32 v2, 15, v1
    v_lshrrev_b32 v9, 4, v1
    v_add_u32 v37, 1, v2
    v_lshrrev_b32 v37, 1, v37
    v_lshlrev_b32 v38, 2, v9
    v_sub_u32 v37, v38, v37
    v_lshlrev_b32 v37, 2, v37
    v_and_b32 v38, 1, v2
    v_xor_b32 v38, 1, v38
    v_mul_u32_u24 v38, 4160, v38
    v_add3_u32 v37, v37, v38, s70
    v_add_u32 v160, 3104, v37
    v_add_u32 v161, 2080, v37
    v_add_u32 v162, 1056, v37
    v_add_u32 v163, 32, v37
    v_add_u32 v37, 1, v2
    v_lshrrev_b32 v37, 1, v37
    v_lshlrev_b32 v38, 1, v9
    v_sub_u32 v37, v38, v37
    v_lshlrev_b32 v37, 2, v37
    v_and_b32 v38, 1, v2
    v_xor_b32 v38, 1, v38
    v_mul_u32_u24 v38, 192, v38
    v_add3_u32 v167, v37, v38, s68
    v_add_u32 v167, 3360, v167
    v_lshlrev_b32 v39, 4, v1
    v_add_u32 v79, 148288, v39
    s_mul_i32 s56, s55, 4608
    s_add_u32 s56, s56, 90944
    v_lshlrev_b32 v37, 5, v2
    v_lshl_add_u32 v37, v9, 4, v37
    v_add_u32 v164, s56, v37
    s_mul_i32 s56, s55, 8224
    s_add_u32 s56, s56, 115328
    v_lshlrev_b32 v37, 5, v2
    v_lshrrev_b32 v38, 1, v9
    v_lshl_add_u32 v37, v38, 4, v37
    v_and_b32 v38, 1, v9
    v_mul_u32_u24 v38, 4112, v38
    v_add3_u32 v165, v37, v38, s56
    v_lshrrev_b32 v37, 3, v2
    s_mov_b32 s56, 163840
    v_mul_lo_u32 v37, v37, s56
    v_and_b32 v38, 7, v2
    v_lshl_add_u32 v37, v38, 5, v37
    v_lshrrev_b32 v38, 1, v9
    v_lshl_add_u32 v37, v38, 4, v37
    v_and_b32 v38, 1, v9
    s_mov_b32 s56, 327680
    v_mul_lo_u32 v38, v38, s56
    v_add_u32 v37, v37, v38
    s_lshl_b32 s56, s52, 8
    v_add_u32 v166, s56, v37
    v_add_u32 v8, 16, v8
    s_branch LA_p
LA_q:
    s_cmp_lg_u32 s55, 0
    s_cbranch_scc1 LA_noband
    v_and_b32 v80, 15, v1
    v_lshrrev_b32 v81, 4, v1
    v_lshlrev_b32 v81, 3, v81
    s_movk_i32 s56, 0x3f80
    s_mov_b32 s58, 0x3f800000
    v_lshlrev_b32 v90, 4, v1
    v_add_u32 v90, 148288, v90
    v_mov_b32 v82, 511
    v_mov_b32 v83, 0
    v_add_u32 v84, 4, v80
    v_lshlrev_b64 v[82:83], v84, v[82:83]
    v_add_u32 v84, 8, v81
    v_lshrrev_b64 v[82:83], v84, v[82:83]
    v_bfe_u32 v84, v82, 0, 1
    v_bfe_u32 v85, v82, 1, 1
    v_mul_u32_u24 v84, s56, v84
    v_mul_lo_u32 v85, v85, s58
    v_or_b32 v86, v84, v85
    v_bfe_u32 v84, v82, 2, 1
    v_bfe_u32 v85, v82, 3, 1
    v_mul_u32_u24 v84, s56, v84
    v_mul_lo_u32 v85, v85, s58
    v_or_b32 v87, v84, v85
    v_bfe_u32 v84, v82, 4, 1
    v_bfe_u32 v85, v82, 5, 1
    v_mul_u32_u24 v84, s56, v84
    v_mul_lo_u32 v85, v85, s58
    v_or_b32 v88, v84, v85
    v_bfe_u32 v84, v82, 6, 1
    v_bfe_u32 v85, v82, 7, 1
    v_mul_u32_u24 v84, s56, v84
    v_mul_lo_u32 v85, v85, s58
    v_or_b32 v89, v84, v85
    ds_write_b128 v90, v[86:89] offset:0
    v_mov_b32 v82, 511
    v_mov_b32 v83, 0
    v_add_u32 v84, 36, v80
    v_lshlrev_b64 v[82:83], v84, v[82:83]
    v_add_u32 v84, 8, v81
    v_lshrrev_b64 v[82:83], v84, v[82:83]
    v_bfe_u32 v84, v82, 0, 1
    v_bfe_u32 v85, v82, 1, 1
    v_mul_u32_u24 v84, s56, v84
    v_mul_lo_u32 v85, v85, s58
    v_or_b32 v86, v84, v85
    v_bfe_u32 v84, v82, 2, 1
    v_bfe_u32 v85, v82, 3, 1
    v_mul_u32_u24 v84, s56, v84
    v_mul_lo_u32 v85, v85, s58
    v_or_b32 v87, v84, v85
    v_bfe_u32 v84, v82, 4, 1
    v_bfe_u32 v85, v82, 5, 1
    v_mul_u32_u24 v84, s56, v84
    v_mul_lo_u32 v85, v85, s58
    v_or_b32 v88, v84, v85
    v_bfe_u32 v84, v82, 6, 1
    v_bfe_u32 v85, v82, 7, 1
    v_mul_u32_u24 v84, s56, v84
    v_mul_lo_u32 v85, v85, s58
    v_or_b32 v89, v84, v85
    ds_write_b128 v90, v[86:89] offset:1024
    v_mov_b32 v82, 127
    v_mov_b32 v83, 0
    v_add_u32 v84, 13, v80
    v_lshlrev_b64 v[82:83], v84, v[82:83]
    v_add_u32 v84, 8, v81
    v_lshrrev_b64 v[82:83], v84, v[82:83]
    v_bfe_u32 v84, v82, 0, 1
    v_bfe_u32 v85, v82, 1, 1
    v_mul_u32_u24 v84, s56, v84
    v_mul_lo_u32 v85, v85, s58
    v_or_b32 v86, v84, v85
    v_bfe_u32 v84, v82, 2, 1
    v_bfe_u32 v85, v82, 3, 1
    v_mul_u32_u24 v84, s56, v84
    v_mul_lo_u32 v85, v85, s58
    v_or_b32 v87, v84, v85
    v_bfe_u32 v84, v82, 4, 1
    v_bfe_u32 v85, v82, 5, 1
    v_mul_u32_u24 v84, s56, v84
    v_mul_lo_u32 v85, v85, s58
    v_or_b32 v88, v84, v85
    v_bfe_u32 v84, v82, 6, 1
    v_bfe_u32 v85, v82, 7, 1
    v_mul_u32_u24 v84, s56, v84
    v_mul_lo_u32 v85, v85, s58
    v_or_b32 v89, v84, v85
    ds_write_b128 v90, v[86:89] offset:2048
LA_noband:
    s_waitcnt lgkmcnt(0)
    s_cmp_ge_u32 s55, 2
    s_cselect_b32 s56, s63, s62
    s_bitcmp1_b32 s55, 0
    s_cselect_b32 s58, 0, 16
    s_lshl_b32 s56, s56, s58
    s_and_b32 s56, s56, s53
    v_mov_b32 v76, 0x3fb8aa3b
    v_mul_f32 v76, s56, v76
    v_exp_f32 v76, v76
    s_nop 0
    v_cvt_pk_bf16_f32 v76, v76, v76
    v_and_b32 v76, s53, v76
    v_mul_f32 v77, 0x3fb8aa3b, v76
    v_mul_f32 v78, 0x3e22f983, v76
    s_mov_b32 m0, s68
    s_waitcnt vmcnt(4)
    v_mul_f32 v68, v10, v77
    v_mul_f32 v69, v11, v78
    v_mul_f32 v70, 0x41000000, v68
    v_mul_f32 v71, 0x41000000, v69
    v_exp_f32 v70, v70
    v_fract_f32 v71, v71
    v_cos_f32 v72, v71
    v_sin_f32 v73, v71
    s_nop 0
    v_pk_mul_f32 v[46:47], v[72:73], v[70:71] op_sel_hi:[1,0] neg_hi:[1,0]
    v_mov_b32 v67, 0x3f80
    ds_write_addtid_b32 v67 offset:5712
    v_cvt_pk_bf16_f32 v64, v46, v47
    ds_write_addtid_b32 v64 offset:5984
    v_pk_mul_f32 v[60:61], v[46:47], v[46:47] op_sel_hi:[1,0]
    v_pk_fma_f32 v[58:59], v[46:47], v[46:47], v[60:61] op_sel:[1,1,0] op_sel_hi:[0,1,1] neg_lo:[1,0,0]
    v_cvt_pk_bf16_f32 v65, v58, v59
    ds_write_addtid_b32 v65 offset:6256
    v_pk_mul_f32 v[60:61], v[58:59], v[46:47] op_sel_hi:[1,0]
    v_pk_fma_f32 v[58:59], v[58:59], v[46:47], v[60:61] op_sel:[1,1,0] op_sel_hi:[0,1,1] neg_lo:[1,0,0]
    v_cvt_pk_bf16_f32 v66, v58, v59
    ds_write_addtid_b32 v66 offset:6528
    v_pk_mul_f32 v[60:61], v[58:59], v[46:47] op_sel_hi:[1,0]
    v_pk_fma_f32 v[58:59], v[58:59], v[46:47], v[60:61] op_sel:[1,1,0] op_sel_hi:[0,1,1] neg_lo:[1,0,0]
    v_cvt_pk_bf16_f32 v67, v58, v59
    ds_write_addtid_b32 v67 offset:6800
    v_pk_mul_f32 v[60:61], v[58:59], v[46:47] op_sel_hi:[1,0]
    v_pk_fma_f32 v[58:59], v[58:59], v[46:47], v[60:61] op_sel:[1,1,0] op_sel_hi:[0,1,1] neg_lo:[1,0,0]
    v_cvt_pk_bf16_f32 v64, v58, v59
    ds_write_addtid_b32 v64 offset:7072
    v_pk_mul_f32 v[60:61], v[58:59], v[46:47] op_sel_hi:[1,0]
    v_pk_fma_f32 v[58:59], v[58:59], v[46:47], v[60:61] op_sel:[1,1,0] op_sel_hi:[0,1,1] neg_lo:[1,0,0]
    v_cvt_pk_bf16_f32 v65, v58, v59
    ds_write_addtid_b32 v65 offset:7344
    v_pk_mul_f32 v[60:61], v[58:59], v[46:47] op_sel_hi:[1,0]
    v_pk_fma_f32 v[58:59], v[58:59], v[46:47], v[60:61] op_sel:[1,1,0] op_sel_hi:[0,1,1] neg_lo:[1,0,0]
    v_cvt_pk_bf16_f32 v66, v58, v59
    ds_write_addtid_b32 v66 offset:7616
    v_pk_mul_f32 v[60:61], v[58:59], v[46:47] op_sel_hi:[1,0]
    v_pk_fma_f32 v[58:59], v[58:59], v[46:47], v[60:61] op_sel:[1,1,0] op_sel_hi:[0,1,1] neg_lo:[1,0,0]
    v_cvt_pk_bf16_f32 v67, v58, v59
    ds_write_addtid_b32 v67 offset:7888
    v_pk_mul_f32 v[60:61], v[58:59], v[46:47] op_sel_hi:[1,0]
    v_pk_fma_f32 v[58:59], v[58:59], v[46:47], v[60:61] op_sel:[1,1,0] op_sel_hi:[0,1,1] neg_lo:[1,0,0]
    v_cvt_pk_bf16_f32 v64, v58, v59
    ds_write_addtid_b32 v64 offset:8160
    v_pk_mul_f32 v[60:61], v[58:59], v[46:47] op_sel_hi:[1,0]
    v_pk_fma_f32 v[58:59], v[58:59], v[46:47], v[60:61] op_sel:[1,1,0] op_sel_hi:[0,1,1] neg_lo:[1,0,0]
    v_cvt_pk_bf16_f32 v65, v58, v59
    ds_write_addtid_b32 v65 offset:8432
    v_pk_mul_f32 v[60:61], v[58:59], v[46:47] op_sel_hi:[1,0]
    v_pk_fma_f32 v[58:59], v[58:59], v[46:47], v[60:61] op_sel:[1,1,0] op_sel_hi:[0,1,1] neg_lo:[1,0,0]
    v_cvt_pk_bf16_f32 v66, v58, v59
    ds_write_addtid_b32 v66 offset:8704
    v_pk_mul_f32 v[60:61], v[58:59], v[46:47] op_sel_hi:[1,0]
    v_pk_fma_f32 v[58:59], v[58:59], v[46:47], v[60:61] op_sel:[1,1,0] op_sel_hi:[0,1,1] neg_lo:[1,0,0]
    v_cvt_pk_bf16_f32 v67, v58, v59
    ds_write_addtid_b32 v67 offset:8976
    v_pk_mul_f32 v[60:61], v[58:59], v[46:47] op_sel_hi:[1,0]
    v_pk_fma_f32 v[58:59], v[58:59], v[46:47], v[60:61] op_sel:[1,1,0] op_sel_hi:[0,1,1] neg_lo:[1,0,0]
    v_cvt_pk_bf16_f32 v64, v58, v59
    ds_write_addtid_b32 v64 offset:9248
    v_pk_mul_f32 v[60:61], v[58:59], v[46:47] op_sel_hi:[1,0]
    v_pk_fma_f32 v[58:59], v[58:59], v[46:47], v[60:61] op_sel:[1,1,0] op_sel_hi:[0,1,1] neg_lo:[1,0,0]
    v_cvt_pk_bf16_f32 v65, v58, v59
    ds_write_addtid_b32 v65 offset:9520
    v_pk_mul_f32 v[60:61], v[58:59], v[46:47] op_sel_hi:[1,0]
    v_pk_fma_f32 v[58:59], v[58:59], v[46:47], v[60:61] op_sel:[1,1,0] op_sel_hi:[0,1,1] neg_lo:[1,0,0]
    v_cvt_pk_bf16_f32 v66, v58, v59
    ds_write_addtid_b32 v66 offset:9792
    v_pk_mul_f32 v[60:61], v[58:59], v[46:47] op_sel_hi:[1,0]
    v_pk_fma_f32 v[58:59], v[58:59], v[46:47], v[60:61] op_sel:[1,1,0] op_sel_hi:[0,1,1] neg_lo:[1,0,0]
    v_cvt_pk_bf16_f32 v67, v58, v59
    ds_write_addtid_b32 v67 offset:10064
    v_pk_mul_f32 v[60:61], v[58:59], v[46:47] op_sel_hi:[1,0]
    v_pk_fma_f32 v[58:59], v[58:59], v[46:47], v[60:61] op_sel:[1,1,0] op_sel_hi:[0,1,1] neg_lo:[1,0,0]
    v_cvt_pk_bf16_f32 v64, v58, v59
    ds_write_addtid_b32 v64 offset:10336
    v_pk_mul_f32 v[60:61], v[58:59], v[46:47] op_sel_hi:[1,0]
    v_pk_fma_f32 v[58:59], v[58:59], v[46:47], v[60:61] op_sel:[1,1,0] op_sel_hi:[0,1,1] neg_lo:[1,0,0]
    v_cvt_pk_bf16_f32 v65, v58, v59
    ds_write_addtid_b32 v65 offset:10608
    v_pk_mul_f32 v[60:61], v[58:59], v[46:47] op_sel_hi:[1,0]
    v_pk_fma_f32 v[58:59], v[58:59], v[46:47], v[60:61] op_sel:[1,1,0] op_sel_hi:[0,1,1] neg_lo:[1,0,0]
    v_cvt_pk_bf16_f32 v66, v58, v59
    ds_write_addtid_b32 v66 offset:10880
    v_pk_mul_f32 v[60:61], v[58:59], v[46:47] op_sel_hi:[1,0]
    v_pk_fma_f32 v[58:59], v[58:59], v[46:47], v[60:61] op_sel:[1,1,0] op_sel_hi:[0,1,1] neg_lo:[1,0,0]
    v_cvt_pk_bf16_f32 v67, v58, v59
    ds_write_addtid_b32 v67 offset:11152
    v_pk_mul_f32 v[60:61], v[58:59], v[46:47] op_sel_hi:[1,0]
    v_pk_fma_f32 v[58:59], v[58:59], v[46:47], v[60:61] op_sel:[1,1,0] op_sel_hi:[0,1,1] neg_lo:[1,0,0]
    v_cvt_pk_bf16_f32 v64, v58, v59
    ds_write_addtid_b32 v64 offset:11424
    v_pk_mul_f32 v[60:61], v[58:59], v[46:47] op_sel_hi:[1,0]
    v_pk_fma_f32 v[58:59], v[58:59], v[46:47], v[60:61] op_sel:[1,1,0] op_sel_hi:[0,1,1] neg_lo:[1,0,0]
    v_cvt_pk_bf16_f32 v65, v58, v59
    ds_write_addtid_b32 v65 offset:11696
    v_pk_mul_f32 v[60:61], v[58:59], v[46:47] op_sel_hi:[1,0]
    v_pk_fma_f32 v[58:59], v[58:59], v[46:47], v[60:61] op_sel:[1,1,0] op_sel_hi:[0,1,1] neg_lo:[1,0,0]
    v_cvt_pk_bf16_f32 v66, v58, v59
    ds_write_addtid_b32 v66 offset:11968
    v_pk_mul_f32 v[60:61], v[58:59], v[46:47] op_sel_hi:[1,0]
    v_pk_fma_f32 v[58:59], v[58:59], v[46:47], v[60:61] op_sel:[1,1,0] op_sel_hi:[0,1,1] neg_lo:[1,0,0]
    v_cvt_pk_bf16_f32 v67, v58, v59
    ds_write_addtid_b32 v67 offset:12240
    v_pk_mul_f32 v[60:61], v[58:59], v[46:47] op_sel_hi:[1,0]
    v_pk_fma_f32 v[58:59], v[58:59], v[46:47], v[60:61] op_sel:[1,1,0] op_sel_hi:[0,1,1] neg_lo:[1,0,0]
    v_cvt_pk_bf16_f32 v64, v58, v59
    ds_write_addtid_b32 v64 offset:12512
    v_pk_mul_f32 v[60:61], v[58:59], v[46:47] op_sel_hi:[1,0]
    v_pk_fma_f32 v[58:59], v[58:59], v[46:47], v[60:61] op_sel:[1,1,0] op_sel_hi:[0,1,1] neg_lo:[1,0,0]
    v_cvt_pk_bf16_f32 v65, v58, v59
    ds_write_addtid_b32 v65 offset:12784
    v_pk_mul_f32 v[60:61], v[58:59], v[46:47] op_sel_hi:[1,0]
    v_pk_fma_f32 v[58:59], v[58:59], v[46:47], v[60:61] op_sel:[1,1,0] op_sel_hi:[0,1,1] neg_lo:[1,0,0]
    v_cvt_pk_bf16_f32 v66, v58, v59
    ds_write_addtid_b32 v66 offset:13056
    v_pk_mul_f32 v[60:61], v[58:59], v[46:47] op_sel_hi:[1,0]
    v_pk_fma_f32 v[58:59], v[58:59], v[46:47], v[60:61] op_sel:[1,1,0] op_sel_hi:[0,1,1] neg_lo:[1,0,0]
    v_cvt_pk_bf16_f32 v67, v58, v59
    ds_write_addtid_b32 v67 offset:13328
    v_pk_mul_f32 v[60:61], v[58:59], v[46:47] op_sel_hi:[1,0]
    v_pk_fma_f32 v[58:59], v[58:59], v[46:47], v[60:61] op_sel:[1,1,0] op_sel_hi:[0,1,1] neg_lo:[1,0,0]
    v_cvt_pk_bf16_f32 v64, v58, v59
    ds_write_addtid_b32 v64 offset:13600
    v_pk_mul_f32 v[60:61], v[58:59], v[46:47] op_sel_hi:[1,0]
    v_pk_fma_f32 v[58:59], v[58:59], v[46:47], v[60:61] op_sel:[1,1,0] op_sel_hi:[0,1,1] neg_lo:[1,0,0]
    v_cvt_pk_bf16_f32 v65, v58, v59
    ds_write_addtid_b32 v65 offset:13872
    v_pk_mul_f32 v[60:61], v[58:59], v[46:47] op_sel_hi:[1,0]
    v_pk_fma_f32 v[58:59], v[58:59], v[46:47], v[60:61] op_sel:[1,1,0] op_sel_hi:[0,1,1] neg_lo:[1,0,0]
    v_cvt_pk_bf16_f32 v66, v58, v59
    ds_write_addtid_b32 v66 offset:14144
    v_mov_b32 v62, 1
    ds_write_b32 v4, v62
    s_mov_b32 m0, s69
    s_waitcnt vmcnt(2)
    v_mul_f32 v68, v16, v77
    v_mul_f32 v69, v17, v78
    v_mul_f32 v70, 0x41000000, v68
    v_mul_f32 v71, 0x41000000, v69
    v_exp_f32 v70, v70
    v_fract_f32 v71, v71
    v_cos_f32 v72, v71
    v_sin_f32 v73, v71
    s_nop 0
    v_pk_mul_f32 v[46:47], v[72:73], v[70:71] op_sel_hi:[1,0] neg_hi:[1,0]
    v_mov_b32 v67, 0x3f80
    ds_write_addtid_b32 v67 offset:5712
    v_cvt_pk_bf16_f32 v67, v46, v47
    ds_write_addtid_b32 v67 offset:5984
    v_pk_mul_f32 v[60:61], v[46:47], v[46:47] op_sel_hi:[1,0]
    v_pk_fma_f32 v[58:59], v[46:47], v[46:47], v[60:61] op_sel:[1,1,0] op_sel_hi:[0,1,1] neg_lo:[1,0,0]
    v_cvt_pk_bf16_f32 v64, v58, v59
    ds_write_addtid_b32 v64 offset:6256
    v_pk_mul_f32 v[60:61], v[58:59], v[46:47] op_sel_hi:[1,0]
    v_pk_fma_f32 v[58:59], v[58:59], v[46:47], v[60:61] op_sel:[1,1,0] op_sel_hi:[0,1,1] neg_lo:[1,0,0]
    v_cvt_pk_bf16_f32 v65, v58, v59
    ds_write_addtid_b32 v65 offset:6528
    v_pk_mul_f32 v[60:61], v[58:59], v[46:47] op_sel_hi:[1,0]
    v_pk_fma_f32 v[58:59], v[58:59], v[46:47], v[60:61] op_sel:[1,1,0] op_sel_hi:[0,1,1] neg_lo:[1,0,0]
    v_cvt_pk_bf16_f32 v66, v58, v59
    ds_write_addtid_b32 v66 offset:6800
    v_pk_mul_f32 v[60:61], v[58:59], v[46:47] op_sel_hi:[1,0]
    v_pk_fma_f32 v[58:59], v[58:59], v[46:47], v[60:61] op_sel:[1,1,0] op_sel_hi:[0,1,1] neg_lo:[1,0,0]
    v_cvt_pk_bf16_f32 v67, v58, v59
    ds_write_addtid_b32 v67 offset:7072
    v_pk_mul_f32 v[60:61], v[58:59], v[46:47] op_sel_hi:[1,0]
    v_pk_fma_f32 v[58:59], v[58:59], v[46:47], v[60:61] op_sel:[1,1,0] op_sel_hi:[0,1,1] neg_lo:[1,0,0]
    v_cvt_pk_bf16_f32 v64, v58, v59
    ds_write_addtid_b32 v64 offset:7344
    v_pk_mul_f32 v[60:61], v[58:59], v[46:47] op_sel_hi:[1,0]
    v_pk_fma_f32 v[58:59], v[58:59], v[46:47], v[60:61] op_sel:[1,1,0] op_sel_hi:[0,1,1] neg_lo:[1,0,0]
    v_cvt_pk_bf16_f32 v65, v58, v59
    ds_write_addtid_b32 v65 offset:7616
    v_pk_mul_f32 v[60:61], v[58:59], v[46:47] op_sel_hi:[1,0]
    v_pk_fma_f32 v[58:59], v[58:59], v[46:47], v[60:61] op_sel:[1,1,0] op_sel_hi:[0,1,1] neg_lo:[1,0,0]
    v_cvt_pk_bf16_f32 v66, v58, v59
    ds_write_addtid_b32 v66 offset:7888
    v_pk_mul_f32 v[60:61], v[58:59], v[46:47] op_sel_hi:[1,0]
    v_pk_fma_f32 v[58:59], v[58:59], v[46:47], v[60:61] op_sel:[1,1,0] op_sel_hi:[0,1,1] neg_lo:[1,0,0]
    v_cvt_pk_bf16_f32 v67, v58, v59
    ds_write_addtid_b32 v67 offset:8160
    v_pk_mul_f32 v[60:61], v[58:59], v[46:47] op_sel_hi:[1,0]
    v_pk_fma_f32 v[58:59], v[58:59], v[46:47], v[60:61] op_sel:[1,1,0] op_sel_hi:[0,1,1] neg_lo:[1,0,0]
    v_cvt_pk_bf16_f32 v64, v58, v59
    ds_write_addtid_b32 v64 offset:8432
    v_pk_mul_f32 v[60:61], v[58:59], v[46:47] op_sel_hi:[1,0]
    v_pk_fma_f32 v[58:59], v[58:59], v[46:47], v[60:61] op_sel:[1,1,0] op_sel_hi:[0,1,1] neg_lo:[1,0,0]
    v_cvt_pk_bf16_f32 v65, v58, v59
    ds_write_addtid_b32 v65 offset:8704
    v_pk_mul_f32 v[60:61], v[58:59], v[46:47] op_sel_hi:[1,0]
    v_pk_fma_f32 v[58:59], v[58:59], v[46:47], v[60:61] op_sel:[1,1,0] op_sel_hi:[0,1,1] neg_lo:[1,0,0]
    v_cvt_pk_bf16_f32 v66, v58, v59
    ds_write_addtid_b32 v66 offset:8976
    v_pk_mul_f32 v[60:61], v[58:59], v[46:47] op_sel_hi:[1,0]
    v_pk_fma_f32 v[58:59], v[58:59], v[46:47], v[60:61] op_sel:[1,1,0] op_sel_hi:[0,1,1] neg_lo:[1,0,0]
    v_cvt_pk_bf16_f32 v67, v58, v59
    ds_write_addtid_b32 v67 offset:9248
    v_pk_mul_f32 v[60:61], v[58:59], v[46:47] op_sel_hi:[1,0]
    v_pk_fma_f32 v[58:59], v[58:59], v[46:47], v[60:61] op_sel:[1,1,0] op_sel_hi:[0,1,1] neg_lo:[1,0,0]
    v_cvt_pk_bf16_f32 v64, v58, v59
    ds_write_addtid_b32 v64 offset:9520
    v_pk_mul_f32 v[60:61], v[58:59], v[46:47] op_sel_hi:[1,0]
    v_pk_fma_f32 v[58:59], v[58:59], v[46:47], v[60:61] op_sel:[1,1,0] op_sel_hi:[0,1,1] neg_lo:[1,0,0]
    v_cvt_pk_bf16_f32 v65, v58, v59
    ds_write_addtid_b32 v65 offset:9792
    v_pk_mul_f32 v[60:61], v[58:59], v[46:47] op_sel_hi:[1,0]
    v_pk_fma_f32 v[58:59], v[58:59], v[46:47], v[60:61] op_sel:[1,1,0] op_sel_hi:[0,1,1] neg_lo:[1,0,0]
    v_cvt_pk_bf16_f32 v66, v58, v59
    ds_write_addtid_b32 v66 offset:10064
    v_pk_mul_f32 v[60:61], v[58:59], v[46:47] op_sel_hi:[1,0]
    v_pk_fma_f32 v[58:59], v[58:59], v[46:47], v[60:61] op_sel:[1,1,0] op_sel_hi:[0,1,1] neg_lo:[1,0,0]
    v_cvt_pk_bf16_f32 v67, v58, v59
    ds_write_addtid_b32 v67 offset:10336
    v_pk_mul_f32 v[60:61], v[58:59], v[46:47] op_sel_hi:[1,0]
    v_pk_fma_f32 v[58:59], v[58:59], v[46:47], v[60:61] op_sel:[1,1,0] op_sel_hi:[0,1,1] neg_lo:[1,0,0]
    v_cvt_pk_bf16_f32 v64, v58, v59
    ds_write_addtid_b32 v64 offset:10608
    v_pk_mul_f32 v[60:61], v[58:59], v[46:47] op_sel_hi:[1,0]
    v_pk_fma_f32 v[58:59], v[58:59], v[46:47], v[60:61] op_sel:[1,1,0] op_sel_hi:[0,1,1] neg_lo:[1,0,0]
    v_cvt_pk_bf16_f32 v65, v58, v59
    ds_write_addtid_b32 v65 offset:10880
    v_pk_mul_f32 v[60:61], v[58:59], v[46:47] op_sel_hi:[1,0]
    v_pk_fma_f32 v[58:59], v[58:59], v[46:47], v[60:61] op_sel:[1,1,0] op_sel_hi:[0,1,1] neg_lo:[1,0,0]
    v_cvt_pk_bf16_f32 v66, v58, v59
    ds_write_addtid_b32 v66 offset:11152
    v_pk_mul_f32 v[60:61], v[58:59], v[46:47] op_sel_hi:[1,0]
    v_pk_fma_f32 v[58:59], v[58:59], v[46:47], v[60:61] op_sel:[1,1,0] op_sel_hi:[0,1,1] neg_lo:[1,0,0]
    v_cvt_pk_bf16_f32 v67, v58, v59
    ds_write_addtid_b32 v67 offset:11424
    v_pk_mul_f32 v[60:61], v[58:59], v[46:47] op_sel_hi:[1,0]
    v_pk_fma_f32 v[58:59], v[58:59], v[46:47], v[60:61] op_sel:[1,1,0] op_sel_hi:[0,1,1] neg_lo:[1,0,0]
    v_cvt_pk_bf16_f32 v64, v58, v59
    ds_write_addtid_b32 v64 offset:11696
    v_pk_mul_f32 v[60:61], v[58:59], v[46:47] op_sel_hi:[1,0]
    v_pk_fma_f32 v[58:59], v[58:59], v[46:47], v[60:61] op_sel:[1,1,0] op_sel_hi:[0,1,1] neg_lo:[1,0,0]
    v_cvt_pk_bf16_f32 v65, v58, v59
    ds_write_addtid_b32 v65 offset:11968
    v_pk_mul_f32 v[60:61], v[58:59], v[46:47] op_sel_hi:[1,0]
    v_pk_fma_f32 v[58:59], v[58:59], v[46:47], v[60:61] op_sel:[1,1,0] op_sel_hi:[0,1,1] neg_lo:[1,0,0]
    v_cvt_pk_bf16_f32 v66, v58, v59
    ds_write_addtid_b32 v66 offset:12240
    v_pk_mul_f32 v[60:61], v[58:59], v[46:47] op_sel_hi:[1,0]
    v_pk_fma_f32 v[58:59], v[58:59], v[46:47], v[60:61] op_sel:[1,1,0] op_sel_hi:[0,1,1] neg_lo:[1,0,0]
    v_cvt_pk_bf16_f32 v67, v58, v59
    ds_write_addtid_b32 v67 offset:12512
    v_pk_mul_f32 v[60:61], v[58:59], v[46:47] op_sel_hi:[1,0]
    v_pk_fma_f32 v[58:59], v[58:59], v[46:47], v[60:61] op_sel:[1,1,0] op_sel_hi:[0,1,1] neg_lo:[1,0,0]
    v_cvt_pk_bf16_f32 v64, v58, v59
    ds_write_addtid_b32 v64 offset:12784
    v_pk_mul_f32 v[60:61], v[58:59], v[46:47] op_sel_hi:[1,0]
    v_pk_fma_f32 v[58:59], v[58:59], v[46:47], v[60:61] op_sel:[1,1,0] op_sel_hi:[0,1,1] neg_lo:[1,0,0]
    v_cvt_pk_bf16_f32 v65, v58, v59
    ds_write_addtid_b32 v65 offset:13056
    v_pk_mul_f32 v[60:61], v[58:59], v[46:47] op_sel_hi:[1,0]
    v_pk_fma_f32 v[58:59], v[58:59], v[46:47], v[60:61] op_sel:[1,1,0] op_sel_hi:[0,1,1] neg_lo:[1,0,0]
    v_cvt_pk_bf16_f32 v66, v58, v59
    ds_write_addtid_b32 v66 offset:13328
    v_pk_mul_f32 v[60:61], v[58:59], v[46:47] op_sel_hi:[1,0]
    v_pk_fma_f32 v[58:59], v[58:59], v[46:47], v[60:61] op_sel:[1,1,0] op_sel_hi:[0,1,1] neg_lo:[1,0,0]
    v_cvt_pk_bf16_f32 v67, v58, v59
    ds_write_addtid_b32 v67 offset:13600
    v_pk_mul_f32 v[60:61], v[58:59], v[46:47] op_sel_hi:[1,0]
    v_pk_fma_f32 v[58:59], v[58:59], v[46:47], v[60:61] op_sel:[1,1,0] op_sel_hi:[0,1,1] neg_lo:[1,0,0]
    v_cvt_pk_bf16_f32 v64, v58, v59
    ds_write_addtid_b32 v64 offset:13872
    v_pk_mul_f32 v[60:61], v[58:59], v[46:47] op_sel_hi:[1,0]
    v_pk_fma_f32 v[58:59], v[58:59], v[46:47], v[60:61] op_sel:[1,1,0] op_sel_hi:[0,1,1] neg_lo:[1,0,0]
    v_cvt_pk_bf16_f32 v65, v58, v59
    ds_write_addtid_b32 v65 offset:14144
    v_mov_b32 v62, 2
    ds_write_b32 v4, v62
    s_mov_b32 m0, s68
    s_waitcnt vmcnt(0)
    v_mul_f32 v68, v22, v77
    v_mul_f32 v69, v23, v78
    v_mul_f32 v70, 0x41000000, v68
    v_mul_f32 v71, 0x41000000, v69
    v_exp_f32 v70, v70
    v_fract_f32 v71, v71
    v_cos_f32 v72, v71
    v_sin_f32 v73, v71
    s_nop 0
    v_pk_mul_f32 v[46:47], v[72:73], v[70:71] op_sel_hi:[1,0] neg_hi:[1,0]
    s_mov_b32 s56, 0x100000
LA_s1:
    ds_read_b32 v62, v5
    s_waitcnt lgkmcnt(0)
    v_cmp_gt_u32 vcc, 1, v62
    s_cbranch_vccz LA_s1d
    s_sub_u32 s56, s56, 1
    s_cmp_lg_u32 s56, 0
    s_cbranch_scc1 LA_s1
LA_s1d:
    v_mov_b32 v67, 0x3f80
    ds_write_addtid_b32 v67 offset:5712
    v_cvt_pk_bf16_f32 v66, v46, v47
    ds_write_addtid_b32 v66 offset:5984
    v_pk_mul_f32 v[60:61], v[46:47], v[46:47] op_sel_hi:[1,0]
    v_pk_fma_f32 v[58:59], v[46:47], v[46:47], v[60:61] op_sel:[1,1,0] op_sel_hi:[0,1,1] neg_lo:[1,0,0]
    v_cvt_pk_bf16_f32 v67, v58, v59
    ds_write_addtid_b32 v67 offset:6256
    v_pk_mul_f32 v[60:61], v[58:59], v[46:47] op_sel_hi:[1,0]
    v_pk_fma_f32 v[58:59], v[58:59], v[46:47], v[60:61] op_sel:[1,1,0] op_sel_hi:[0,1,1] neg_lo:[1,0,0]
    v_cvt_pk_bf16_f32 v64, v58, v59
    ds_write_addtid_b32 v64 offset:6528
    v_pk_mul_f32 v[60:61], v[58:59], v[46:47] op_sel_hi:[1,0]
    v_pk_fma_f32 v[58:59], v[58:59], v[46:47], v[60:61] op_sel:[1,1,0] op_sel_hi:[0,1,1] neg_lo:[1,0,0]
    v_cvt_pk_bf16_f32 v65, v58, v59
    ds_write_addtid_b32 v65 offset:6800
    v_pk_mul_f32 v[60:61], v[58:59], v[46:47] op_sel_hi:[1,0]
    v_pk_fma_f32 v[58:59], v[58:59], v[46:47], v[60:61] op_sel:[1,1,0] op_sel_hi:[0,1,1] neg_lo:[1,0,0]
    v_cvt_pk_bf16_f32 v66, v58, v59
    ds_write_addtid_b32 v66 offset:7072
    v_pk_mul_f32 v[60:61], v[58:59], v[46:47] op_sel_hi:[1,0]
    v_pk_fma_f32 v[58:59], v[58:59], v[46:47], v[60:61] op_sel:[1,1,0] op_sel_hi:[0,1,1] neg_lo:[1,0,0]
    v_cvt_pk_bf16_f32 v67, v58, v59
    ds_write_addtid_b32 v67 offset:7344
    v_pk_mul_f32 v[60:61], v[58:59], v[46:47] op_sel_hi:[1,0]
    v_pk_fma_f32 v[58:59], v[58:59], v[46:47], v[60:61] op_sel:[1,1,0] op_sel_hi:[0,1,1] neg_lo:[1,0,0]
    v_cvt_pk_bf16_f32 v64, v58, v59
    ds_write_addtid_b32 v64 offset:7616
    v_pk_mul_f32 v[60:61], v[58:59], v[46:47] op_sel_hi:[1,0]
    v_pk_fma_f32 v[58:59], v[58:59], v[46:47], v[60:61] op_sel:[1,1,0] op_sel_hi:[0,1,1] neg_lo:[1,0,0]
    v_cvt_pk_bf16_f32 v65, v58, v59
    ds_write_addtid_b32 v65 offset:7888
    v_pk_mul_f32 v[60:61], v[58:59], v[46:47] op_sel_hi:[1,0]
    v_pk_fma_f32 v[58:59], v[58:59], v[46:47], v[60:61] op_sel:[1,1,0] op_sel_hi:[0,1,1] neg_lo:[1,0,0]
    v_cvt_pk_bf16_f32 v66, v58, v59
    ds_write_addtid_b32 v66 offset:8160
    v_pk_mul_f32 v[60:61], v[58:59], v[46:47] op_sel_hi:[1,0]
    v_pk_fma_f32 v[58:59], v[58:59], v[46:47], v[60:61] op_sel:[1,1,0] op_sel_hi:[0,1,1] neg_lo:[1,0,0]
    v_cvt_pk_bf16_f32 v67, v58, v59
    ds_write_addtid_b32 v67 offset:8432
    v_pk_mul_f32 v[60:61], v[58:59], v[46:47] op_sel_hi:[1,0]
    v_pk_fma_f32 v[58:59], v[58:59], v[46:47], v[60:61] op_sel:[1,1,0] op_sel_hi:[0,1,1] neg_lo:[1,0,0]
    v_cvt_pk_bf16_f32 v64, v58, v59
    ds_write_addtid_b32 v64 offset:8704
    v_pk_mul_f32 v[60:61], v[58:59], v[46:47] op_sel_hi:[1,0]
    v_pk_fma_f32 v[58:59], v[58:59], v[46:47], v[60:61] op_sel:[1,1,0] op_sel_hi:[0,1,1] neg_lo:[1,0,0]
    v_cvt_pk_bf16_f32 v65, v58, v59
    ds_write_addtid_b32 v65 offset:8976
    v_pk_mul_f32 v[60:61], v[58:59], v[46:47] op_sel_hi:[1,0]
    v_pk_fma_f32 v[58:59], v[58:59], v[46:47], v[60:61] op_sel:[1,1,0] op_sel_hi:[0,1,1] neg_lo:[1,0,0]
    v_cvt_pk_bf16_f32 v66, v58, v59
    ds_write_addtid_b32 v66 offset:9248
    v_pk_mul_f32 v[60:61], v[58:59], v[46:47] op_sel_hi:[1,0]
    v_pk_fma_f32 v[58:59], v[58:59], v[46:47], v[60:61] op_sel:[1,1,0] op_sel_hi:[0,1,1] neg_lo:[1,0,0]
    v_cvt_pk_bf16_f32 v67, v58, v59
    ds_write_addtid_b32 v67 offset:9520
    v_pk_mul_f32 v[60:61], v[58:59], v[46:47] op_sel_hi:[1,0]
    v_pk_fma_f32 v[58:59], v[58:59], v[46:47], v[60:61] op_sel:[1,1,0] op_sel_hi:[0,1,1] neg_lo:[1,0,0]
    v_cvt_pk_bf16_f32 v64, v58, v59
    ds_write_addtid_b32 v64 offset:9792
    v_pk_mul_f32 v[60:61], v[58:59], v[46:47] op_sel_hi:[1,0]
    v_pk_fma_f32 v[58:59], v[58:59], v[46:47], v[60:61] op_sel:[1,1,0] op_sel_hi:[0,1,1] neg_lo:[1,0,0]
    v_cvt_pk_bf16_f32 v65, v58, v59
    ds_write_addtid_b32 v65 offset:10064
    v_pk_mul_f32 v[60:61], v[58:59], v[46:47] op_sel_hi:[1,0]
    v_pk_fma_f32 v[58:59], v[58:59], v[46:47], v[60:61] op_sel:[1,1,0] op_sel_hi:[0,1,1] neg_lo:[1,0,0]
    v_cvt_pk_bf16_f32 v66, v58, v59
    ds_write_addtid_b32 v66 offset:10336
    v_pk_mul_f32 v[60:61], v[58:59], v[46:47] op_sel_hi:[1,0]
    v_pk_fma_f32 v[58:59], v[58:59], v[46:47], v[60:61] op_sel:[1,1,0] op_sel_hi:[0,1,1] neg_lo:[1,0,0]
    v_cvt_pk_bf16_f32 v67, v58, v59
    ds_write_addtid_b32 v67 offset:10608
    v_pk_mul_f32 v[60:61], v[58:59], v[46:47] op_sel_hi:[1,0]
    v_pk_fma_f32 v[58:59], v[58:59], v[46:47], v[60:61] op_sel:[1,1,0] op_sel_hi:[0,1,1] neg_lo:[1,0,0]
    v_cvt_pk_bf16_f32 v64, v58, v59
    ds_write_addtid_b32 v64 offset:10880
    v_pk_mul_f32 v[60:61], v[58:59], v[46:47] op_sel_hi:[1,0]
    v_pk_fma_f32 v[58:59], v[58:59], v[46:47], v[60:61] op_sel:[1,1,0] op_sel_hi:[0,1,1] neg_lo:[1,0,0]
    v_cvt_pk_bf16_f32 v65, v58, v59
    ds_write_addtid_b32 v65 offset:11152
    v_pk_mul_f32 v[60:61], v[58:59], v[46:47] op_sel_hi:[1,0]
    v_pk_fma_f32 v[58:59], v[58:59], v[46:47], v[60:61] op_sel:[1,1,0] op_sel_hi:[0,1,1] neg_lo:[1,0,0]
    v_cvt_pk_bf16_f32 v66, v58, v59
    ds_write_addtid_b32 v66 offset:11424
    v_pk_mul_f32 v[60:61], v[58:59], v[46:47] op_sel_hi:[1,0]
    v_pk_fma_f32 v[58:59], v[58:59], v[46:47], v[60:61] op_sel:[1,1,0] op_sel_hi:[0,1,1] neg_lo:[1,0,0]
    v_cvt_pk_bf16_f32 v67, v58, v59
    ds_write_addtid_b32 v67 offset:11696
    v_pk_mul_f32 v[60:61], v[58:59], v[46:47] op_sel_hi:[1,0]
    v_pk_fma_f32 v[58:59], v[58:59], v[46:47], v[60:61] op_sel:[1,1,0] op_sel_hi:[0,1,1] neg_lo:[1,0,0]
    v_cvt_pk_bf16_f32 v64, v58, v59
    ds_write_addtid_b32 v64 offset:11968
    v_pk_mul_f32 v[60:61], v[58:59], v[46:47] op_sel_hi:[1,0]
    v_pk_fma_f32 v[58:59], v[58:59], v[46:47], v[60:61] op_sel:[1,1,0] op_sel_hi:[0,1,1] neg_lo:[1,0,0]
    v_cvt_pk_bf16_f32 v65, v58, v59
    ds_write_addtid_b32 v65 offset:12240
    v_pk_mul_f32 v[60:61], v[58:59], v[46:47] op_sel_hi:[1,0]
    v_pk_fma_f32 v[58:59], v[58:59], v[46:47], v[60:61] op_sel:[1,1,0] op_sel_hi:[0,1,1] neg_lo:[1,0,0]
    v_cvt_pk_bf16_f32 v66, v58, v59
    ds_write_addtid_b32 v66 offset:12512
    v_pk_mul_f32 v[60:61], v[58:59], v[46:47] op_sel_hi:[1,0]
    v_pk_fma_f32 v[58:59], v[58:59], v[46:47], v[60:61] op_sel:[1,1,0] op_sel_hi:[0,1,1] neg_lo:[1,0,0]
    v_cvt_pk_bf16_f32 v67, v58, v59
    ds_write_addtid_b32 v67 offset:12784
    v_pk_mul_f32 v[60:61], v[58:59], v[46:47] op_sel_hi:[1,0]
    v_pk_fma_f32 v[58:59], v[58:59], v[46:47], v[60:61] op_sel:[1,1,0] op_sel_hi:[0,1,1] neg_lo:[1,0,0]
    v_cvt_pk_bf16_f32 v64, v58, v59
    ds_write_addtid_b32 v64 offset:13056
    v_pk_mul_f32 v[60:61], v[58:59], v[46:47] op_sel_hi:[1,0]
    v_pk_fma_f32 v[58:59], v[58:59], v[46:47], v[60:61] op_sel:[1,1,0] op_sel_hi:[0,1,1] neg_lo:[1,0,0]
    v_cvt_pk_bf16_f32 v65, v58, v59
    ds_write_addtid_b32 v65 offset:13328
    v_pk_mul_f32 v[60:61], v[58:59], v[46:47] op_sel_hi:[1,0]
    v_pk_fma_f32 v[58:59], v[58:59], v[46:47], v[60:61] op_sel:[1,1,0] op_sel_hi:[0,1,1] neg_lo:[1,0,0]
    v_cvt_pk_bf16_f32 v66, v58, v59
    ds_write_addtid_b32 v66 offset:13600
    v_pk_mul_f32 v[60:61], v[58:59], v[46:47] op_sel_hi:[1,0]
    v_pk_fma_f32 v[58:59], v[58:59], v[46:47], v[60:61] op_sel:[1,1,0] op_sel_hi:[0,1,1] neg_lo:[1,0,0]
    v_cvt_pk_bf16_f32 v67, v58, v59
    ds_write_addtid_b32 v67 offset:13872
    v_pk_mul_f32 v[60:61], v[58:59], v[46:47] op_sel_hi:[1,0]
    v_pk_fma_f32 v[58:59], v[58:59], v[46:47], v[60:61] op_sel:[1,1,0] op_sel_hi:[0,1,1] neg_lo:[1,0,0]
    v_cvt_pk_bf16_f32 v64, v58, v59
    ds_write_addtid_b32 v64 offset:14144
    v_mov_b32 v62, 3
    ds_write_b32 v4, v62
    s_endpgm
LA_p:
    s_waitcnt lgkmcnt(0)
    s_cmp_ge_u32 s55, 2
    s_cselect_b32 s56, s63, s62
    s_bitcmp1_b32 s55, 0
    s_cselect_b32 s58, 0, 16
    s_lshl_b32 s56, s56, s58
    s_and_b32 s56, s56, s53
    v_mov_b32 v76, 0x3fb8aa3b
    v_mul_f32 v76, s56, v76
    v_exp_f32 v76, v76
    s_nop 0
    v_cvt_pk_bf16_f32 v76, v76, v76
    v_and_b32 v76, s53, v76
    v_mul_f32 v77, 0x3fb8aa3b, v76
    v_mul_f32 v78, 0x3e22f983, v76
    s_cmp_ge_u32 s55, 2
    s_cselect_b32 s76, s65, s64
    s_lshl_b32 s76, s76, s58
    s_and_b32 s76, s76, s53
    s_mov_b32 m0, s68
    s_waitcnt vmcnt(8)
    v_mul_f32 v68, v10, v77
    v_mul_f32 v69, v11, v78
    v_mul_f32 v12, v12, v76
    v_mul_f32 v13, v13, v76
    v_exp_f32 v70, v68
    v_fract_f32 v71, v69
    v_cos_f32 v72, v71
    v_sin_f32 v73, v71
    s_nop 0
    v_pk_mul_f32 v[44:45], v[72:73], v[70:71] op_sel_hi:[1,0]
    v_pk_mul_f32 v[60:61], v[14:15], v[12:13] op_sel_hi:[1,0]
    v_pk_fma_f32 v[50:51], v[14:15], v[12:13], v[60:61] op_sel:[1,1,0] op_sel_hi:[0,1,1] neg_lo:[1,0,0]
    v_mul_f32 v70, 0x43800000, v68
    v_mul_f32 v71, 0x43800000, v69
    v_exp_f32 v70, v70
    v_fract_f32 v71, v71
    v_cos_f32 v72, v71
    v_sin_f32 v73, v71
    s_nop 0
    v_pk_mul_f32 v[48:49], v[72:73], v[70:71] op_sel_hi:[1,0]
    v_cvt_pk_bf16_f32 v65, v50, v51
    ds_write_addtid_b32 v65 offset:0
    v_pk_mul_f32 v[60:61], v[50:51], v[44:45] op_sel_hi:[1,0]
    v_pk_fma_f32 v[58:59], v[50:51], v[44:45], v[60:61] op_sel:[1,1,0] op_sel_hi:[0,1,1] neg_lo:[1,0,0]
    v_cvt_pk_bf16_f32 v66, v58, v59
    ds_write_addtid_b32 v66 offset:272
    v_pk_mul_f32 v[60:61], v[58:59], v[44:45] op_sel_hi:[1,0]
    v_pk_fma_f32 v[52:53], v[58:59], v[44:45], v[60:61] op_sel:[1,1,0] op_sel_hi:[0,1,1] neg_lo:[1,0,0]
    v_cvt_pk_bf16_f32 v67, v52, v53
    ds_write_addtid_b32 v67 offset:544
    v_pk_mul_f32 v[60:61], v[52:53], v[44:45] op_sel_hi:[1,0]
    v_pk_fma_f32 v[58:59], v[52:53], v[44:45], v[60:61] op_sel:[1,1,0] op_sel_hi:[0,1,1] neg_lo:[1,0,0]
    v_cvt_pk_bf16_f32 v64, v58, v59
    ds_write_addtid_b32 v64 offset:816
    v_pk_mul_f32 v[60:61], v[58:59], v[44:45] op_sel_hi:[1,0]
    v_pk_fma_f32 v[54:55], v[58:59], v[44:45], v[60:61] op_sel:[1,1,0] op_sel_hi:[0,1,1] neg_lo:[1,0,0]
    v_cvt_pk_bf16_f32 v65, v54, v55
    ds_write_addtid_b32 v65 offset:1088
    v_pk_mul_f32 v[60:61], v[54:55], v[44:45] op_sel_hi:[1,0]
    v_pk_fma_f32 v[58:59], v[54:55], v[44:45], v[60:61] op_sel:[1,1,0] op_sel_hi:[0,1,1] neg_lo:[1,0,0]
    v_cvt_pk_bf16_f32 v66, v58, v59
    ds_write_addtid_b32 v66 offset:1360
    v_pk_mul_f32 v[60:61], v[58:59], v[44:45] op_sel_hi:[1,0]
    v_pk_fma_f32 v[56:57], v[58:59], v[44:45], v[60:61] op_sel:[1,1,0] op_sel_hi:[0,1,1] neg_lo:[1,0,0]
    v_cvt_pk_bf16_f32 v67, v56, v57
    ds_write_addtid_b32 v67 offset:1632
    v_pk_mul_f32 v[60:61], v[56:57], v[44:45] op_sel_hi:[1,0]
    v_pk_fma_f32 v[58:59], v[56:57], v[44:45], v[60:61] op_sel:[1,1,0] op_sel_hi:[0,1,1] neg_lo:[1,0,0]
    v_cvt_pk_bf16_f32 v64, v58, v59
    ds_write_addtid_b32 v64 offset:1904
    v_pk_mul_f32 v[60:61], v[50:51], v[48:49] op_sel_hi:[1,0]
    v_pk_fma_f32 v[50:51], v[50:51], v[48:49], v[60:61] op_sel:[1,1,0] op_sel_hi:[0,1,1] neg_lo:[1,0,0]
    v_cvt_pk_bf16_f32 v65, v50, v51
    ds_write_addtid_b32 v65 offset:2176
    v_pk_mul_f32 v[60:61], v[52:53], v[48:49] op_sel_hi:[1,0]
    v_pk_fma_f32 v[52:53], v[52:53], v[48:49], v[60:61] op_sel:[1,1,0] op_sel_hi:[0,1,1] neg_lo:[1,0,0]
    v_cvt_pk_bf16_f32 v66, v52, v53
    ds_write_addtid_b32 v66 offset:2448
    v_pk_mul_f32 v[60:61], v[54:55], v[48:49] op_sel_hi:[1,0]
    v_pk_fma_f32 v[54:55], v[54:55], v[48:49], v[60:61] op_sel:[1,1,0] op_sel_hi:[0,1,1] neg_lo:[1,0,0]
    v_cvt_pk_bf16_f32 v67, v54, v55
    ds_write_addtid_b32 v67 offset:2720
    v_pk_mul_f32 v[60:61], v[56:57], v[48:49] op_sel_hi:[1,0]
    v_pk_fma_f32 v[56:57], v[56:57], v[48:49], v[60:61] op_sel:[1,1,0] op_sel_hi:[0,1,1] neg_lo:[1,0,0]
    v_cvt_pk_bf16_f32 v64, v56, v57
    ds_write_addtid_b32 v64 offset:2992
    v_pk_mul_f32 v[60:61], v[50:51], v[48:49] op_sel_hi:[1,0]
    v_pk_fma_f32 v[50:51], v[50:51], v[48:49], v[60:61] op_sel:[1,1,0] op_sel_hi:[0,1,1] neg_lo:[1,0,0]
    v_cvt_pk_bf16_f32 v65, v50, v51
    ds_write_addtid_b32 v65 offset:3264
    v_pk_mul_f32 v[60:61], v[54:55], v[48:49] op_sel_hi:[1,0]
    v_pk_fma_f32 v[54:55], v[54:55], v[48:49], v[60:61] op_sel:[1,1,0] op_sel_hi:[0,1,1] neg_lo:[1,0,0]
    v_cvt_pk_bf16_f32 v66, v54, v55
    ds_write_addtid_b32 v66 offset:3536
    v_pk_mul_f32 v[60:61], v[50:51], v[48:49] op_sel_hi:[1,0]
    v_pk_fma_f32 v[50:51], v[50:51], v[48:49], v[60:61] op_sel:[1,1,0] op_sel_hi:[0,1,1] neg_lo:[1,0,0]
    v_cvt_pk_bf16_f32 v67, v50, v51
    ds_write_addtid_b32 v67 offset:3808
    v_pk_mul_f32 v[60:61], v[54:55], v[48:49] op_sel_hi:[1,0]
    v_pk_fma_f32 v[54:55], v[54:55], v[48:49], v[60:61] op_sel:[1,1,0] op_sel_hi:[0,1,1] neg_lo:[1,0,0]
    v_cvt_pk_bf16_f32 v64, v54, v55
    ds_write_addtid_b32 v64 offset:4080
    v_pk_mul_f32 v[60:61], v[50:51], v[48:49] op_sel_hi:[1,0]
    v_pk_fma_f32 v[50:51], v[50:51], v[48:49], v[60:61] op_sel:[1,1,0] op_sel_hi:[0,1,1] neg_lo:[1,0,0]
    v_cvt_pk_bf16_f32 v65, v50, v51
    ds_write_addtid_b32 v65 offset:4352
    v_pk_mul_f32 v[60:61], v[50:51], v[48:49] op_sel_hi:[1,0]
    v_pk_fma_f32 v[50:51], v[50:51], v[48:49], v[60:61] op_sel:[1,1,0] op_sel_hi:[0,1,1] neg_lo:[1,0,0]
    v_cvt_pk_bf16_f32 v66, v50, v51
    ds_write_addtid_b32 v66 offset:4624
    v_pk_mul_f32 v[60:61], v[50:51], v[48:49] op_sel_hi:[1,0]
    v_pk_fma_f32 v[50:51], v[50:51], v[48:49], v[60:61] op_sel:[1,1,0] op_sel_hi:[0,1,1] neg_lo:[1,0,0]
    v_cvt_pk_bf16_f32 v67, v50, v51
    ds_write_addtid_b32 v67 offset:4896
    v_pk_mul_f32 v[60:61], v[50:51], v[48:49] op_sel_hi:[1,0]
    v_pk_fma_f32 v[50:51], v[50:51], v[48:49], v[60:61] op_sel:[1,1,0] op_sel_hi:[0,1,1] neg_lo:[1,0,0]
    v_cvt_pk_bf16_f32 v64, v50, v51
    ds_write_addtid_b32 v64 offset:5168
    v_pk_mul_f32 v[60:61], v[50:51], v[48:49] op_sel_hi:[1,0]
    v_pk_fma_f32 v[50:51], v[50:51], v[48:49], v[60:61] op_sel:[1,1,0] op_sel_hi:[0,1,1] neg_lo:[1,0,0]
    v_cvt_pk_bf16_f32 v65, v50, v51
    ds_write_addtid_b32 v65 offset:5440
    s_mov_b32 s56, 0x100000
LA_s2:
    ds_read_b32 v62, v4
    s_waitcnt lgkmcnt(0)
    v_cmp_gt_u32 vcc, 1, v62
    s_cbranch_vccz LA_s2d
    s_sub_u32 s56, s56, 1
    s_cmp_lg_u32 s56, 0
    s_cbranch_scc1 LA_s2
LA_s2d:
    ds_read_b128 v[80:83], v6 offset:0
    ds_read_b128 v[84:87], v6 offset:5712
    ds_read_b128 v[88:91], v6 offset:32
    ds_read_b128 v[92:95], v6 offset:5744
    ds_read_b128 v[96:99], v6 offset:64
    ds_read_b128 v[100:103], v6 offset:5776
    ds_read_b128 v[104:107], v6 offset:96
    ds_read_b128 v[108:111], v6 offset:5808
    ds_read_b128 v[112:115], v6 offset:128
    ds_read_b128 v[116:119], v6 offset:5840
    ds_read_b128 v[120:123], v6 offset:160
    ds_read_b128 v[124:127], v6 offset:5872
    ds_read_b128 v[128:131], v6 offset:192
    ds_read_b128 v[132:135], v6 offset:5904
    ds_read_b128 v[136:139], v6 offset:224
    ds_read_b128 v[140:143], v6 offset:5936
    s_mov_b32 m0, s69
    s_waitcnt vmcnt(4)
    v_mul_f32 v68, v16, v77
    v_mul_f32 v69, v17, v78
    v_mul_f32 v18, v18, v76
    v_mul_f32 v19, v19, v76
    v_exp_f32 v70, v68
    v_fract_f32 v71, v69
    v_cos_f32 v72, v71
    v_sin_f32 v73, v71
    s_nop 0
    v_pk_mul_f32 v[44:45], v[72:73], v[70:71] op_sel_hi:[1,0]
    v_pk_mul_f32 v[60:61], v[20:21], v[18:19] op_sel_hi:[1,0]
    v_pk_fma_f32 v[50:51], v[20:21], v[18:19], v[60:61] op_sel:[1,1,0] op_sel_hi:[0,1,1] neg_lo:[1,0,0]
    v_mul_f32 v70, 0x43800000, v68
    v_mul_f32 v71, 0x43800000, v69
    v_exp_f32 v70, v70
    v_fract_f32 v71, v71
    v_cos_f32 v72, v71
    v_sin_f32 v73, v71
    s_nop 0
    v_pk_mul_f32 v[48:49], v[72:73], v[70:71] op_sel_hi:[1,0]
    v_mov_b32 v62, 1
    s_waitcnt lgkmcnt(0)
    ds_write_b32 v5, v62
    v_cvt_pk_bf16_f32 v66, v50, v51
    ds_write_addtid_b32 v66 offset:0
    v_mfma_f32_32x32x16_bf16 v[144:159], v[80:83], v[84:87], 0
    v_pk_mul_f32 v[60:61], v[50:51], v[44:45] op_sel_hi:[1,0]
    v_pk_fma_f32 v[58:59], v[50:51], v[44:45], v[60:61] op_sel:[1,1,0] op_sel_hi:[0,1,1] neg_lo:[1,0,0]
    v_cvt_pk_bf16_f32 v67, v58, v59
    ds_write_addtid_b32 v67 offset:272
    v_mfma_f32_32x32x16_bf16 v[144:159], v[88:91], v[92:95], v[144:159]
    v_pk_mul_f32 v[60:61], v[58:59], v[44:45] op_sel_hi:[1,0]
    v_pk_fma_f32 v[52:53], v[58:59], v[44:45], v[60:61] op_sel:[1,1,0] op_sel_hi:[0,1,1] neg_lo:[1,0,0]
    v_cvt_pk_bf16_f32 v64, v52, v53
    ds_write_addtid_b32 v64 offset:544
    v_mfma_f32_32x32x16_bf16 v[144:159], v[96:99], v[100:103], v[144:159]
    v_pk_mul_f32 v[60:61], v[52:53], v[44:45] op_sel_hi:[1,0]
    v_pk_fma_f32 v[58:59], v[52:53], v[44:45], v[60:61] op_sel:[1,1,0] op_sel_hi:[0,1,1] neg_lo:[1,0,0]
    v_cvt_pk_bf16_f32 v65, v58, v59
    ds_write_addtid_b32 v65 offset:816
    v_mfma_f32_32x32x16_bf16 v[144:159], v[104:107], v[108:111], v[144:159]
    v_pk_mul_f32 v[60:61], v[58:59], v[44:45] op_sel_hi:[1,0]
    v_pk_fma_f32 v[54:55], v[58:59], v[44:45], v[60:61] op_sel:[1,1,0] op_sel_hi:[0,1,1] neg_lo:[1,0,0]
    v_cvt_pk_bf16_f32 v66, v54, v55
    ds_write_addtid_b32 v66 offset:1088
    v_mfma_f32_32x32x16_bf16 v[144:159], v[112:115], v[116:119], v[144:159]
    v_pk_mul_f32 v[60:61], v[54:55], v[44:45] op_sel_hi:[1,0]
    v_pk_fma_f32 v[58:59], v[54:55], v[44:45], v[60:61] op_sel:[1,1,0] op_sel_hi:[0,1,1] neg_lo:[1,0,0]
    v_cvt_pk_bf16_f32 v67, v58, v59
    ds_write_addtid_b32 v67 offset:1360
    v_mfma_f32_32x32x16_bf16 v[144:159], v[120:123], v[124:127], v[144:159]
    v_pk_mul_f32 v[60:61], v[58:59], v[44:45] op_sel_hi:[1,0]
    v_pk_fma_f32 v[56:57], v[58:59], v[44:45], v[60:61] op_sel:[1,1,0] op_sel_hi:[0,1,1] neg_lo:[1,0,0]
    v_cvt_pk_bf16_f32 v64, v56, v57
    ds_write_addtid_b32 v64 offset:1632
    v_mfma_f32_32x32x16_bf16 v[144:159], v[128:131], v[132:135], v[144:159]
    v_pk_mul_f32 v[60:61], v[56:57], v[44:45] op_sel_hi:[1,0]
    v_pk_fma_f32 v[58:59], v[56:57], v[44:45], v[60:61] op_sel:[1,1,0] op_sel_hi:[0,1,1] neg_lo:[1,0,0]
    v_cvt_pk_bf16_f32 v65, v58, v59
    ds_write_addtid_b32 v65 offset:1904
    v_mfma_f32_32x32x16_bf16 v[144:159], v[136:139], v[140:143], v[144:159]
    v_pk_mul_f32 v[60:61], v[50:51], v[48:49] op_sel_hi:[1,0]
    v_pk_fma_f32 v[50:51], v[50:51], v[48:49], v[60:61] op_sel:[1,1,0] op_sel_hi:[0,1,1] neg_lo:[1,0,0]
    v_cvt_pk_bf16_f32 v66, v50, v51
    ds_write_addtid_b32 v66 offset:2176
    v_pk_mul_f32 v[60:61], v[52:53], v[48:49] op_sel_hi:[1,0]
    v_pk_fma_f32 v[52:53], v[52:53], v[48:49], v[60:61] op_sel:[1,1,0] op_sel_hi:[0,1,1] neg_lo:[1,0,0]
    v_cvt_pk_bf16_f32 v67, v52, v53
    ds_write_addtid_b32 v67 offset:2448
    v_pk_mul_f32 v[60:61], v[54:55], v[48:49] op_sel_hi:[1,0]
    v_pk_fma_f32 v[54:55], v[54:55], v[48:49], v[60:61] op_sel:[1,1,0] op_sel_hi:[0,1,1] neg_lo:[1,0,0]
    v_cvt_pk_bf16_f32 v64, v54, v55
    ds_write_addtid_b32 v64 offset:2720
    v_pk_mul_f32 v[60:61], v[56:57], v[48:49] op_sel_hi:[1,0]
    v_pk_fma_f32 v[56:57], v[56:57], v[48:49], v[60:61] op_sel:[1,1,0] op_sel_hi:[0,1,1] neg_lo:[1,0,0]
    v_cvt_pk_bf16_f32 v65, v56, v57
    ds_write_addtid_b32 v65 offset:2992
    v_pk_mul_f32 v[60:61], v[50:51], v[48:49] op_sel_hi:[1,0]
    v_pk_fma_f32 v[50:51], v[50:51], v[48:49], v[60:61] op_sel:[1,1,0] op_sel_hi:[0,1,1] neg_lo:[1,0,0]
    v_cvt_pk_bf16_f32 v66, v50, v51
    ds_write_addtid_b32 v66 offset:3264
    v_pk_mul_f32 v[60:61], v[54:55], v[48:49] op_sel_hi:[1,0]
    v_pk_fma_f32 v[54:55], v[54:55], v[48:49], v[60:61] op_sel:[1,1,0] op_sel_hi:[0,1,1] neg_lo:[1,0,0]
    v_cvt_pk_bf16_f32 v67, v54, v55
    ds_write_addtid_b32 v67 offset:3536
    v_pk_mul_f32 v[60:61], v[50:51], v[48:49] op_sel_hi:[1,0]
    v_pk_fma_f32 v[50:51], v[50:51], v[48:49], v[60:61] op_sel:[1,1,0] op_sel_hi:[0,1,1] neg_lo:[1,0,0]
    v_cvt_pk_bf16_f32 v64, v50, v51
    ds_write_addtid_b32 v64 offset:3808
    v_pk_mul_f32 v[60:61], v[54:55], v[48:49] op_sel_hi:[1,0]
    v_pk_fma_f32 v[54:55], v[54:55], v[48:49], v[60:61] op_sel:[1,1,0] op_sel_hi:[0,1,1] neg_lo:[1,0,0]
    v_cvt_pk_bf16_f32 v65, v54, v55
    ds_write_addtid_b32 v65 offset:4080
    v_pk_mul_f32 v[60:61], v[50:51], v[48:49] op_sel_hi:[1,0]
    v_pk_fma_f32 v[50:51], v[50:51], v[48:49], v[60:61] op_sel:[1,1,0] op_sel_hi:[0,1,1] neg_lo:[1,0,0]
    v_cvt_pk_bf16_f32 v66, v50, v51
    ds_write_addtid_b32 v66 offset:4352
    v_pk_mul_f32 v[60:61], v[50:51], v[48:49] op_sel_hi:[1,0]
    v_pk_fma_f32 v[50:51], v[50:51], v[48:49], v[60:61] op_sel:[1,1,0] op_sel_hi:[0,1,1] neg_lo:[1,0,0]
    v_cvt_pk_bf16_f32 v67, v50, v51
    ds_write_addtid_b32 v67 offset:4624
    v_pk_mul_f32 v[60:61], v[50:51], v[48:49] op_sel_hi:[1,0]
    v_pk_fma_f32 v[50:51], v[50:51], v[48:49], v[60:61] op_sel:[1,1,0] op_sel_hi:[0,1,1] neg_lo:[1,0,0]
    v_cvt_pk_bf16_f32 v64, v50, v51
    ds_write_addtid_b32 v64 offset:4896
    v_pk_mul_f32 v[60:61], v[50:51], v[48:49] op_sel_hi:[1,0]
    v_pk_fma_f32 v[50:51], v[50:51], v[48:49], v[60:61] op_sel:[1,1,0] op_sel_hi:[0,1,1] neg_lo:[1,0,0]
    v_cvt_pk_bf16_f32 v65, v50, v51
    ds_write_addtid_b32 v65 offset:5168
    v_pk_mul_f32 v[60:61], v[50:51], v[48:49] op_sel_hi:[1,0]
    v_pk_fma_f32 v[50:51], v[50:51], v[48:49], v[60:61] op_sel:[1,1,0] op_sel_hi:[0,1,1] neg_lo:[1,0,0]
    v_cvt_pk_bf16_f32 v66, v50, v51
    ds_write_addtid_b32 v66 offset:5440
    s_mov_b32 s56, 0x100000
LA_s3:
    ds_read_b32 v62, v4
    s_waitcnt lgkmcnt(0)
    v_cmp_gt_u32 vcc, 2, v62
    s_cbranch_vccz LA_s3d
    s_sub_u32 s56, s56, 1
    s_cmp_lg_u32 s56, 0
    s_cbranch_scc1 LA_s3
LA_s3d:
    ds_read_b128 v[80:83], v7 offset:0
    ds_read_b128 v[84:87], v7 offset:5712
    ds_read_b128 v[88:91], v7 offset:32
    ds_read_b128 v[92:95], v7 offset:5744
    ds_read_b128 v[96:99], v7 offset:64
    ds_read_b128 v[100:103], v7 offset:5776
    ds_read_b128 v[104:107], v7 offset:96
    ds_read_b128 v[108:111], v7 offset:5808
    ds_read_b128 v[112:115], v7 offset:128
    ds_read_b128 v[116:119], v7 offset:5840
    ds_read_b128 v[120:123], v7 offset:160
    ds_read_b128 v[124:127], v7 offset:5872
    ds_read_b128 v[128:131], v7 offset:192
    ds_read_b128 v[132:135], v7 offset:5904
    ds_read_b128 v[136:139], v7 offset:224
    ds_read_b128 v[140:143], v7 offset:5936
    s_mov_b32 m0, s68
    s_waitcnt vmcnt(0)
    v_mul_f32 v68, v22, v77
    v_mul_f32 v69, v23, v78
    v_mul_f32 v24, v24, v76
    v_mul_f32 v25, v25, v76
    v_exp_f32 v70, v68
    v_fract_f32 v71, v69
    v_cos_f32 v72, v71
    v_sin_f32 v73, v71
    s_nop 0
    v_pk_mul_f32 v[44:45], v[72:73], v[70:71] op_sel_hi:[1,0]
    v_pk_mul_f32 v[60:61], v[26:27], v[24:25] op_sel_hi:[1,0]
    v_pk_fma_f32 v[50:51], v[26:27], v[24:25], v[60:61] op_sel:[1,1,0] op_sel_hi:[0,1,1] neg_lo:[1,0,0]
    v_mul_f32 v70, 0x43800000, v68
    v_mul_f32 v71, 0x43800000, v69
    v_exp_f32 v70, v70
    v_fract_f32 v71, v71
    v_cos_f32 v72, v71
    v_sin_f32 v73, v71
    s_nop 0
    v_pk_mul_f32 v[48:49], v[72:73], v[70:71] op_sel_hi:[1,0]
    v_mov_b32 v62, 2
    s_waitcnt lgkmcnt(0)
    ds_write_b32 v5, v62
    v_cvt_pk_bf16_f32 v67, v50, v51
    ds_write_addtid_b32 v67 offset:0
    v_mfma_f32_32x32x16_bf16 v[144:159], v[80:83], v[84:87], v[144:159]
    v_pk_mul_f32 v[60:61], v[50:51], v[44:45] op_sel_hi:[1,0]
    v_pk_fma_f32 v[58:59], v[50:51], v[44:45], v[60:61] op_sel:[1,1,0] op_sel_hi:[0,1,1] neg_lo:[1,0,0]
    v_cvt_pk_bf16_f32 v64, v58, v59
    ds_write_addtid_b32 v64 offset:272
    v_mfma_f32_32x32x16_bf16 v[144:159], v[88:91], v[92:95], v[144:159]
    v_pk_mul_f32 v[60:61], v[58:59], v[44:45] op_sel_hi:[1,0]
    v_pk_fma_f32 v[52:53], v[58:59], v[44:45], v[60:61] op_sel:[1,1,0] op_sel_hi:[0,1,1] neg_lo:[1,0,0]
    v_cvt_pk_bf16_f32 v65, v52, v53
    ds_write_addtid_b32 v65 offset:544
    v_mfma_f32_32x32x16_bf16 v[144:159], v[96:99], v[100:103], v[144:159]
    v_pk_mul_f32 v[60:61], v[52:53], v[44:45] op_sel_hi:[1,0]
    v_pk_fma_f32 v[58:59], v[52:53], v[44:45], v[60:61] op_sel:[1,1,0] op_sel_hi:[0,1,1] neg_lo:[1,0,0]
    v_cvt_pk_bf16_f32 v66, v58, v59
    ds_write_addtid_b32 v66 offset:816
    v_mfma_f32_32x32x16_bf16 v[144:159], v[104:107], v[108:111], v[144:159]
    v_pk_mul_f32 v[60:61], v[58:59], v[44:45] op_sel_hi:[1,0]
    v_pk_fma_f32 v[54:55], v[58:59], v[44:45], v[60:61] op_sel:[1,1,0] op_sel_hi:[0,1,1] neg_lo:[1,0,0]
    v_cvt_pk_bf16_f32 v67, v54, v55
    ds_write_addtid_b32 v67 offset:1088
    v_mfma_f32_32x32x16_bf16 v[144:159], v[112:115], v[116:119], v[144:159]
    v_pk_mul_f32 v[60:61], v[54:55], v[44:45] op_sel_hi:[1,0]
    v_pk_fma_f32 v[58:59], v[54:55], v[44:45], v[60:61] op_sel:[1,1,0] op_sel_hi:[0,1,1] neg_lo:[1,0,0]
    v_cvt_pk_bf16_f32 v64, v58, v59
    ds_write_addtid_b32 v64 offset:1360
    v_mfma_f32_32x32x16_bf16 v[144:159], v[120:123], v[124:127], v[144:159]
    v_pk_mul_f32 v[60:61], v[58:59], v[44:45] op_sel_hi:[1,0]
    v_pk_fma_f32 v[56:57], v[58:59], v[44:45], v[60:61] op_sel:[1,1,0] op_sel_hi:[0,1,1] neg_lo:[1,0,0]
    v_cvt_pk_bf16_f32 v65, v56, v57
    ds_write_addtid_b32 v65 offset:1632
    v_mfma_f32_32x32x16_bf16 v[144:159], v[128:131], v[132:135], v[144:159]
    v_pk_mul_f32 v[60:61], v[56:57], v[44:45] op_sel_hi:[1,0]
    v_pk_fma_f32 v[58:59], v[56:57], v[44:45], v[60:61] op_sel:[1,1,0] op_sel_hi:[0,1,1] neg_lo:[1,0,0]
    v_cvt_pk_bf16_f32 v66, v58, v59
    ds_write_addtid_b32 v66 offset:1904
    v_mfma_f32_32x32x16_bf16 v[144:159], v[136:139], v[140:143], v[144:159]
    v_pk_mul_f32 v[60:61], v[50:51], v[48:49] op_sel_hi:[1,0]
    v_pk_fma_f32 v[50:51], v[50:51], v[48:49], v[60:61] op_sel:[1,1,0] op_sel_hi:[0,1,1] neg_lo:[1,0,0]
    v_cvt_pk_bf16_f32 v67, v50, v51
    ds_write_addtid_b32 v67 offset:2176
    v_pk_mul_f32 v[60:61], v[52:53], v[48:49] op_sel_hi:[1,0]
    v_pk_fma_f32 v[52:53], v[52:53], v[48:49], v[60:61] op_sel:[1,1,0] op_sel_hi:[0,1,1] neg_lo:[1,0,0]
    v_cvt_pk_bf16_f32 v64, v52, v53
    ds_write_addtid_b32 v64 offset:2448
    v_pk_mul_f32 v[60:61], v[54:55], v[48:49] op_sel_hi:[1,0]
    v_pk_fma_f32 v[54:55], v[54:55], v[48:49], v[60:61] op_sel:[1,1,0] op_sel_hi:[0,1,1] neg_lo:[1,0,0]
    v_cvt_pk_bf16_f32 v65, v54, v55
    ds_write_addtid_b32 v65 offset:2720
    v_pk_mul_f32 v[60:61], v[56:57], v[48:49] op_sel_hi:[1,0]
    v_pk_fma_f32 v[56:57], v[56:57], v[48:49], v[60:61] op_sel:[1,1,0] op_sel_hi:[0,1,1] neg_lo:[1,0,0]
    v_cvt_pk_bf16_f32 v66, v56, v57
    ds_write_addtid_b32 v66 offset:2992
    v_pk_mul_f32 v[60:61], v[50:51], v[48:49] op_sel_hi:[1,0]
    v_pk_fma_f32 v[50:51], v[50:51], v[48:49], v[60:61] op_sel:[1,1,0] op_sel_hi:[0,1,1] neg_lo:[1,0,0]
    v_cvt_pk_bf16_f32 v67, v50, v51
    ds_write_addtid_b32 v67 offset:3264
    v_pk_mul_f32 v[60:61], v[54:55], v[48:49] op_sel_hi:[1,0]
    v_pk_fma_f32 v[54:55], v[54:55], v[48:49], v[60:61] op_sel:[1,1,0] op_sel_hi:[0,1,1] neg_lo:[1,0,0]
    v_cvt_pk_bf16_f32 v64, v54, v55
    ds_write_addtid_b32 v64 offset:3536
    v_pk_mul_f32 v[60:61], v[50:51], v[48:49] op_sel_hi:[1,0]
    v_pk_fma_f32 v[50:51], v[50:51], v[48:49], v[60:61] op_sel:[1,1,0] op_sel_hi:[0,1,1] neg_lo:[1,0,0]
    v_cvt_pk_bf16_f32 v65, v50, v51
    ds_write_addtid_b32 v65 offset:3808
    v_pk_mul_f32 v[60:61], v[54:55], v[48:49] op_sel_hi:[1,0]
    v_pk_fma_f32 v[54:55], v[54:55], v[48:49], v[60:61] op_sel:[1,1,0] op_sel_hi:[0,1,1] neg_lo:[1,0,0]
    v_cvt_pk_bf16_f32 v66, v54, v55
    ds_write_addtid_b32 v66 offset:4080
    v_pk_mul_f32 v[60:61], v[50:51], v[48:49] op_sel_hi:[1,0]
    v_pk_fma_f32 v[50:51], v[50:51], v[48:49], v[60:61] op_sel:[1,1,0] op_sel_hi:[0,1,1] neg_lo:[1,0,0]
    v_cvt_pk_bf16_f32 v67, v50, v51
    ds_write_addtid_b32 v67 offset:4352
    v_pk_mul_f32 v[60:61], v[50:51], v[48:49] op_sel_hi:[1,0]
    v_pk_fma_f32 v[50:51], v[50:51], v[48:49], v[60:61] op_sel:[1,1,0] op_sel_hi:[0,1,1] neg_lo:[1,0,0]
    v_cvt_pk_bf16_f32 v64, v50, v51
    ds_write_addtid_b32 v64 offset:4624
    v_pk_mul_f32 v[60:61], v[50:51], v[48:49] op_sel_hi:[1,0]
    v_pk_fma_f32 v[50:51], v[50:51], v[48:49], v[60:61] op_sel:[1,1,0] op_sel_hi:[0,1,1] neg_lo:[1,0,0]
    v_cvt_pk_bf16_f32 v65, v50, v51
    ds_write_addtid_b32 v65 offset:4896
    v_pk_mul_f32 v[60:61], v[50:51], v[48:49] op_sel_hi:[1,0]
    v_pk_fma_f32 v[50:51], v[50:51], v[48:49], v[60:61] op_sel:[1,1,0] op_sel_hi:[0,1,1] neg_lo:[1,0,0]
    v_cvt_pk_bf16_f32 v66, v50, v51
    ds_write_addtid_b32 v66 offset:5168
    v_pk_mul_f32 v[60:61], v[50:51], v[48:49] op_sel_hi:[1,0]
    v_pk_fma_f32 v[50:51], v[50:51], v[48:49], v[60:61] op_sel:[1,1,0] op_sel_hi:[0,1,1] neg_lo:[1,0,0]
    v_cvt_pk_bf16_f32 v67, v50, v51
    ds_write_addtid_b32 v67 offset:5440
    s_mov_b32 s56, 0x100000
LA_s4:
    ds_read_b32 v62, v4
    s_waitcnt lgkmcnt(0)
    v_cmp_gt_u32 vcc, 3, v62
    s_cbranch_vccz LA_s4d
    s_sub_u32 s56, s56, 1
    s_cmp_lg_u32 s56, 0
    s_cbranch_scc1 LA_s4
LA_s4d:
    ds_read_b128 v[80:83], v6 offset:0
    ds_read_b128 v[84:87], v6 offset:5712
    ds_read_b128 v[88:91], v6 offset:32
    ds_read_b128 v[92:95], v6 offset:5744
    ds_read_b128 v[96:99], v6 offset:64
    ds_read_b128 v[100:103], v6 offset:5776
    ds_read_b128 v[104:107], v6 offset:96
    ds_read_b128 v[108:111], v6 offset:5808
    ds_read_b128 v[112:115], v6 offset:128
    ds_read_b128 v[116:119], v6 offset:5840
    ds_read_b128 v[120:123], v6 offset:160
    ds_read_b128 v[124:127], v6 offset:5872
    ds_read_b128 v[128:131], v6 offset:192
    ds_read_b128 v[132:135], v6 offset:5904
    ds_read_b128 v[136:139], v6 offset:224
    ds_read_b128 v[140:143], v6 offset:5936
    ds_read_b128 v[40:43], v8
    v_mov_b32 v44, 0
    v_mov_b32 v45, 0
    v_mov_b32 v46, 0
    v_mov_b32 v47, 0
    s_waitcnt lgkmcnt(15)
    v_mfma_f32_32x32x16_bf16 v[144:159], v[80:83], v[84:87], v[144:159]
    s_waitcnt lgkmcnt(13)
    v_mfma_f32_32x32x16_bf16 v[144:159], v[88:91], v[92:95], v[144:159]
    s_waitcnt lgkmcnt(11)
    v_mfma_f32_32x32x16_bf16 v[144:159], v[96:99], v[100:103], v[144:159]
    s_waitcnt lgkmcnt(9)
    v_mfma_f32_32x32x16_bf16 v[144:159], v[104:107], v[108:111], v[144:159]
    s_waitcnt lgkmcnt(7)
    v_mfma_f32_32x32x16_bf16 v[144:159], v[112:115], v[116:119], v[144:159]
    s_waitcnt lgkmcnt(5)
    v_mfma_f32_32x32x16_bf16 v[144:159], v[120:123], v[124:127], v[144:159]
    s_waitcnt lgkmcnt(3)
    v_mfma_f32_32x32x16_bf16 v[144:159], v[128:131], v[132:135], v[144:159]
    s_waitcnt lgkmcnt(1)
    v_mfma_f32_32x32x16_bf16 v[144:159], v[136:139], v[140:143], v[144:159]
    s_waitcnt lgkmcnt(0)
    v_min_u32 v40, v40, v41
    v_min3_u32 v40, v40, v42, v43
    v_cmp_gt_u32 vcc, 2, v40
    s_cbranch_vccz LA_pgo
    s_mov_b32 s56, 0x100000
LA_s5:
    ds_read_b128 v[40:43], v8
    s_waitcnt lgkmcnt(0)
    v_min_u32 v40, v40, v41
    v_min3_u32 v40, v40, v42, v43
    v_cmp_gt_u32 vcc, 2, v40
    s_cbranch_vccz LA_s5d
    s_sub_u32 s56, s56, 1
    s_cmp_lg_u32 s56, 0
    s_cbranch_scc1 LA_s5
LA_s5d:
LA_pgo:
    ds_write_b128 v36, v[44:47] offset:4096
    ds_write_b128 v28, v[144:147]
    ds_write_b64 v29, v[148:149]
    ds_write_b64 v30, v[150:151]
    ds_write_b32 v31, v152 offset:2048
    ds_write_b32 v31, v153 offset:2176
    ds_write_b32 v31, v154 offset:2304
    ds_write_b32 v31, v155 offset:2432
    ds_read_b128 v[80:83], v32
    ds_read_b128 v[84:87], v32 offset:16
    ds_read_b32 v88, v32 offset:32
    ds_read_b64 v[90:91], v33 offset:1536
    ds_read_b32 v92, v33 offset:1544
    v_min_u32 v34, 39, v1
    v_lshlrev_b32 v39, 2, v34
    v_lshlrev_b32 v34, 4, v34
    v_sub_u32 v34, s68, v34
    v_add_u32 v34, 2548, v34
    v_add_u32 v39, s68, v39
    v_mov_b32 v38, s68
    ds_read2_b32 v[94:95], v34 offset0:0 offset1:1
    ds_read2_b32 v[96:97], v34 offset0:2 offset1:3
    ds_read2_b32 v[98:99], v34 offset0:4 offset1:5
    ds_read_b32 v89, v38 offset:2048
    v_cmp_gt_u32 vcc, 33, v1
    v_cmp_eq_u32 s[72:73], 0, v1
    v_mov_b32 v0, v160
    v_mov_b32 v1, v161
    v_mov_b32 v2, v162
    v_mov_b32 v3, v163
    v_mov_b32 v4, v164
    v_mov_b32 v5, v165
    v_mov_b32 v6, v166
    v_mov_b32 v7, v35
    v_mov_b32 v120, s70
    s_waitcnt lgkmcnt(6)
    s_mov_b64 exec, 1
    v_add_f32 v80, s76, v80
    s_mov_b64 exec, -1
    v_cndmask_b32 v118, v84, v88, s[74:75]
    v_cndmask_b32 v117, v84, v87, s[74:75]
    v_cndmask_b32 v116, v83, v86, s[74:75]
    v_cndmask_b32 v115, v82, v85, s[74:75]
    v_cndmask_b32 v114, v82, v84, s[74:75]
    v_cndmask_b32 v113, v82, v83, s[74:75]
    v_cndmask_b32 v112, v81, v82, s[74:75]
    v_cndmask_b32 v111, v80, v81, s[74:75]
    v_cvt_pk_bf16_f32 v100, v117, v116
    v_cvt_pk_bf16_f32 v101, v115, v114
    v_cvt_pk_bf16_f32 v102, v113, v112
    v_cvt_pk_bf16_f32 v103, v111, v80
    v_cvt_pk_bf16_f32 v104, v118, v117
    v_cvt_pk_bf16_f32 v105, v116, v115
    v_cvt_pk_bf16_f32 v106, v114, v113
    v_cvt_pk_bf16_f32 v107, v112, v111
    ds_write_b128 v7, v[100:103] offset:3072
    ds_write_b128 v7, v[104:107] offset:7232
    v_cvt_pk_bf16_f32 v119, v80, 0
    s_mov_b64 exec, 1
    ds_write_b32 v120, v119 offset:8256
    s_mov_b64 exec, -1
    s_waitcnt lgkmcnt(7)
    v_cvt_pk_bf16_f32 v124, v92, v92
    v_cvt_pk_bf16_f32 v125, v91, v91
    v_cvt_pk_bf16_f32 v126, v91, v90
    v_cvt_pk_bf16_f32 v127, v90, v90
    v_cvt_pk_bf16_f32 v128, v92, v92
    v_cvt_pk_bf16_f32 v129, v92, v91
    v_cvt_pk_bf16_f32 v130, v91, v91
    v_cvt_pk_bf16_f32 v131, v90, v90
    ds_write_b128 v7, v[124:127] offset:2048
    ds_write_b128 v7, v[128:131] offset:6208
    s_waitcnt lgkmcnt(5)
    v_cndmask_b32 v121, 0, v89, s[72:73]
    v_cvt_pk_bf16_f32 v100, 0, 0
    v_cvt_pk_bf16_f32 v101, 0, v121
    v_cvt_pk_bf16_f32 v102, v121, v121
    v_cvt_pk_bf16_f32 v103, v121, v121
    v_cvt_pk_bf16_f32 v104, 0, 0
    v_cvt_pk_bf16_f32 v105, 0, 0
    v_cvt_pk_bf16_f32 v106, v121, v121
    v_cvt_pk_bf16_f32 v107, v121, v121
    ds_write_b128 v7, v[100:103] offset:1024
    ds_write_b128 v7, v[104:107] offset:5184
    v_cndmask_b32 v94, 0, v94, s[74:75]
    v_cndmask_b32 v95, 0, v95, s[74:75]
    v_cndmask_b32 v96, 0, v96, s[74:75]
    v_cndmask_b32 v97, 0, v97, s[74:75]
    v_cndmask_b32 v98, 0, v98, vcc
    v_cndmask_b32 v99, 0, v99, vcc
    v_cvt_pk_bf16_f32 v112, v96, v94
    v_cvt_pk_bf16_f32 v113, v98, v96
    ds_write_b32 v39, v112 offset:3328
    ds_write_b32 v39, v113 offset:3520
    v_cvt_pk_bf16_f32 v114, v97, v95
    v_cvt_pk_bf16_f32 v115, v99, v97
    ds_write_b32 v39, v114 offset:3712
    ds_write_b32 v39, v115 offset:3904
    v_mov_b32 v3, v167
    v_mov_b32 v7, v79
    ds_read2_b32 v[8:9], v0 offset0:128 offset1:129
    ds_read2_b32 v[10:11], v0 offset0:130 offset1:131
    ds_read2_b32 v[12:13], v0 offset0:0 offset1:1
    ds_read2_b32 v[14:15], v0 offset0:2 offset1:3
    ds_read2_b32 v[16:17], v1 offset0:128 offset1:129
    ds_read2_b32 v[18:19], v1 offset0:130 offset1:131
    ds_read2_b32 v[20:21], v1 offset0:0 offset1:1
    ds_read2_b32 v[22:23], v1 offset0:2 offset1:3
    ds_read_b128 v[88:91], v7 offset:0
    ds_read_b128 v[92:95], v7 offset:1024
    ds_read_b128 v[96:99], v7 offset:2048
    s_barrier
    ds_read_b128 v[56:59], v4 offset:384
    ds_read_b128 v[72:75], v4 offset:448
    ds_read_b128 v[60:63], v4 offset:896
    ds_read_b128 v[76:79], v4 offset:960
    ds_read_b128 v[64:67], v4 offset:1408
    ds_read_b128 v[80:83], v4 offset:1472
    ds_read_b128 v[68:71], v4 offset:1920
    ds_read_b128 v[84:87], v4 offset:1984
    ds_read_b128 v[136:139], v5 offset:0
    ds_read_b128 v[24:27], v4 offset:0
    ds_read_b128 v[140:143], v5 offset:512
    ds_read_b128 v[28:31], v4 offset:512
    ds_read_b128 v[144:147], v5 offset:1024
    ds_read_b128 v[32:35], v4 offset:1024
    ds_read_b128 v[148:151], v5 offset:1536
    ds_read_b128 v[36:39], v4 offset:1536
    ds_read_b128 v[152:155], v5 offset:2048
    ds_read_b128 v[40:43], v4 offset:2048
    ds_read_b128 v[156:159], v5 offset:2560
    ds_read_b128 v[44:47], v4 offset:2560
    ds_read_b128 v[160:163], v5 offset:3072
    ds_read_b128 v[48:51], v4 offset:3072
    ds_read_b128 v[164:167], v5 offset:3584
    ds_read_b128 v[52:55], v4 offset:3584
    s_waitcnt lgkmcnt(15)
    v_mfma_f32_16x16x32_bf16 v[104:107], v[56:59], v[92:95], 0
    v_mfma_f32_16x16x32_bf16 v[108:111], v[60:63], v[92:95], 0
    v_mfma_f32_16x16x32_bf16 v[112:115], v[64:67], v[92:95], 0
    v_mfma_f32_16x16x32_bf16 v[116:119], v[68:71], v[92:95], 0
    v_mfma_f32_16x16x32_bf16 v[120:123], v[72:75], v[96:99], 0
    v_mfma_f32_16x16x32_bf16 v[124:127], v[76:79], v[96:99], 0
    v_mfma_f32_16x16x32_bf16 v[128:131], v[80:83], v[96:99], 0
    v_mfma_f32_16x16x32_bf16 v[132:135], v[84:87], v[96:99], 0
    v_mfma_f32_16x16x32_bf16 v[104:107], v[72:75], v[88:91], v[104:107]
    v_mfma_f32_16x16x32_bf16 v[108:111], v[76:79], v[88:91], v[108:111]
    v_mfma_f32_16x16x32_bf16 v[112:115], v[80:83], v[88:91], v[112:115]
    v_mfma_f32_16x16x32_bf16 v[116:119], v[84:87], v[88:91], v[116:119]
    s_waitcnt lgkmcnt(14)
    v_mfma_f32_16x16x32_bf16 v[136:139], v[8:11], v[24:27], v[136:139]
    s_waitcnt lgkmcnt(12)
    v_mfma_f32_16x16x32_bf16 v[140:143], v[12:15], v[24:27], v[140:143]
    v_mfma_f32_16x16x32_bf16 v[140:143], v[8:11], v[28:31], v[140:143]
    s_waitcnt lgkmcnt(10)
    v_mfma_f32_16x16x32_bf16 v[144:147], v[16:19], v[24:27], v[144:147]
    v_mfma_f32_16x16x32_bf16 v[144:147], v[12:15], v[28:31], v[144:147]
    ds_read2_b32 v[56:57], v0 offset0:144 offset1:145
    v_mfma_f32_16x16x32_bf16 v[144:147], v[8:11], v[32:35], v[144:147]
    ds_read2_b32 v[58:59], v0 offset0:146 offset1:147
    s_waitcnt lgkmcnt(10)
    v_mfma_f32_16x16x32_bf16 v[148:151], v[20:23], v[24:27], v[148:151]
    ds_read_b128 v[72:75], v4 offset:64
    v_mfma_f32_16x16x32_bf16 v[148:151], v[16:19], v[28:31], v[148:151]
    ds_read2_b32 v[60:61], v0 offset0:16 offset1:17
    v_mfma_f32_16x16x32_bf16 v[148:151], v[12:15], v[32:35], v[148:151]
    ds_read2_b32 v[62:63], v0 offset0:18 offset1:19
    v_mfma_f32_16x16x32_bf16 v[148:151], v[8:11], v[36:39], v[148:151]
    ds_read_b128 v[76:79], v4 offset:576
    s_waitcnt lgkmcnt(12)
    v_mfma_f32_16x16x32_bf16 v[152:155], v[20:23], v[28:31], v[152:155]
    ds_read2_b32 v[64:65], v1 offset0:144 offset1:145
    v_mfma_f32_16x16x32_bf16 v[152:155], v[16:19], v[32:35], v[152:155]
    ds_read2_b32 v[66:67], v1 offset0:146 offset1:147
    v_mfma_f32_16x16x32_bf16 v[152:155], v[12:15], v[36:39], v[152:155]
    v_mfma_f32_16x16x32_bf16 v[152:155], v[8:11], v[40:43], v[152:155]
    ds_read_b128 v[80:83], v4 offset:1088
    s_waitcnt lgkmcnt(13)
    v_mfma_f32_16x16x32_bf16 v[156:159], v[20:23], v[32:35], v[156:159]
    ds_read2_b32 v[68:69], v1 offset0:16 offset1:17
    v_mfma_f32_16x16x32_bf16 v[156:159], v[16:19], v[36:39], v[156:159]
    ds_read2_b32 v[70:71], v1 offset0:18 offset1:19
    v_mfma_f32_16x16x32_bf16 v[156:159], v[12:15], v[40:43], v[156:159]
    ds_read_b128 v[84:87], v4 offset:1600
    v_mfma_f32_16x16x32_bf16 v[156:159], v[8:11], v[44:47], v[156:159]
    ds_read_b128 v[88:91], v4 offset:2112
    s_waitcnt lgkmcnt(15)
    v_mfma_f32_16x16x32_bf16 v[160:163], v[20:23], v[36:39], v[160:163]
    ds_read_b128 v[92:95], v4 offset:2624
    v_mfma_f32_16x16x32_bf16 v[160:163], v[16:19], v[40:43], v[160:163]
    ds_read_b128 v[96:99], v4 offset:3136
    v_mfma_f32_16x16x32_bf16 v[160:163], v[12:15], v[44:47], v[160:163]
    ds_read_b128 v[100:103], v4 offset:3648
    v_mfma_f32_16x16x32_bf16 v[160:163], v[8:11], v[48:51], v[160:163]
    s_waitcnt lgkmcnt(15)
    v_mfma_f32_16x16x32_bf16 v[164:167], v[20:23], v[40:43], v[164:167]
    v_mfma_f32_16x16x32_bf16 v[164:167], v[16:19], v[44:47], v[164:167]
    v_mfma_f32_16x16x32_bf16 v[164:167], v[12:15], v[48:51], v[164:167]
    v_mfma_f32_16x16x32_bf16 v[164:167], v[8:11], v[52:55], v[164:167]
    s_waitcnt lgkmcnt(0)
    v_mfma_f32_16x16x32_bf16 v[136:139], v[56:59], v[72:75], v[136:139]
    ds_read2_b32 v[8:9], v0 offset0:160 offset1:161
    v_mfma_f32_16x16x32_bf16 v[140:143], v[60:63], v[72:75], v[140:143]
    ds_read2_b32 v[10:11], v0 offset0:162 offset1:163
    v_mfma_f32_16x16x32_bf16 v[144:147], v[64:67], v[72:75], v[144:147]
    ds_read_b128 v[24:27], v4 offset:128
    v_cvt_pk_bf16_f32 v104, v104, v105
    v_mfma_f32_16x16x32_bf16 v[148:151], v[68:71], v[72:75], v[148:151]
    v_cvt_pk_bf16_f32 v105, v106, v107
    v_mfma_f32_16x16x32_bf16 v[140:143], v[56:59], v[76:79], v[140:143]
    ds_read2_b32 v[12:13], v0 offset0:32 offset1:33
    v_cvt_pk_bf16_f32 v106, v120, v121
    v_mfma_f32_16x16x32_bf16 v[144:147], v[60:63], v[76:79], v[144:147]
    ds_read2_b32 v[14:15], v0 offset0:34 offset1:35
    v_cvt_pk_bf16_f32 v107, v122, v123
    v_mfma_f32_16x16x32_bf16 v[148:151], v[64:67], v[76:79], v[148:151]
    ds_read_b128 v[28:31], v4 offset:640
    v_cvt_pk_bf16_f32 v108, v108, v109
    v_mfma_f32_16x16x32_bf16 v[152:155], v[68:71], v[76:79], v[152:155]
    v_cvt_pk_bf16_f32 v109, v110, v111
    v_mfma_f32_16x16x32_bf16 v[144:147], v[56:59], v[80:83], v[144:147]
    ds_read2_b32 v[16:17], v1 offset0:160 offset1:161
    v_cvt_pk_bf16_f32 v110, v124, v125
    v_mfma_f32_16x16x32_bf16 v[148:151], v[60:63], v[80:83], v[148:151]
    ds_read2_b32 v[18:19], v1 offset0:162 offset1:163
    v_cvt_pk_bf16_f32 v111, v126, v127
    v_mfma_f32_16x16x32_bf16 v[152:155], v[64:67], v[80:83], v[152:155]
    v_cvt_pk_bf16_f32 v112, v112, v113
    v_mfma_f32_16x16x32_bf16 v[156:159], v[68:71], v[80:83], v[156:159]
    ds_read_b128 v[32:35], v4 offset:1152
    v_cvt_pk_bf16_f32 v113, v114, v115
    v_mfma_f32_16x16x32_bf16 v[148:151], v[56:59], v[84:87], v[148:151]
    ds_read2_b32 v[20:21], v1 offset0:32 offset1:33
    v_cvt_pk_bf16_f32 v114, v128, v129
    v_mfma_f32_16x16x32_bf16 v[152:155], v[60:63], v[84:87], v[152:155]
    ds_read2_b32 v[22:23], v1 offset0:34 offset1:35
    v_cvt_pk_bf16_f32 v115, v130, v131
    v_mfma_f32_16x16x32_bf16 v[156:159], v[64:67], v[84:87], v[156:159]
    v_cvt_pk_bf16_f32 v116, v116, v117
    v_mfma_f32_16x16x32_bf16 v[160:163], v[68:71], v[84:87], v[160:163]
    ds_read_b128 v[36:39], v4 offset:1664
    v_cvt_pk_bf16_f32 v117, v118, v119
    v_mfma_f32_16x16x32_bf16 v[152:155], v[56:59], v[88:91], v[152:155]
    ds_read_b128 v[40:43], v4 offset:2176
    v_cvt_pk_bf16_f32 v118, v132, v133
    v_mfma_f32_16x16x32_bf16 v[156:159], v[60:63], v[88:91], v[156:159]
    ds_read_b128 v[44:47], v4 offset:2688
    v_cvt_pk_bf16_f32 v119, v134, v135
    v_mfma_f32_16x16x32_bf16 v[160:163], v[64:67], v[88:91], v[160:163]
    v_mfma_f32_16x16x32_bf16 v[164:167], v[68:71], v[88:91], v[164:167]
    ds_read_b128 v[48:51], v4 offset:3200
    v_mfma_f32_16x16x32_bf16 v[156:159], v[56:59], v[92:95], v[156:159]
    ds_read_b128 v[52:55], v4 offset:3712
    v_mfma_f32_16x16x32_bf16 v[160:163], v[60:63], v[92:95], v[160:163]
    v_mfma_f32_16x16x32_bf16 v[164:167], v[64:67], v[92:95], v[164:167]
    v_mfma_f32_16x16x32_bf16 v[160:163], v[56:59], v[96:99], v[160:163]
    v_mfma_f32_16x16x32_bf16 v[164:167], v[60:63], v[96:99], v[164:167]
    v_mfma_f32_16x16x32_bf16 v[164:167], v[56:59], v[100:103], v[164:167]
    s_waitcnt lgkmcnt(0)
    v_mfma_f32_16x16x32_bf16 v[136:139], v[8:11], v[24:27], v[136:139]
    ds_read2_b32 v[56:57], v0 offset0:176 offset1:177
    ds_read2_b32 v[58:59], v0 offset0:178 offset1:179
    v_mfma_f32_16x16x32_bf16 v[140:143], v[12:15], v[24:27], v[140:143]
    ds_read_b128 v[72:75], v4 offset:192
    v_mfma_f32_16x16x32_bf16 v[144:147], v[16:19], v[24:27], v[144:147]
    ds_read2_b32 v[60:61], v0 offset0:48 offset1:49
    v_mfma_f32_16x16x32_bf16 v[148:151], v[20:23], v[24:27], v[148:151]
    ds_read2_b32 v[62:63], v0 offset0:50 offset1:51
    v_mfma_f32_16x16x32_bf16 v[140:143], v[8:11], v[28:31], v[140:143]
    ds_read_b128 v[76:79], v4 offset:704
    v_mfma_f32_16x16x32_bf16 v[144:147], v[12:15], v[28:31], v[144:147]
    ds_read2_b32 v[64:65], v1 offset0:176 offset1:177
    v_mfma_f32_16x16x32_bf16 v[148:151], v[16:19], v[28:31], v[148:151]
    ds_read2_b32 v[66:67], v1 offset0:178 offset1:179
    v_mfma_f32_16x16x32_bf16 v[152:155], v[20:23], v[28:31], v[152:155]
    ds_read_b128 v[80:83], v4 offset:1216
    v_mfma_f32_16x16x32_bf16 v[144:147], v[8:11], v[32:35], v[144:147]
    ds_read2_b32 v[68:69], v1 offset0:48 offset1:49
    v_mfma_f32_16x16x32_bf16 v[148:151], v[12:15], v[32:35], v[148:151]
    ds_read2_b32 v[70:71], v1 offset0:50 offset1:51
    v_mfma_f32_16x16x32_bf16 v[152:155], v[16:19], v[32:35], v[152:155]
    ds_read_b128 v[84:87], v4 offset:1728
    v_mfma_f32_16x16x32_bf16 v[156:159], v[20:23], v[32:35], v[156:159]
    ds_read_b128 v[88:91], v4 offset:2240
    ds_read_b128 v[92:95], v4 offset:2752
    v_mfma_f32_16x16x32_bf16 v[148:151], v[8:11], v[36:39], v[148:151]
    ds_read_b128 v[96:99], v4 offset:3264
    v_mfma_f32_16x16x32_bf16 v[152:155], v[12:15], v[36:39], v[152:155]
    ds_read_b128 v[100:103], v4 offset:3776
    v_mfma_f32_16x16x32_bf16 v[156:159], v[16:19], v[36:39], v[156:159]
    ds_read2_b32 v[120:121], v3 offset0:120 offset1:121
    v_mfma_f32_16x16x32_bf16 v[160:163], v[20:23], v[36:39], v[160:163]
    ds_read2_b32 v[122:123], v3 offset0:24 offset1:25
    v_mfma_f32_16x16x32_bf16 v[152:155], v[8:11], v[40:43], v[152:155]
    ds_read2_b32 v[124:125], v3 offset0:112 offset1:113
    v_mfma_f32_16x16x32_bf16 v[156:159], v[12:15], v[40:43], v[156:159]
    ds_read2_b32 v[126:127], v3 offset0:16 offset1:17
    v_mfma_f32_16x16x32_bf16 v[160:163], v[16:19], v[40:43], v[160:163]
    ds_read2_b32 v[128:129], v3 offset0:104 offset1:105
    v_mfma_f32_16x16x32_bf16 v[164:167], v[20:23], v[40:43], v[164:167]
    ds_read2_b32 v[130:131], v3 offset0:8 offset1:9
    v_mfma_f32_16x16x32_bf16 v[156:159], v[8:11], v[44:47], v[156:159]
    ds_read2_b32 v[132:133], v3 offset0:96 offset1:97
    v_mfma_f32_16x16x32_bf16 v[160:163], v[12:15], v[44:47], v[160:163]
    ds_read2_b32 v[134:135], v3 offset0:0 offset1:1
    v_mfma_f32_16x16x32_bf16 v[164:167], v[16:19], v[44:47], v[164:167]
    v_mfma_f32_16x16x32_bf16 v[160:163], v[8:11], v[48:51], v[160:163]
    v_mfma_f32_16x16x32_bf16 v[164:167], v[12:15], v[48:51], v[164:167]
    v_mfma_f32_16x16x32_bf16 v[164:167], v[8:11], v[52:55], v[164:167]
    s_waitcnt lgkmcnt(0)
    v_mfma_f32_16x16x32_bf16 v[136:139], v[56:59], v[72:75], v[136:139]
    ds_read2_b32 v[8:9], v0 offset0:192 offset1:193
    v_mfma_f32_16x16x32_bf16 v[140:143], v[60:63], v[72:75], v[140:143]
    v_mfma_f32_16x16x32_bf16 v[144:147], v[64:67], v[72:75], v[144:147]
    ds_read2_b32 v[10:11], v0 offset0:194 offset1:195
    v_mfma_f32_16x16x32_bf16 v[148:151], v[68:71], v[72:75], v[148:151]
    v_mfma_f32_16x16x32_bf16 v[140:143], v[56:59], v[76:79], v[140:143]
    ds_read_b128 v[24:27], v4 offset:256
    v_mfma_f32_16x16x32_bf16 v[144:147], v[60:63], v[76:79], v[144:147]
    v_mfma_f32_16x16x32_bf16 v[148:151], v[64:67], v[76:79], v[148:151]
    ds_read2_b32 v[12:13], v0 offset0:64 offset1:65
    v_mfma_f32_16x16x32_bf16 v[152:155], v[68:71], v[76:79], v[152:155]
    v_mfma_f32_16x16x32_bf16 v[144:147], v[56:59], v[80:83], v[144:147]
    ds_read2_b32 v[14:15], v0 offset0:66 offset1:67
    v_mfma_f32_16x16x32_bf16 v[148:151], v[60:63], v[80:83], v[148:151]
    v_mfma_f32_16x16x32_bf16 v[152:155], v[64:67], v[80:83], v[152:155]
    ds_read_b128 v[28:31], v4 offset:768
    v_mfma_f32_16x16x32_bf16 v[156:159], v[68:71], v[80:83], v[156:159]
    v_mfma_f32_16x16x32_bf16 v[148:151], v[56:59], v[84:87], v[148:151]
    ds_read2_b32 v[16:17], v1 offset0:192 offset1:193
    v_mfma_f32_16x16x32_bf16 v[152:155], v[60:63], v[84:87], v[152:155]
    v_mfma_f32_16x16x32_bf16 v[156:159], v[64:67], v[84:87], v[156:159]
    ds_read2_b32 v[18:19], v1 offset0:194 offset1:195
    v_mfma_f32_16x16x32_bf16 v[160:163], v[68:71], v[84:87], v[160:163]
    v_mfma_f32_16x16x32_bf16 v[152:155], v[56:59], v[88:91], v[152:155]
    ds_read_b128 v[32:35], v4 offset:1280
    v_mfma_f32_16x16x32_bf16 v[156:159], v[60:63], v[88:91], v[156:159]
    v_mfma_f32_16x16x32_bf16 v[160:163], v[64:67], v[88:91], v[160:163]
    ds_read2_b32 v[20:21], v1 offset0:64 offset1:65
    v_mfma_f32_16x16x32_bf16 v[164:167], v[68:71], v[88:91], v[164:167]
    v_mfma_f32_16x16x32_bf16 v[156:159], v[56:59], v[92:95], v[156:159]
    ds_read2_b32 v[22:23], v1 offset0:66 offset1:67
    v_mfma_f32_16x16x32_bf16 v[160:163], v[60:63], v[92:95], v[160:163]
    v_mfma_f32_16x16x32_bf16 v[164:167], v[64:67], v[92:95], v[164:167]
    ds_read_b128 v[36:39], v4 offset:1792
    v_mfma_f32_16x16x32_bf16 v[160:163], v[56:59], v[96:99], v[160:163]
    v_mfma_f32_16x16x32_bf16 v[164:167], v[60:63], v[96:99], v[164:167]
    ds_read_b128 v[40:43], v4 offset:2304
    v_mfma_f32_16x16x32_bf16 v[164:167], v[56:59], v[100:103], v[164:167]
    v_mfma_f32_16x16x32_bf16 v[152:155], v[104:107], v[120:123], v[152:155]
    ds_read_b128 v[44:47], v4 offset:2816
    v_mfma_f32_16x16x32_bf16 v[156:159], v[104:107], v[124:127], v[156:159]
    v_mfma_f32_16x16x32_bf16 v[160:163], v[104:107], v[128:131], v[160:163]
    ds_read_b128 v[48:51], v4 offset:3328
    v_mfma_f32_16x16x32_bf16 v[164:167], v[104:107], v[132:135], v[164:167]
    v_mfma_f32_16x16x32_bf16 v[156:159], v[108:111], v[120:123], v[156:159]
    ds_read_b128 v[52:55], v4 offset:3840
    v_mfma_f32_16x16x32_bf16 v[160:163], v[108:111], v[124:127], v[160:163]
    v_mfma_f32_16x16x32_bf16 v[164:167], v[108:111], v[128:131], v[164:167]
    v_mfma_f32_16x16x32_bf16 v[160:163], v[112:115], v[120:123], v[160:163]
    v_mfma_f32_16x16x32_bf16 v[164:167], v[112:115], v[124:127], v[164:167]
    v_mfma_f32_16x16x32_bf16 v[164:167], v[116:119], v[120:123], v[164:167]
    s_waitcnt lgkmcnt(0)
    v_mfma_f32_16x16x32_bf16 v[136:139], v[8:11], v[24:27], v[136:139]
    ds_read2_b32 v[56:57], v0 offset0:208 offset1:209
    v_mfma_f32_16x16x32_bf16 v[140:143], v[12:15], v[24:27], v[140:143]
    ds_read2_b32 v[58:59], v0 offset0:210 offset1:211
    v_mfma_f32_16x16x32_bf16 v[144:147], v[16:19], v[24:27], v[144:147]
    ds_read_b128 v[72:75], v4 offset:320
    v_mfma_f32_16x16x32_bf16 v[148:151], v[20:23], v[24:27], v[148:151]
    v_mfma_f32_16x16x32_bf16 v[140:143], v[8:11], v[28:31], v[140:143]
    ds_read2_b32 v[60:61], v0 offset0:80 offset1:81
    v_mfma_f32_16x16x32_bf16 v[144:147], v[12:15], v[28:31], v[144:147]
    ds_read2_b32 v[62:63], v0 offset0:82 offset1:83
    v_mfma_f32_16x16x32_bf16 v[148:151], v[16:19], v[28:31], v[148:151]
    ds_read_b128 v[76:79], v4 offset:832
    v_mfma_f32_16x16x32_bf16 v[152:155], v[20:23], v[28:31], v[152:155]
    v_mfma_f32_16x16x32_bf16 v[144:147], v[8:11], v[32:35], v[144:147]
    ds_read2_b32 v[64:65], v1 offset0:208 offset1:209
    v_mfma_f32_16x16x32_bf16 v[148:151], v[12:15], v[32:35], v[148:151]
    ds_read2_b32 v[66:67], v1 offset0:210 offset1:211
    v_mfma_f32_16x16x32_bf16 v[152:155], v[16:19], v[32:35], v[152:155]
    v_mfma_f32_16x16x32_bf16 v[156:159], v[20:23], v[32:35], v[156:159]
    ds_read_b128 v[80:83], v4 offset:1344
    v_mfma_f32_16x16x32_bf16 v[148:151], v[8:11], v[36:39], v[148:151]
    ds_read2_b32 v[68:69], v1 offset0:80 offset1:81
    v_mfma_f32_16x16x32_bf16 v[152:155], v[12:15], v[36:39], v[152:155]
    ds_read2_b32 v[70:71], v1 offset0:82 offset1:83
    v_mfma_f32_16x16x32_bf16 v[156:159], v[16:19], v[36:39], v[156:159]
    v_mfma_f32_16x16x32_bf16 v[160:163], v[20:23], v[36:39], v[160:163]
    ds_read_b128 v[84:87], v4 offset:1856
    v_mfma_f32_16x16x32_bf16 v[152:155], v[8:11], v[40:43], v[152:155]
    ds_read_b128 v[88:91], v4 offset:2368
    v_mfma_f32_16x16x32_bf16 v[156:159], v[12:15], v[40:43], v[156:159]
    ds_read_b128 v[92:95], v4 offset:2880
    v_mfma_f32_16x16x32_bf16 v[160:163], v[16:19], v[40:43], v[160:163]
    v_mfma_f32_16x16x32_bf16 v[164:167], v[20:23], v[40:43], v[164:167]
    ds_read_b128 v[96:99], v4 offset:3392
    v_mfma_f32_16x16x32_bf16 v[156:159], v[8:11], v[44:47], v[156:159]
    ds_read_b128 v[100:103], v4 offset:3904
    v_mfma_f32_16x16x32_bf16 v[160:163], v[12:15], v[44:47], v[160:163]
    v_mfma_f32_16x16x32_bf16 v[164:167], v[16:19], v[44:47], v[164:167]
    v_mfma_f32_16x16x32_bf16 v[160:163], v[8:11], v[48:51], v[160:163]
    v_mfma_f32_16x16x32_bf16 v[164:167], v[12:15], v[48:51], v[164:167]
    v_mfma_f32_16x16x32_bf16 v[164:167], v[8:11], v[52:55], v[164:167]
    s_waitcnt lgkmcnt(0)
    v_mfma_f32_16x16x32_bf16 v[136:139], v[56:59], v[72:75], v[136:139]
    ds_read2_b32 v[8:9], v0 offset0:224 offset1:225
    v_mfma_f32_16x16x32_bf16 v[140:143], v[60:63], v[72:75], v[140:143]
    ds_read2_b32 v[10:11], v0 offset0:226 offset1:227
    v_mfma_f32_16x16x32_bf16 v[144:147], v[64:67], v[72:75], v[144:147]
    ds_read_b128 v[24:27], v4 offset:384
    v_mfma_f32_16x16x32_bf16 v[148:151], v[68:71], v[72:75], v[148:151]
    v_mfma_f32_16x16x32_bf16 v[140:143], v[56:59], v[76:79], v[140:143]
    ds_read2_b32 v[12:13], v0 offset0:96 offset1:97
    v_mfma_f32_16x16x32_bf16 v[144:147], v[60:63], v[76:79], v[144:147]
    ds_read2_b32 v[14:15], v0 offset0:98 offset1:99
    v_mfma_f32_16x16x32_bf16 v[148:151], v[64:67], v[76:79], v[148:151]
    ds_read_b128 v[28:31], v4 offset:896
    v_mfma_f32_16x16x32_bf16 v[152:155], v[68:71], v[76:79], v[152:155]
    v_mfma_f32_16x16x32_bf16 v[144:147], v[56:59], v[80:83], v[144:147]
    ds_read2_b32 v[16:17], v1 offset0:224 offset1:225
    v_mfma_f32_16x16x32_bf16 v[148:151], v[60:63], v[80:83], v[148:151]
    ds_read2_b32 v[18:19], v1 offset0:226 offset1:227
    v_mfma_f32_16x16x32_bf16 v[152:155], v[64:67], v[80:83], v[152:155]
    v_mfma_f32_16x16x32_bf16 v[156:159], v[68:71], v[80:83], v[156:159]
    ds_read_b128 v[32:35], v4 offset:1408
    v_mfma_f32_16x16x32_bf16 v[148:151], v[56:59], v[84:87], v[148:151]
    ds_read2_b32 v[20:21], v1 offset0:96 offset1:97
    v_mfma_f32_16x16x32_bf16 v[152:155], v[60:63], v[84:87], v[152:155]
    ds_read2_b32 v[22:23], v1 offset0:98 offset1:99
    v_mfma_f32_16x16x32_bf16 v[156:159], v[64:67], v[84:87], v[156:159]
    v_mfma_f32_16x16x32_bf16 v[160:163], v[68:71], v[84:87], v[160:163]
    ds_read_b128 v[36:39], v4 offset:1920
    v_mfma_f32_16x16x32_bf16 v[152:155], v[56:59], v[88:91], v[152:155]
    ds_read_b128 v[40:43], v4 offset:2432
    v_mfma_f32_16x16x32_bf16 v[156:159], v[60:63], v[88:91], v[156:159]
    ds_read_b128 v[44:47], v4 offset:2944
    v_mfma_f32_16x16x32_bf16 v[160:163], v[64:67], v[88:91], v[160:163]
    v_mfma_f32_16x16x32_bf16 v[164:167], v[68:71], v[88:91], v[164:167]
    ds_read_b128 v[48:51], v4 offset:3456
    v_mfma_f32_16x16x32_bf16 v[156:159], v[56:59], v[92:95], v[156:159]
    ds_read_b128 v[52:55], v4 offset:3968
    v_mfma_f32_16x16x32_bf16 v[160:163], v[60:63], v[92:95], v[160:163]
    v_mfma_f32_16x16x32_bf16 v[164:167], v[64:67], v[92:95], v[164:167]
    v_mfma_f32_16x16x32_bf16 v[160:163], v[56:59], v[96:99], v[160:163]
    v_mfma_f32_16x16x32_bf16 v[164:167], v[60:63], v[96:99], v[164:167]
    v_mfma_f32_16x16x32_bf16 v[164:167], v[56:59], v[100:103], v[164:167]
    s_waitcnt lgkmcnt(0)
    v_mfma_f32_16x16x32_bf16 v[136:139], v[8:11], v[24:27], v[136:139]
    ds_read2_b32 v[56:57], v0 offset0:240 offset1:241
    v_mfma_f32_16x16x32_bf16 v[140:143], v[12:15], v[24:27], v[140:143]
    ds_read2_b32 v[58:59], v0 offset0:242 offset1:243
    v_mfma_f32_16x16x32_bf16 v[144:147], v[16:19], v[24:27], v[144:147]
    ds_read_b128 v[72:75], v4 offset:448
    v_mfma_f32_16x16x32_bf16 v[148:151], v[20:23], v[24:27], v[148:151]
    ds_read2_b32 v[60:61], v0 offset0:112 offset1:113
    v_mfma_f32_16x16x32_bf16 v[140:143], v[8:11], v[28:31], v[140:143]
    ds_read2_b32 v[62:63], v0 offset0:114 offset1:115
    v_mfma_f32_16x16x32_bf16 v[144:147], v[12:15], v[28:31], v[144:147]
    v_mfma_f32_16x16x32_bf16 v[148:151], v[16:19], v[28:31], v[148:151]
    ds_read_b128 v[76:79], v4 offset:960
    v_mfma_f32_16x16x32_bf16 v[152:155], v[20:23], v[28:31], v[152:155]
    ds_read2_b32 v[64:65], v1 offset0:240 offset1:241
    v_mfma_f32_16x16x32_bf16 v[144:147], v[8:11], v[32:35], v[144:147]
    ds_read2_b32 v[66:67], v1 offset0:242 offset1:243
    v_mfma_f32_16x16x32_bf16 v[148:151], v[12:15], v[32:35], v[148:151]
    ds_read_b128 v[80:83], v4 offset:1472
    v_mfma_f32_16x16x32_bf16 v[152:155], v[16:19], v[32:35], v[152:155]
    v_mfma_f32_16x16x32_bf16 v[156:159], v[20:23], v[32:35], v[156:159]
    ds_read2_b32 v[68:69], v1 offset0:112 offset1:113
    v_mfma_f32_16x16x32_bf16 v[148:151], v[8:11], v[36:39], v[148:151]
    ds_read2_b32 v[70:71], v1 offset0:114 offset1:115
    v_mfma_f32_16x16x32_bf16 v[152:155], v[12:15], v[36:39], v[152:155]
    ds_read_b128 v[84:87], v4 offset:1984
    v_mfma_f32_16x16x32_bf16 v[156:159], v[16:19], v[36:39], v[156:159]
    ds_read_b128 v[88:91], v4 offset:2496
    v_mfma_f32_16x16x32_bf16 v[160:163], v[20:23], v[36:39], v[160:163]
    ds_read_b128 v[92:95], v4 offset:3008
    v_mfma_f32_16x16x32_bf16 v[152:155], v[8:11], v[40:43], v[152:155]
    v_mfma_f32_16x16x32_bf16 v[156:159], v[12:15], v[40:43], v[156:159]
    ds_read_b128 v[96:99], v4 offset:3520
    v_mfma_f32_16x16x32_bf16 v[160:163], v[16:19], v[40:43], v[160:163]
    ds_read_b128 v[100:103], v4 offset:4032
    v_mfma_f32_16x16x32_bf16 v[164:167], v[20:23], v[40:43], v[164:167]
    ds_read2_b32 v[104:105], v2 offset0:240 offset1:241
    v_mfma_f32_16x16x32_bf16 v[156:159], v[8:11], v[44:47], v[156:159]
    ds_read2_b32 v[106:107], v2 offset0:242 offset1:243
    v_mfma_f32_16x16x32_bf16 v[160:163], v[12:15], v[44:47], v[160:163]
    v_mfma_f32_16x16x32_bf16 v[164:167], v[16:19], v[44:47], v[164:167]
    v_mfma_f32_16x16x32_bf16 v[160:163], v[8:11], v[48:51], v[160:163]
    v_mfma_f32_16x16x32_bf16 v[164:167], v[12:15], v[48:51], v[164:167]
    v_mfma_f32_16x16x32_bf16 v[164:167], v[8:11], v[52:55], v[164:167]
    s_waitcnt lgkmcnt(0)
    v_mfma_f32_16x16x32_bf16 v[136:139], v[56:59], v[72:75], v[136:139]
    v_mfma_f32_16x16x32_bf16 v[140:143], v[60:63], v[72:75], v[140:143]
    v_mfma_f32_16x16x32_bf16 v[140:143], v[56:59], v[76:79], v[140:143]
    v_mfma_f32_16x16x32_bf16 v[144:147], v[64:67], v[72:75], v[144:147]
    v_mfma_f32_16x16x32_bf16 v[144:147], v[60:63], v[76:79], v[144:147]
    v_mfma_f32_16x16x32_bf16 v[144:147], v[56:59], v[80:83], v[144:147]
    v_mfma_f32_16x16x32_bf16 v[148:151], v[68:71], v[72:75], v[148:151]
    v_mfma_f32_16x16x32_bf16 v[148:151], v[64:67], v[76:79], v[148:151]
    v_mfma_f32_16x16x32_bf16 v[148:151], v[60:63], v[80:83], v[148:151]
    v_mfma_f32_16x16x32_bf16 v[148:151], v[56:59], v[84:87], v[148:151]
    s_add_u32 s58, s46, 0
    s_addc_u32 s59, s47, 0
    v_cvt_pk_bf16_f32 v8, v136, v137
    v_cvt_pk_bf16_f32 v9, v138, v139
    v_cvt_pk_bf16_f32 v10, v140, v141
    v_cvt_pk_bf16_f32 v11, v142, v143
    s_nop 0
    v_permlane16_swap_b32 v8, v10
    v_permlane16_swap_b32 v9, v11
    global_store_dwordx4 v6, v[8:11], s[58:59] sc1
    s_add_u32 s58, s58, 655360
    s_addc_u32 s59, s59, 0
    v_mfma_f32_16x16x32_bf16 v[152:155], v[104:107], v[72:75], v[152:155]
    v_mfma_f32_16x16x32_bf16 v[152:155], v[68:71], v[76:79], v[152:155]
    v_mfma_f32_16x16x32_bf16 v[152:155], v[64:67], v[80:83], v[152:155]
    v_mfma_f32_16x16x32_bf16 v[152:155], v[60:63], v[84:87], v[152:155]
    v_mfma_f32_16x16x32_bf16 v[152:155], v[56:59], v[88:91], v[152:155]
    v_mfma_f32_16x16x32_bf16 v[156:159], v[104:107], v[76:79], v[156:159]
    v_mfma_f32_16x16x32_bf16 v[156:159], v[68:71], v[80:83], v[156:159]
    v_mfma_f32_16x16x32_bf16 v[156:159], v[64:67], v[84:87], v[156:159]
    v_mfma_f32_16x16x32_bf16 v[156:159], v[60:63], v[88:91], v[156:159]
    v_mfma_f32_16x16x32_bf16 v[156:159], v[56:59], v[92:95], v[156:159]
    v_cvt_pk_bf16_f32 v12, v144, v145
    v_cvt_pk_bf16_f32 v13, v146, v147
    v_cvt_pk_bf16_f32 v14, v148, v149
    v_cvt_pk_bf16_f32 v15, v150, v151
    s_nop 0
    v_permlane16_swap_b32 v12, v14
    v_permlane16_swap_b32 v13, v15
    global_store_dwordx4 v6, v[12:15], s[58:59] sc1
    s_add_u32 s58, s58, 655360
    s_addc_u32 s59, s59, 0
    v_mfma_f32_16x16x32_bf16 v[160:163], v[104:107], v[80:83], v[160:163]
    v_mfma_f32_16x16x32_bf16 v[160:163], v[68:71], v[84:87], v[160:163]
    v_mfma_f32_16x16x32_bf16 v[160:163], v[64:67], v[88:91], v[160:163]
    v_mfma_f32_16x16x32_bf16 v[160:163], v[60:63], v[92:95], v[160:163]
    v_mfma_f32_16x16x32_bf16 v[160:163], v[56:59], v[96:99], v[160:163]
    v_mfma_f32_16x16x32_bf16 v[164:167], v[104:107], v[84:87], v[164:167]
    v_mfma_f32_16x16x32_bf16 v[164:167], v[68:71], v[88:91], v[164:167]
    v_mfma_f32_16x16x32_bf16 v[164:167], v[64:67], v[92:95], v[164:167]
    v_mfma_f32_16x16x32_bf16 v[164:167], v[60:63], v[96:99], v[164:167]
    v_mfma_f32_16x16x32_bf16 v[164:167], v[56:59], v[100:103], v[164:167]
    v_cvt_pk_bf16_f32 v16, v152, v153
    v_cvt_pk_bf16_f32 v17, v154, v155
    v_cvt_pk_bf16_f32 v18, v156, v157
    v_cvt_pk_bf16_f32 v19, v158, v159
    s_nop 0
    v_permlane16_swap_b32 v16, v18
    v_permlane16_swap_b32 v17, v19
    global_store_dwordx4 v6, v[16:19], s[58:59] sc1
    s_add_u32 s58, s58, 655360
    s_addc_u32 s59, s59, 0
    v_cvt_pk_bf16_f32 v20, v160, v161
    v_cvt_pk_bf16_f32 v21, v162, v163
    v_cvt_pk_bf16_f32 v22, v164, v165
    v_cvt_pk_bf16_f32 v23, v166, v167
    s_nop 0
    v_permlane16_swap_b32 v20, v22
    v_permlane16_swap_b32 v21, v23
    global_store_dwordx4 v6, v[20:23], s[58:59] sc1
    s_add_u32 s58, s58, 655360
    s_addc_u32 s59, s59, 0
    s_endpgm
LA_x:
    s_lshl_b32 s77, s55, 10
    s_add_u32 s77, s77, 119440
    v_and_b32 v9, 15, v1
    v_lshrrev_b32 v10, 4, v1
    v_mul_u32_u24 v7, 8224, v10
    v_lshl_add_u32 v7, v9, 4, v7
    v_add_u32 v7, s77, v7
    s_lshl_b32 s56, s55, 12
    s_add_u32 s56, s56, 2686976
    v_lshl_add_u32 v3, v9, 2, v10
    v_lshl_add_u32 v3, v3, 4, s56
    s_lshl_b32 s56, s55, 10
    s_add_u32 s56, s56, 91424
    v_lshl_add_u32 v19, v1, 4, s56
    s_lshl_b32 s56, s55, 10
    s_add_u32 s56, s56, 115328
    v_lshl_add_u32 v18, v1, 4, s56
    s_mov_b32 s79, 0x40000
    s_mov_b32 s78, 0
    s_mul_i32 s56, s55, 4608
    s_add_u32 s56, s56, 90944
    v_min_u32 v48, 29, v1
    v_lshl_add_u32 v48, v48, 4, s56
    v_add_u32 v8, 16, v8
    v_mov_b32 v44, 0
    v_mov_b32 v45, 0
    v_mov_b32 v46, 0
    v_mov_b32 v47, 0
    s_waitcnt vmcnt(7)
    v_lshlrev_b32 v120, 16, v28
    v_and_b32 v128, s53, v28
    v_lshlrev_b32 v136, 16, v29
    v_and_b32 v144, s53, v29
    s_waitcnt vmcnt(6)
    v_lshlrev_b32 v121, 16, v30
    v_and_b32 v129, s53, v30
    v_lshlrev_b32 v137, 16, v31
    v_and_b32 v145, s53, v31
    s_waitcnt vmcnt(5)
    v_lshlrev_b32 v122, 16, v32
    v_and_b32 v130, s53, v32
    v_lshlrev_b32 v138, 16, v33
    v_and_b32 v146, s53, v33
    s_waitcnt vmcnt(4)
    v_lshlrev_b32 v123, 16, v34
    v_and_b32 v131, s53, v34
    v_lshlrev_b32 v139, 16, v35
    v_and_b32 v147, s53, v35
    ds_write_b128 v18, v[120:123] offset:0
    ds_write_b128 v18, v[128:131] offset:8224
    ds_write_b128 v18, v[136:139] offset:16448
    ds_write_b128 v18, v[144:147] offset:24672
    s_waitcnt vmcnt(3)
    v_lshlrev_b32 v124, 16, v36
    v_and_b32 v132, s53, v36
    v_lshlrev_b32 v140, 16, v37
    v_and_b32 v148, s53, v37
    s_waitcnt vmcnt(2)
    v_lshlrev_b32 v125, 16, v38
    v_and_b32 v133, s53, v38
    v_lshlrev_b32 v141, 16, v39
    v_and_b32 v149, s53, v39
    global_load_dword v79, v6, s[44:45] sc1
    s_add_u32 m0, s77, 0
    s_nop 0
    global_load_lds_dwordx4 v3, s[46:47] offset:0 sc1
    s_add_u32 m0, s77, 7200
    s_nop 0
    global_load_lds_dwordx4 v3, s[46:47] offset:1024 sc1
    s_add_u32 m0, s77, 14400
    s_nop 0
    global_load_lds_dwordx4 v3, s[46:47] offset:2048 sc1
    s_add_u32 m0, s77, 21600
    s_nop 0
    global_load_lds_dwordx4 v3, s[46:47] offset:3072 sc1
    s_waitcnt vmcnt(6)
    v_lshlrev_b32 v126, 16, v40
    v_and_b32 v134, s53, v40
    v_lshlrev_b32 v142, 16, v41
    v_and_b32 v150, s53, v41
    s_waitcnt vmcnt(5)
    v_lshlrev_b32 v127, 16, v42
    v_and_b32 v135, s53, v42
    v_lshlrev_b32 v143, 16, v43
    v_and_b32 v151, s53, v43
    s_waitcnt vmcnt(0)
    ds_read_b128 v[100:103], v7 offset:0
    ds_read_b128 v[104:107], v7 offset:256
    ds_read_b128 v[108:111], v7 offset:512
    ds_read_b128 v[112:115], v7 offset:768
    v_cmp_eq_u32 vcc, 0, v79
    s_cbranch_vccnz LA_slow
LA_chk:
    s_waitcnt lgkmcnt(0)
    v_xor_b32 v10, v79, v101
    v_xor_b32 v11, v79, v103
    v_xor_b32 v16, v79, v105
    v_xor_b32 v17, v79, v107
    v_or3_b32 v10, v10, v16, v17
    v_xor_b32 v16, v79, v109
    v_xor_b32 v17, v79, v111
    v_or3_b32 v10, v10, v16, v17
    v_xor_b32 v16, v79, v113
    v_xor_b32 v17, v79, v115
    v_or3_b32 v10, v10, v16, v17
    v_or_b32 v10, v10, v11
    v_cmp_ne_u32 vcc, 0, v10
    s_cbranch_vccnz LA_slow
LA_got:
    ds_write_b64 v18, v[124:125] offset:4112
    ds_write_b64 v18, v[132:133] offset:12336
    ds_write_b64 v18, v[140:141] offset:20560
    ds_write_b64 v18, v[148:149] offset:28784
    ds_write_b64 v18, v[126:127] offset:4120
    ds_write_b64 v18, v[134:135] offset:12344
    ds_write_b64 v18, v[142:143] offset:20568
    ds_write_b64 v18, v[150:151] offset:28792
    v_and_b32 v80, s53, v100
    v_lshlrev_b32 v82, 16, v100
    v_rcp_f32 v80, v80
    v_and_b32 v81, s53, v102
    v_lshlrev_b32 v83, 16, v102
    v_rcp_f32 v81, v81
    v_and_b32 v84, s53, v104
    v_lshlrev_b32 v86, 16, v104
    v_rcp_f32 v84, v84
    v_and_b32 v85, s53, v106
    v_lshlrev_b32 v87, 16, v106
    v_rcp_f32 v85, v85
    v_and_b32 v88, s53, v108
    v_lshlrev_b32 v90, 16, v108
    v_rcp_f32 v88, v88
    v_and_b32 v89, s53, v110
    v_lshlrev_b32 v91, 16, v110
    v_rcp_f32 v89, v89
    v_and_b32 v92, s53, v112
    v_lshlrev_b32 v94, 16, v112
    v_rcp_f32 v92, v92
    v_and_b32 v93, s53, v114
    v_lshlrev_b32 v95, 16, v114
    v_rcp_f32 v93, v93
    v_pk_mul_f32 v[82:83], v[82:83], v[80:81] neg_lo:[1,0] neg_hi:[1,0]
    v_pk_mul_f32 v[86:87], v[86:87], v[84:85] neg_lo:[1,0] neg_hi:[1,0]
    v_pk_mul_f32 v[90:91], v[90:91], v[88:89] neg_lo:[1,0] neg_hi:[1,0]
    v_pk_mul_f32 v[94:95], v[94:95], v[92:93] neg_lo:[1,0] neg_hi:[1,0]
    v_pk_fma_f32 v[16:17], v[120:121], v[80:81], v[82:83]
    v_cvt_pk_bf16_f32 v52, v16, v17
    v_pk_fma_f32 v[16:17], v[122:123], v[84:85], v[86:87]
    v_cvt_pk_bf16_f32 v53, v16, v17
    v_pk_fma_f32 v[16:17], v[124:125], v[88:89], v[90:91]
    v_cvt_pk_bf16_f32 v54, v16, v17
    v_pk_fma_f32 v[16:17], v[126:127], v[92:93], v[94:95]
    v_cvt_pk_bf16_f32 v55, v16, v17
    v_pk_fma_f32 v[16:17], v[128:129], v[80:81], v[82:83]
    v_cvt_pk_bf16_f32 v56, v16, v17
    v_pk_fma_f32 v[16:17], v[130:131], v[84:85], v[86:87]
    v_cvt_pk_bf16_f32 v57, v16, v17
    v_pk_fma_f32 v[16:17], v[132:133], v[88:89], v[90:91]
    v_cvt_pk_bf16_f32 v58, v16, v17
    v_pk_fma_f32 v[16:17], v[134:135], v[92:93], v[94:95]
    v_cvt_pk_bf16_f32 v59, v16, v17
    v_pk_fma_f32 v[16:17], v[136:137], v[80:81], v[82:83]
    v_cvt_pk_bf16_f32 v60, v16, v17
    v_pk_fma_f32 v[16:17], v[138:139], v[84:85], v[86:87]
    v_cvt_pk_bf16_f32 v61, v16, v17
    v_pk_fma_f32 v[16:17], v[140:141], v[88:89], v[90:91]
    v_cvt_pk_bf16_f32 v62, v16, v17
    v_pk_fma_f32 v[16:17], v[142:143], v[92:93], v[94:95]
    v_cvt_pk_bf16_f32 v63, v16, v17
    v_pk_fma_f32 v[16:17], v[144:145], v[80:81], v[82:83]
    v_cvt_pk_bf16_f32 v64, v16, v17
    v_pk_fma_f32 v[16:17], v[146:147], v[84:85], v[86:87]
    v_cvt_pk_bf16_f32 v65, v16, v17
    v_pk_fma_f32 v[16:17], v[148:149], v[88:89], v[90:91]
    v_cvt_pk_bf16_f32 v66, v16, v17
    v_pk_fma_f32 v[16:17], v[150:151], v[92:93], v[94:95]
    v_cvt_pk_bf16_f32 v67, v16, v17
    s_mov_b32 s56, 0x100000
LA_s6:
    ds_read_b128 v[12:15], v8
    s_waitcnt lgkmcnt(0)
    v_min_u32 v12, v12, v13
    v_min3_u32 v12, v12, v14, v15
    v_cmp_gt_u32 vcc, 2, v12
    s_cbranch_vccz LA_s6d
    s_sub_u32 s56, s56, 1
    s_cmp_lg_u32 s56, 0
    s_cbranch_scc1 LA_s6
LA_s6d:
    ds_write_b128 v48, v[44:47]
    ds_write_b128 v19, v[52:55] offset:0
    ds_write_b128 v19, v[56:59] offset:4608
    ds_write_b128 v19, v[60:63] offset:9216
    ds_write_b128 v19, v[64:67] offset:13824
    s_waitcnt lgkmcnt(0)
    s_barrier
    s_endpgm
LA_slow:
    s_sub_u32 s79, s79, 1
    s_cmp_eq_u32 s79, 0
    s_cbranch_scc1 LA_got
    s_waitcnt lgkmcnt(0)
    global_load_dword v79, v6, s[44:45] sc1
    s_add_u32 m0, s77, 0
    s_nop 0
    global_load_lds_dwordx4 v3, s[46:47] offset:0 sc1
    s_add_u32 m0, s77, 7200
    s_nop 0
    global_load_lds_dwordx4 v3, s[46:47] offset:1024 sc1
    s_add_u32 m0, s77, 14400
    s_nop 0
    global_load_lds_dwordx4 v3, s[46:47] offset:2048 sc1
    s_add_u32 m0, s77, 21600
    s_nop 0
    global_load_lds_dwordx4 v3, s[46:47] offset:3072 sc1
    s_waitcnt vmcnt(0)
    ds_read_b128 v[100:103], v7 offset:0
    ds_read_b128 v[104:107], v7 offset:256
    ds_read_b128 v[108:111], v7 offset:512
    ds_read_b128 v[112:115], v7 offset:768
    v_cmp_eq_u32 vcc, 0, v79
    s_cbranch_vccnz LA_slow
    s_branch LA_chk
LA_w13:
    s_cmp_ge_u32 s48, 8
    s_cbranch_scc1 LA_bg
    s_sub_u32 s55, s50, 28
    s_mov_b32 s58, 0xaaaaaab
    s_and_b32 s56, s48, 3
    s_mul_i32 s57, s55, 160
    s_mul_i32 s59, s56, 40
    s_add_u32 s57, s57, s59
    s_mul_i32 s57, s57, 3072
    s_mul_i32 s59, s49, 384
    s_add_u32 s57, s57, s59
    v_add_u32 v3, 0, v1
    v_mul_hi_u32 v4, v3, s58
    v_mul_u32_u24 v5, 24, v4
    v_sub_u32 v5, v3, v5
    v_mul_u32_u24 v4, 3072, v4
    v_lshl_add_u32 v6, v5, 4, v4
    v_add_u32 v3, 64, v1
    v_mul_hi_u32 v4, v3, s58
    v_mul_u32_u24 v5, 24, v4
    v_sub_u32 v5, v3, v5
    v_mul_u32_u24 v4, 3072, v4
    v_lshl_add_u32 v7, v5, 4, v4
    v_subrev_u32 v7, 1024, v7
    v_add_u32 v3, 128, v1
    v_mul_hi_u32 v4, v3, s58
    v_mul_u32_u24 v5, 24, v4
    v_sub_u32 v5, v3, v5
    v_mul_u32_u24 v4, 3072, v4
    v_lshl_add_u32 v8, v5, 4, v4
    v_subrev_u32 v8, 2048, v8
    s_mul_i32 s68, s56, 15360
    s_lshr_b32 s59, s48, 2
    s_mul_i32 s59, s59, 61472
    s_add_u32 s68, s68, s59
    s_add_u32 s68, s68, 4096
    s_waitcnt lgkmcnt(0)
    s_cmp_lt_u32 s48, 4
    s_cselect_b32 s60, s36, s38
    s_cselect_b32 s61, s37, s39
    s_mov_b32 s62, 1966080
    s_mov_b32 s63, 0x20000
    s_add_u32 m0, s68, 0
    s_nop 0
    buffer_load_dwordx4 v6, s[60:63], s57 offen offset:0 lds
    buffer_load_dwordx4 v7, s[60:63], s57 offen offset:1024 lds
    buffer_load_dwordx4 v8, s[60:63], s57 offen offset:2048 lds
    s_add_u32 s57, s57, 24576
    s_waitcnt vmcnt(0)
    s_add_u32 m0, s68, 3072
    s_nop 0
    buffer_load_dwordx4 v6, s[60:63], s57 offen offset:0 lds
    buffer_load_dwordx4 v7, s[60:63], s57 offen offset:1024 lds
    buffer_load_dwordx4 v8, s[60:63], s57 offen offset:2048 lds
    s_add_u32 s57, s57, 24576
    s_waitcnt vmcnt(0)
    s_add_u32 m0, s68, 6144
    s_nop 0
    buffer_load_dwordx4 v6, s[60:63], s57 offen offset:0 lds
    buffer_load_dwordx4 v7, s[60:63], s57 offen offset:1024 lds
    buffer_load_dwordx4 v8, s[60:63], s57 offen offset:2048 lds
    s_add_u32 s57, s57, 24576
    s_waitcnt vmcnt(0)
    s_add_u32 m0, s68, 9216
    s_nop 0
    buffer_load_dwordx4 v6, s[60:63], s57 offen offset:0 lds
    buffer_load_dwordx4 v7, s[60:63], s57 offen offset:1024 lds
    buffer_load_dwordx4 v8, s[60:63], s57 offen offset:2048 lds
    s_add_u32 s57, s57, 24576
    s_waitcnt vmcnt(0)
    s_add_u32 m0, s68, 12288
    s_nop 0
    buffer_load_dwordx4 v6, s[60:63], s57 offen offset:0 lds
    buffer_load_dwordx4 v7, s[60:63], s57 offen offset:1024 lds
    buffer_load_dwordx4 v8, s[60:63], s57 offen offset:2048 lds
    v_lshrrev_b32 v3, 4, v1
    v_bfe_u32 v4, v1, 2, 2
    v_lshl_add_u32 v3, v3, 3, v4
    v_mul_u32_u24 v3, 384, v3
    s_lshr_b32 s59, s48, 2
    s_mul_i32 s64, s59, 61472
    s_mul_i32 s65, s56, 96
    s_add_u32 s64, s64, s65
    s_add_u32 s64, s64, 4096
    v_and_b32 v5, 3, v1
    v_lshl_add_u32 v3, v5, 3, v3
    v_add_u32 v3, s64, v3
    s_lshl_b32 s57, s49, 1
    s_lshr_b32 s65, s56, 1
    s_add_u32 s57, s57, s65
    s_mul_i32 s66, s57, 768
    s_mul_i32 s57, s57, 20
    s_mul_i32 s65, s55, 5
    s_add_u32 s57, s57, s65
    s_mul_i32 s57, s57, 12
    s_and_b32 s65, s48, 1
    s_mul_i32 s65, s65, 6
    s_add_u32 s65, s65, s59
    s_add_u32 s57, s57, s65
    s_lshl_b32 s57, s57, 10
    s_add_u32 s57, s57, 10485760
    v_lshl_add_u32 v4, v1, 4, s57
    v_add_u32 v11, 4096, v4
    v_mov_b32 v8, 0
    v_mov_b32 v9, 0
    v_mov_b32 v10, 0
    s_lshl_b32 s65, s65, 6
    s_add_u32 s66, s66, s65
    s_mul_i32 s65, s55, 12288
    s_add_u32 s66, s66, s65
    s_add_u32 s66, s66, 2883584
    v_and_b32 v12, 15, v1
    v_lshl_add_u32 v12, v12, 2, s66
    s_waitcnt vmcnt(0)
    s_barrier
    ds_read_b64_tr_b16 v[16:17], v3 offset:0
    ds_read_b64_tr_b16 v[18:19], v3 offset:1536
    ds_read_b64_tr_b16 v[20:21], v3 offset:32
    ds_read_b64_tr_b16 v[22:23], v3 offset:1568
    ds_read_b64_tr_b16 v[24:25], v3 offset:64
    ds_read_b64_tr_b16 v[26:27], v3 offset:1600
    ds_read_b64_tr_b16 v[28:29], v3 offset:12288
    ds_read_b64_tr_b16 v[30:31], v3 offset:13824
    ds_read_b64_tr_b16 v[32:33], v3 offset:12320
    ds_read_b64_tr_b16 v[34:35], v3 offset:13856
    ds_read_b64_tr_b16 v[36:37], v3 offset:12352
    ds_read_b64_tr_b16 v[38:39], v3 offset:13888
    s_waitcnt lgkmcnt(6)
    global_store_dwordx4 v4, v[16:19], s[46:47] offset:0 sc1
    global_store_dwordx4 v4, v[20:23], s[46:47] offset:2048 sc1
    global_store_dwordx4 v11, v[24:27], s[46:47] offset:0 sc1
    v_add_u32 v4, 12288, v4
    v_add_u32 v11, 12288, v11
    ds_read_b64_tr_b16 v[40:41], v3 offset:24576
    ds_read_b64_tr_b16 v[42:43], v3 offset:26112
    ds_read_b64_tr_b16 v[44:45], v3 offset:24608
    ds_read_b64_tr_b16 v[46:47], v3 offset:26144
    ds_read_b64_tr_b16 v[48:49], v3 offset:24640
    ds_read_b64_tr_b16 v[50:51], v3 offset:26176
    s_waitcnt lgkmcnt(6)
    global_store_dwordx4 v4, v[28:31], s[46:47] offset:0 sc1
    global_store_dwordx4 v4, v[32:35], s[46:47] offset:2048 sc1
    global_store_dwordx4 v11, v[36:39], s[46:47] offset:0 sc1
    v_add_u32 v4, 12288, v4
    v_add_u32 v11, 12288, v11
    ds_read_b64_tr_b16 v[52:53], v3 offset:36864
    ds_read_b64_tr_b16 v[54:55], v3 offset:38400
    ds_read_b64_tr_b16 v[56:57], v3 offset:36896
    ds_read_b64_tr_b16 v[58:59], v3 offset:38432
    ds_read_b64_tr_b16 v[60:61], v3 offset:36928
    ds_read_b64_tr_b16 v[62:63], v3 offset:38464
    s_waitcnt lgkmcnt(6)
    global_store_dwordx4 v4, v[40:43], s[46:47] offset:0 sc1
    global_store_dwordx4 v4, v[44:47], s[46:47] offset:2048 sc1
    global_store_dwordx4 v11, v[48:51], s[46:47] offset:0 sc1
    v_add_u32 v4, 12288, v4
    v_add_u32 v11, 12288, v11
    ds_read_b64_tr_b16 v[64:65], v3 offset:49152
    ds_read_b64_tr_b16 v[66:67], v3 offset:50688
    ds_read_b64_tr_b16 v[68:69], v3 offset:49184
    ds_read_b64_tr_b16 v[70:71], v3 offset:50720
    ds_read_b64_tr_b16 v[72:73], v3 offset:49216
    ds_read_b64_tr_b16 v[74:75], v3 offset:50752
    s_waitcnt lgkmcnt(6)
    global_store_dwordx4 v4, v[52:55], s[46:47] offset:0 sc1
    global_store_dwordx4 v4, v[56:59], s[46:47] offset:2048 sc1
    global_store_dwordx4 v11, v[60:63], s[46:47] offset:0 sc1
    v_add_u32 v4, 12288, v4
    v_add_u32 v11, 12288, v11
    s_waitcnt lgkmcnt(0)
    global_store_dwordx4 v4, v[64:67], s[46:47] offset:0 sc1
    global_store_dwordx4 v4, v[68:71], s[46:47] offset:2048 sc1
    global_store_dwordx4 v11, v[72:75], s[46:47] offset:0 sc1
    v_dot2c_f32_bf16 v8, s54, v16
    v_dot2c_f32_bf16 v8, s54, v17
    v_dot2c_f32_bf16 v8, s54, v18
    v_dot2c_f32_bf16 v8, s54, v19
    v_dot2c_f32_bf16 v9, s54, v20
    v_dot2c_f32_bf16 v9, s54, v21
    v_dot2c_f32_bf16 v9, s54, v22
    v_dot2c_f32_bf16 v9, s54, v23
    v_dot2c_f32_bf16 v10, s54, v24
    v_dot2c_f32_bf16 v10, s54, v25
    v_dot2c_f32_bf16 v10, s54, v26
    v_dot2c_f32_bf16 v10, s54, v27
    v_dot2c_f32_bf16 v8, s54, v28
    v_dot2c_f32_bf16 v8, s54, v29
    v_dot2c_f32_bf16 v8, s54, v30
    v_dot2c_f32_bf16 v8, s54, v31
    v_dot2c_f32_bf16 v9, s54, v32
    v_dot2c_f32_bf16 v9, s54, v33
    v_dot2c_f32_bf16 v9, s54, v34
    v_dot2c_f32_bf16 v9, s54, v35
    v_dot2c_f32_bf16 v10, s54, v36
    v_dot2c_f32_bf16 v10, s54, v37
    v_dot2c_f32_bf16 v10, s54, v38
    v_dot2c_f32_bf16 v10, s54, v39
    v_dot2c_f32_bf16 v8, s54, v40
    v_dot2c_f32_bf16 v8, s54, v41
    v_dot2c_f32_bf16 v8, s54, v42
    v_dot2c_f32_bf16 v8, s54, v43
    v_dot2c_f32_bf16 v9, s54, v44
    v_dot2c_f32_bf16 v9, s54, v45
    v_dot2c_f32_bf16 v9, s54, v46
    v_dot2c_f32_bf16 v9, s54, v47
    v_dot2c_f32_bf16 v10, s54, v48
    v_dot2c_f32_bf16 v10, s54, v49
    v_dot2c_f32_bf16 v10, s54, v50
    v_dot2c_f32_bf16 v10, s54, v51
    v_dot2c_f32_bf16 v8, s54, v52
    v_dot2c_f32_bf16 v8, s54, v53
    v_dot2c_f32_bf16 v8, s54, v54
    v_dot2c_f32_bf16 v8, s54, v55
    v_dot2c_f32_bf16 v9, s54, v56
    v_dot2c_f32_bf16 v9, s54, v57
    v_dot2c_f32_bf16 v9, s54, v58
    v_dot2c_f32_bf16 v9, s54, v59
    v_dot2c_f32_bf16 v10, s54, v60
    v_dot2c_f32_bf16 v10, s54, v61
    v_dot2c_f32_bf16 v10, s54, v62
    v_dot2c_f32_bf16 v10, s54, v63
    v_dot2c_f32_bf16 v8, s54, v64
    v_dot2c_f32_bf16 v8, s54, v65
    v_dot2c_f32_bf16 v8, s54, v66
    v_dot2c_f32_bf16 v8, s54, v67
    v_dot2c_f32_bf16 v9, s54, v68
    v_dot2c_f32_bf16 v9, s54, v69
    v_dot2c_f32_bf16 v9, s54, v70
    v_dot2c_f32_bf16 v9, s54, v71
    v_dot2c_f32_bf16 v10, s54, v72
    v_dot2c_f32_bf16 v10, s54, v73
    v_dot2c_f32_bf16 v10, s54, v74
    v_dot2c_f32_bf16 v10, s54, v75
    v_mov_b32 v13, v8
    v_mov_b32 v14, v9
    s_nop 0
    v_mov_b32 v15, v10
    v_permlane16_swap_b32 v8, v13
    v_permlane16_swap_b32 v9, v14
    v_permlane16_swap_b32 v10, v15
    v_add_f32 v8, v8, v13
    v_add_f32 v9, v9, v14
    v_add_f32 v10, v10, v15
    v_mov_b32 v13, v8
    v_mov_b32 v14, v9
    v_mov_b32 v15, v10
    v_permlane32_swap_b32 v8, v13
    v_permlane32_swap_b32 v9, v14
    v_permlane32_swap_b32 v10, v15
    v_add_f32 v8, v8, v13
    v_add_f32 v9, v9, v14
    v_add_f32 v10, v10, v15
    s_mov_b64 exec, 0xffff
    global_store_dword v12, v8, s[46:47] offset:0 sc1
    global_store_dword v12, v9, s[46:47] offset:128 sc1
    global_store_dword v12, v10, s[46:47] offset:256 sc1
    s_mov_b64 exec, -1
LA_exit:
    s_endpgm

.globl kB_kernel
.p2align 8
.type kB_kernel,@function
kB_kernel:
    s_cmp_ge_u32 s2, 0x100
    s_cbranch_scc1 LB_exit
    s_load_dwordx8 s[40:47], s[0:1], 96
    v_lshrrev_b32 v2, 6, v0
    v_and_b32 v1, 63, v0
    s_and_b32 s65, s2, 7
    s_lshr_b32 s66, s2, 3
    v_readfirstlane_b32 s64, v2
    s_and_b32 s80, s65, 1
    s_lshl_b32 s80, s80, 3
    s_and_b32 s81, s66, 7
    s_add_u32 s67, s80, s81
    s_lshr_b32 s80, s65, 1
    s_lshr_b32 s81, s66, 3
    s_lshl_b32 s82, s80, 2
    s_add_u32 s68, s82, s81
    v_lshrrev_b32 v28, 4, v1
    v_and_b32 v29, 15, v1
    s_and_b32 s82, s64, 1
    s_lshl_b32 s82, s82, 3
    v_lshl_add_u32 v30, v28, 1, s82
    v_xor_b32 v30, v29, v30
    s_lshl_b32 s71, s64, 11
    v_lshlrev_b32 v2, 8, v28
    v_lshl_add_u32 v2, v30, 4, v2
    v_add_u32 v2, s71, v2
    s_mul_i32 s76, s64, 3072
    v_lshlrev_b32 v4, 4, v1
    v_add_u32 v3, s76, v4
    s_add_u32 s72, s76, 8192
    s_mul_i32 s80, s67, 163840
    s_mul_i32 s81, s68, 245760
    s_add_u32 s81, s81, 10485760
    s_sub_u32 s82, s68, 10
    s_cmp_ge_u32 s68, 10
    s_cselect_b32 s78, s82, s68
    s_mov_b32 s50, 163840
    s_mov_b32 s51, 0x20000
    s_mov_b32 s54, 245760
    s_mov_b32 s55, 0x20000
    s_lshl_b32 s73, s78, 14
    s_mul_i32 s74, s78, 24576
    s_waitcnt lgkmcnt(0)
    s_add_u32 s48, s46, s80
    s_addc_u32 s49, s47, 0
    s_add_u32 s52, s46, s81
    s_addc_u32 s53, s47, 0
    s_add_u32 m0, s71, 0
    s_nop 0
    buffer_load_dwordx4 v2, s[48:51], s73 offen lds
    buffer_load_dwordx4 v2, s[48:51], s73 offen offset:1024 lds
    s_add_u32 m0, s72, 0
    s_add_u32 s73, s73, 8192
    buffer_load_dwordx4 v3, s[52:55], s74 offen offset:0 lds
    buffer_load_dwordx4 v3, s[52:55], s74 offen offset:1024 lds
    buffer_load_dwordx4 v3, s[52:55], s74 offen offset:2048 lds
    s_add_u32 s74, s74, 12288
    s_add_u32 m0, s71, 20480
    s_nop 0
    buffer_load_dwordx4 v2, s[48:51], s73 offen lds
    v_bfe_u32 v29, v1, 2, 2
    v_and_b32 v30, 3, v1
    v_lshl_add_u32 v31, v28, 3, v29
    v_and_b32 v18, 1, v28
    v_lshl_add_u32 v18, v18, 2, v29
    s_lshr_b32 s80, s64, 1
    s_lshl_b32 s80, s80, 2
    v_lshlrev_b32 v19, 8, v31
    buffer_load_dwordx4 v2, s[48:51], s73 offen offset:1024 lds
    v_lshl_add_u32 v19, v30, 3, v19
    s_add_u32 s81, s80, 0
    v_xor_b32 v15, s81, v18
    v_lshl_add_u32 v6, v15, 5, v19
    s_add_u32 s81, s80, 1
    v_xor_b32 v15, s81, v18
    v_lshl_add_u32 v7, v15, 5, v19
    s_add_u32 s81, s80, 2
    s_add_u32 m0, s72, 20480
    s_add_u32 s73, s73, 8192
    buffer_load_dwordx4 v3, s[52:55], s74 offen offset:0 lds
    v_xor_b32 v15, s81, v18
    v_lshl_add_u32 v8, v15, 5, v19
    s_add_u32 s81, s80, 3
    v_xor_b32 v15, s81, v18
    v_lshl_add_u32 v9, v15, 5, v19
    s_and_b32 s80, s64, 1
    s_mul_i32 s80, s80, 6144
    s_add_u32 s80, s80, 8192
    buffer_load_dwordx4 v3, s[52:55], s74 offen offset:1024 lds
    v_add_u32 v10, s80, v4
    s_bitcmp1_b32 s64, 0
    s_cselect_b64 vcc, -1, 0
    v_cndmask_b32 v11, v6, v8, vcc
    v_cndmask_b32 v12, v7, v9, vcc
    s_mov_b32 s77, 0xffff0000
    s_mov_b32 s29, 0x3f803f80
    v_mov_b32 v16, 0
    v_mov_b32 v17, 0
    v_mov_b32 v13, 0
    v_mov_b32 v14, 0
    buffer_load_dwordx4 v3, s[52:55], s74 offen offset:2048 lds
    s_add_u32 s74, s74, 12288
    s_cmp_eq_u32 s73, 163840
    s_cselect_b32 s73, 0, s73
    s_cselect_b32 s74, 0, s74
    s_add_u32 m0, s71, 40960
    s_nop 0
    buffer_load_dwordx4 v2, s[48:51], s73 offen lds
    buffer_load_dwordx4 v2, s[48:51], s73 offen offset:1024 lds
    s_add_u32 m0, s72, 40960
    s_add_u32 s73, s73, 8192
    buffer_load_dwordx4 v3, s[52:55], s74 offen offset:0 lds
    buffer_load_dwordx4 v3, s[52:55], s74 offen offset:1024 lds
    buffer_load_dwordx4 v3, s[52:55], s74 offen offset:2048 lds
    s_add_u32 s74, s74, 12288
    s_lshl_b32 s80, s65, 2
    s_lshr_b32 s81, s66, 3
    s_add_u32 s80, s80, s81
    s_lshr_b32 s84, s80, 1
    s_and_b32 s69, s80, 1
    s_and_b32 s70, s66, 7
    s_mul_i32 s80, s70, 245760
    s_add_u32 s80, s80, 14680064
    s_add_u32 s56, s46, s80
    s_addc_u32 s57, s47, 0
    s_mov_b32 s58, 245760
    s_mov_b32 s59, 0x20000
    s_add_u32 s60, s46, 3145728
    s_addc_u32 s61, s47, 0
    s_mov_b32 s62, 6291456
    s_mov_b32 s63, 0x20000
    s_mul_i32 s75, s64, 61440
    v_add_u32 v5, 4096, v4
    s_mul_i32 s80, s84, 163840
    s_add_u32 s16, s46, s80
    s_addc_u32 s17, s47, 0
    s_mov_b32 s18, 163840
    s_mov_b32 s19, 0x20000
    s_mul_i32 s80, s70, 20480
    s_lshl_b32 s81, s69, 7
    s_add_u32 s80, s80, s81
    s_mul_i32 s81, s64, 6144
    s_add_u32 s80, s80, s81
    v_lshrrev_b32 v15, 3, v1
    v_lshlrev_b32 v15, 8, v15
    v_and_b32 v224, 7, v1
    v_lshl_add_u32 v15, v224, 4, v15
    v_add_u32 v21, s80, v15
    v_and_b32 v224, 31, v1
    v_lshrrev_b32 v225, 5, v1
    s_mul_i32 s80, s67, 10240
    s_add_u32 s80, s80, 2949120
    s_lshl_b32 s81, s78, 10
    s_add_u32 s81, s81, s80
    s_lshl_b32 s82, s64, 8
    s_add_u32 s81, s81, s82
    v_lshl_add_u32 v25, v224, 3, s81
    s_lshr_b32 s81, s64, 1
    s_lshl_b32 s82, s81, 9
    s_add_u32 s80, s80, s82
    v_mul_u32_u24 v15, 5120, v225
    v_lshl_add_u32 v15, v224, 3, v15
    v_add_u32 v15, s80, v15
    v_add_u32 v24, 4096, v15
    v_lshlrev_b32 v226, 11, v225
    v_lshl_add_u32 v226, v224, 4, v226
    s_lshl_b32 s81, s81, 10
    v_add_u32 v26, s81, v226
    s_waitcnt vmcnt(10)
    s_barrier
    ds_read_b64_tr_b16 v[208:209], v11 offset:0
    ds_read_b64_tr_b16 v[210:211], v11 offset:1024
    ds_read_b64_tr_b16 v[212:213], v12 offset:0
    ds_read_b64_tr_b16 v[214:215], v12 offset:1024
    ds_read_b128 v[128:131], v10 offset:0
    ds_read_b64_tr_b16 v[152:153], v6 offset:0
    ds_read_b64_tr_b16 v[154:155], v6 offset:1024
    ds_read_b64_tr_b16 v[156:157], v7 offset:0
    ds_read_b64_tr_b16 v[158:159], v7 offset:1024
    ds_read_b128 v[132:135], v10 offset:1024
    ds_read_b64_tr_b16 v[160:161], v8 offset:0
    ds_read_b64_tr_b16 v[162:163], v8 offset:1024
    ds_read_b64_tr_b16 v[164:165], v9 offset:0
    ds_read_b64_tr_b16 v[166:167], v9 offset:1024
    ds_read_b128 v[136:139], v10 offset:2048
    ds_read_b128 v[140:143], v10 offset:3072
    ds_read_b128 v[144:147], v10 offset:4096
    ds_read_b128 v[148:151], v10 offset:5120
    s_add_u32 m0, s71, 61440
    s_nop 0
    buffer_load_dwordx4 v2, s[48:51], s73 offen lds
    buffer_load_dwordx4 v2, s[48:51], s73 offen offset:1024 lds
    s_add_u32 m0, s72, 61440
    s_add_u32 s73, s73, 8192
    buffer_load_dwordx4 v3, s[52:55], s74 offen offset:0 lds
    buffer_load_dwordx4 v3, s[52:55], s74 offen offset:1024 lds
    buffer_load_dwordx4 v3, s[52:55], s74 offen offset:2048 lds
    s_add_u32 s74, s74, 12288
    s_cmp_eq_u32 s73, 163840
    s_cselect_b32 s73, 0, s73
    s_cselect_b32 s74, 0, s74
    s_add_u32 m0, s71, 81920
    s_nop 0
    buffer_load_dwordx4 v2, s[48:51], s73 offen lds
    buffer_load_dwordx4 v2, s[48:51], s73 offen offset:1024 lds
    s_add_u32 m0, s72, 81920
    s_add_u32 s73, s73, 8192
    s_waitcnt lgkmcnt(14)
    v_dot2c_f32_bf16 v16, s29, v208
    v_dot2c_f32_bf16 v17, v208, v208
    v_dot2c_f32_bf16 v16, s29, v209
    v_dot2c_f32_bf16 v17, v209, v209
    v_dot2c_f32_bf16 v16, s29, v210
    v_dot2c_f32_bf16 v17, v210, v210
    v_dot2c_f32_bf16 v16, s29, v211
    v_dot2c_f32_bf16 v17, v211, v211
    v_dot2c_f32_bf16 v13, s29, v212
    v_dot2c_f32_bf16 v14, v212, v212
    v_dot2c_f32_bf16 v13, s29, v213
    v_dot2c_f32_bf16 v14, v213, v213
    v_dot2c_f32_bf16 v13, s29, v214
    v_dot2c_f32_bf16 v14, v214, v214
    v_dot2c_f32_bf16 v13, s29, v215
    v_dot2c_f32_bf16 v14, v215, v215
    s_waitcnt vmcnt(12)
    s_barrier
    s_waitcnt lgkmcnt(0)
    v_mfma_f32_16x16x32_bf16 v[32:35], v[128:131], v[152:155], 0
    ds_read_b128 v[168:171], v10 offset:20480
    s_mul_i32 s80, s68, 768
    v_mfma_f32_16x16x32_bf16 v[36:39], v[128:131], v[156:159], 0
    buffer_load_dwordx4 v3, s[52:55], s74 offen offset:0 lds
    ds_read_b64_tr_b16 v[192:193], v6 offset:20480
    v_mfma_f32_16x16x32_bf16 v[40:43], v[128:131], v[160:163], 0
    ds_read_b64_tr_b16 v[194:195], v6 offset:21504
    s_and_b32 s81, s64, 1
    v_mfma_f32_16x16x32_bf16 v[44:47], v[128:131], v[164:167], 0
    ds_read_b64_tr_b16 v[196:197], v7 offset:20480
    v_mfma_f32_16x16x32_bf16 v[60:63], v[132:135], v[164:167], 0
    ds_read_b64_tr_b16 v[198:199], v7 offset:21504
    v_mfma_f32_16x16x32_bf16 v[56:59], v[132:135], v[160:163], 0
    buffer_load_dwordx4 v3, s[52:55], s74 offen offset:1024 lds
    ds_read_b128 v[172:175], v10 offset:21504
    s_mul_i32 s81, s81, 384
    v_mfma_f32_16x16x32_bf16 v[52:55], v[132:135], v[156:159], 0
    ds_read_b64_tr_b16 v[200:201], v8 offset:20480
    v_mfma_f32_16x16x32_bf16 v[48:51], v[132:135], v[152:155], 0
    ds_read_b64_tr_b16 v[202:203], v8 offset:21504
    v_mfma_f32_16x16x32_bf16 v[64:67], v[136:139], v[152:155], 0
    buffer_load_dwordx4 v3, s[52:55], s74 offen offset:2048 lds
    ds_read_b64_tr_b16 v[204:205], v9 offset:20480
    s_add_u32 s80, s80, s81
    v_mfma_f32_16x16x32_bf16 v[68:71], v[136:139], v[156:159], 0
    ds_read_b64_tr_b16 v[206:207], v9 offset:21504
    v_mfma_f32_16x16x32_bf16 v[72:75], v[136:139], v[160:163], 0
    ds_read_b128 v[176:179], v10 offset:22528
    s_add_u32 s80, s80, 2883584
    v_mfma_f32_16x16x32_bf16 v[76:79], v[136:139], v[164:167], 0
    s_add_u32 s74, s74, 12288
    s_add_u32 m0, s71, 102400
    ds_read_b128 v[180:183], v10 offset:23552
    v_mfma_f32_16x16x32_bf16 v[92:95], v[140:143], v[164:167], 0
    buffer_load_dwordx4 v2, s[48:51], s73 offen lds
    ds_read_b128 v[184:187], v10 offset:24576
    v_mfma_f32_16x16x32_bf16 v[88:91], v[140:143], v[160:163], 0
    ds_read_b128 v[188:191], v10 offset:25600
    v_min_u32 v18, 23, v224
    v_mfma_f32_16x16x32_bf16 v[84:87], v[140:143], v[156:159], 0
    ds_read_b64_tr_b16 v[216:217], v11 offset:20480
    v_mfma_f32_16x16x32_bf16 v[80:83], v[140:143], v[152:155], 0
    buffer_load_dwordx4 v2, s[48:51], s73 offen offset:1024 lds
    ds_read_b64_tr_b16 v[218:219], v11 offset:21504
    v_mfma_f32_16x16x32_bf16 v[96:99], v[144:147], v[152:155], 0
    ds_read_b64_tr_b16 v[220:221], v12 offset:20480
    v_lshlrev_b32 v18, 4, v18
    v_mfma_f32_16x16x32_bf16 v[100:103], v[144:147], v[156:159], 0
    s_add_u32 m0, s72, 102400
    s_add_u32 s73, s73, 8192
    ds_read_b64_tr_b16 v[222:223], v12 offset:21504
    v_mfma_f32_16x16x32_bf16 v[104:107], v[144:147], v[160:163], 0
    buffer_load_dwordx4 v3, s[52:55], s74 offen offset:0 lds
    v_mul_u32_u24 v226, 12288, v225
    v_mfma_f32_16x16x32_bf16 v[108:111], v[144:147], v[164:167], 0
    v_mfma_f32_16x16x32_bf16 v[124:127], v[148:151], v[164:167], 0
    v_mfma_f32_16x16x32_bf16 v[120:123], v[148:151], v[160:163], 0
    v_add3_u32 v18, v18, v226, s80
    v_mfma_f32_16x16x32_bf16 v[116:119], v[148:151], v[156:159], 0
    buffer_load_dwordx4 v3, s[52:55], s74 offen offset:1024 lds
    v_mfma_f32_16x16x32_bf16 v[112:115], v[148:151], v[152:155], 0
    s_waitcnt vmcnt(14)
    s_barrier
    s_waitcnt lgkmcnt(0)
    v_mfma_f32_16x16x32_bf16 v[32:35], v[168:171], v[192:195], v[32:35]
    ds_read_b128 v[128:131], v10 offset:40960
    v_lshlrev_b32 v30, 16, v216
    v_and_b32 v31, s77, v216
    v_mfma_f32_16x16x32_bf16 v[36:39], v[168:171], v[196:199], v[36:39]
    buffer_load_dwordx4 v3, s[52:55], s74 offen offset:2048 lds
    v_add_f32 v16, v16, v30
    v_mfma_f32_16x16x32_bf16 v[40:43], v[168:171], v[200:203], v[40:43]
    ds_read_b64_tr_b16 v[152:153], v6 offset:40960
    v_fmac_f32 v17, v30, v30
    v_mfma_f32_16x16x32_bf16 v[44:47], v[168:171], v[204:207], v[44:47]
    ds_read_b64_tr_b16 v[154:155], v6 offset:41984
    v_add_f32 v16, v16, v31
    v_fmac_f32 v17, v31, v31
    v_mfma_f32_16x16x32_bf16 v[60:63], v[172:175], v[204:207], v[60:63]
    s_add_u32 s74, s74, 12288
    s_cmp_eq_u32 s73, 163840
    s_cselect_b32 s73, 0, s73
    s_cselect_b32 s74, 0, s74
    s_add_u32 m0, s71, 122880
    ds_read_b64_tr_b16 v[156:157], v7 offset:40960
    v_lshlrev_b32 v30, 16, v217
    v_mfma_f32_16x16x32_bf16 v[56:59], v[172:175], v[200:203], v[56:59]
    buffer_load_dwordx4 v2, s[48:51], s73 offen lds
    v_and_b32 v31, s77, v217
    v_mfma_f32_16x16x32_bf16 v[52:55], v[172:175], v[196:199], v[52:55]
    ds_read_b64_tr_b16 v[158:159], v7 offset:41984
    v_add_f32 v16, v16, v30
    v_fmac_f32 v17, v30, v30
    v_mfma_f32_16x16x32_bf16 v[48:51], v[172:175], v[192:195], v[48:51]
    ds_read_b128 v[132:135], v10 offset:41984
    v_add_f32 v16, v16, v31
    v_mfma_f32_16x16x32_bf16 v[64:67], v[176:179], v[192:195], v[64:67]
    buffer_load_dwordx4 v2, s[48:51], s73 offen offset:1024 lds
    v_fmac_f32 v17, v31, v31
    v_mfma_f32_16x16x32_bf16 v[68:71], v[176:179], v[196:199], v[68:71]
    ds_read_b64_tr_b16 v[160:161], v8 offset:40960
    v_lshlrev_b32 v30, 16, v218
    v_mfma_f32_16x16x32_bf16 v[72:75], v[176:179], v[200:203], v[72:75]
    ds_read_b64_tr_b16 v[162:163], v8 offset:41984
    v_and_b32 v31, s77, v218
    v_add_f32 v16, v16, v30
    v_mfma_f32_16x16x32_bf16 v[76:79], v[176:179], v[204:207], v[76:79]
    s_add_u32 m0, s72, 122880
    s_add_u32 s73, s73, 8192
    ds_read_b64_tr_b16 v[164:165], v9 offset:40960
    v_fmac_f32 v17, v30, v30
    v_mfma_f32_16x16x32_bf16 v[92:95], v[180:183], v[204:207], v[92:95]
    buffer_load_dwordx4 v3, s[52:55], s74 offen offset:0 lds
    v_add_f32 v16, v16, v31
    v_mfma_f32_16x16x32_bf16 v[88:91], v[180:183], v[200:203], v[88:91]
    ds_read_b64_tr_b16 v[166:167], v9 offset:41984
    v_fmac_f32 v17, v31, v31
    v_lshlrev_b32 v30, 16, v219
    v_mfma_f32_16x16x32_bf16 v[84:87], v[180:183], v[196:199], v[84:87]
    ds_read_b128 v[136:139], v10 offset:43008
    v_and_b32 v31, s77, v219
    v_mfma_f32_16x16x32_bf16 v[80:83], v[180:183], v[192:195], v[80:83]
    buffer_load_dwordx4 v3, s[52:55], s74 offen offset:1024 lds
    v_add_f32 v16, v16, v30
    v_mfma_f32_16x16x32_bf16 v[96:99], v[184:187], v[192:195], v[96:99]
    ds_read_b128 v[140:143], v10 offset:44032
    v_fmac_f32 v17, v30, v30
    v_mfma_f32_16x16x32_bf16 v[100:103], v[184:187], v[196:199], v[100:103]
    ds_read_b128 v[144:147], v10 offset:45056
    v_add_f32 v16, v16, v31
    v_fmac_f32 v17, v31, v31
    v_mfma_f32_16x16x32_bf16 v[104:107], v[184:187], v[200:203], v[104:107]
    buffer_load_dwordx4 v3, s[52:55], s74 offen offset:2048 lds
    v_add_u32 v20, 23552, v18
    v_mfma_f32_16x16x32_bf16 v[108:111], v[184:187], v[204:207], v[108:111]
    ds_read_b128 v[148:151], v10 offset:46080
    s_lshl_b32 s83, s64, 11
    v_mfma_f32_16x16x32_bf16 v[124:127], v[188:191], v[204:207], v[124:127]
    s_add_u32 s83, s83, 143360
    v_lshl_add_u32 v22, v1, 3, s83
    v_mfma_f32_16x16x32_bf16 v[120:123], v[188:191], v[200:203], v[120:123]
    s_add_u32 s74, s74, 12288
    s_add_u32 m0, s71, 0
    v_lshl_add_u32 v23, v28, 4, s83
    v_mfma_f32_16x16x32_bf16 v[116:119], v[188:191], v[196:199], v[116:119]
    buffer_load_dwordx4 v2, s[48:51], s73 offen lds
    v_and_b32 v228, 15, v1
    v_mfma_f32_16x16x32_bf16 v[112:115], v[188:191], v[192:195], v[112:115]
    v_lshrrev_b32 v227, 1, v28
    s_waitcnt vmcnt(16)
    s_barrier
    s_waitcnt lgkmcnt(0)
    v_mfma_f32_16x16x32_bf16 v[32:35], v[128:131], v[152:155], v[32:35]
    v_add_u32 v6, 61440, v6
    v_lshlrev_b32 v30, 16, v220
    v_and_b32 v31, s77, v220
    v_mfma_f32_16x16x32_bf16 v[36:39], v[128:131], v[156:159], v[36:39]
    buffer_load_dwordx4 v2, s[48:51], s73 offen offset:1024 lds
    v_add_u32 v7, 61440, v7
    v_add_f32 v13, v13, v30
    v_mfma_f32_16x16x32_bf16 v[40:43], v[128:131], v[160:163], v[40:43]
    v_add_u32 v8, 61440, v8
    v_fmac_f32 v14, v30, v30
    v_mfma_f32_16x16x32_bf16 v[44:47], v[128:131], v[164:167], v[44:47]
    v_add_u32 v9, 61440, v9
    v_add_f32 v13, v13, v31
    v_mfma_f32_16x16x32_bf16 v[60:63], v[132:135], v[164:167], v[60:63]
    s_add_u32 m0, s72, 0
    s_add_u32 s73, s73, 8192
    v_add_u32 v10, 61440, v10
    v_fmac_f32 v14, v31, v31
    v_lshlrev_b32 v30, 16, v221
    v_mfma_f32_16x16x32_bf16 v[56:59], v[132:135], v[160:163], v[56:59]
    buffer_load_dwordx4 v3, s[52:55], s74 offen offset:0 lds
    ds_read_b128 v[168:171], v10 offset:0
    v_and_b32 v31, s77, v221
    v_mfma_f32_16x16x32_bf16 v[52:55], v[132:135], v[156:159], v[52:55]
    ds_read_b64_tr_b16 v[192:193], v6 offset:0
    v_add_f32 v13, v13, v30
    v_mfma_f32_16x16x32_bf16 v[48:51], v[132:135], v[152:155], v[48:51]
    ds_read_b64_tr_b16 v[194:195], v6 offset:1024
    v_fmac_f32 v14, v30, v30
    v_mfma_f32_16x16x32_bf16 v[64:67], v[136:139], v[152:155], v[64:67]
    buffer_load_dwordx4 v3, s[52:55], s74 offen offset:1024 lds
    ds_read_b64_tr_b16 v[196:197], v7 offset:0
    v_add_f32 v13, v13, v31
    v_fmac_f32 v14, v31, v31
    v_mfma_f32_16x16x32_bf16 v[68:71], v[136:139], v[156:159], v[68:71]
    ds_read_b64_tr_b16 v[198:199], v7 offset:1024
    v_lshlrev_b32 v30, 16, v222
    v_mfma_f32_16x16x32_bf16 v[72:75], v[136:139], v[160:163], v[72:75]
    ds_read_b128 v[172:175], v10 offset:1024
    v_and_b32 v31, s77, v222
    v_mfma_f32_16x16x32_bf16 v[76:79], v[136:139], v[164:167], v[76:79]
    ds_read_b64_tr_b16 v[200:201], v8 offset:0
    v_add_f32 v13, v13, v30
    v_mfma_f32_16x16x32_bf16 v[92:95], v[140:143], v[164:167], v[92:95]
    buffer_load_dwordx4 v3, s[52:55], s74 offen offset:2048 lds
    ds_read_b64_tr_b16 v[202:203], v8 offset:1024
    v_fmac_f32 v14, v30, v30
    v_add_f32 v13, v13, v31
    v_mfma_f32_16x16x32_bf16 v[88:91], v[140:143], v[160:163], v[88:91]
    ds_read_b64_tr_b16 v[204:205], v9 offset:0
    v_fmac_f32 v14, v31, v31
    v_mfma_f32_16x16x32_bf16 v[84:87], v[140:143], v[156:159], v[84:87]
    s_add_u32 s74, s74, 12288
    s_cmp_eq_u32 s73, 163840
    s_cselect_b32 s73, 0, s73
    s_cselect_b32 s74, 0, s74
    s_add_u32 m0, s71, 20480
    ds_read_b64_tr_b16 v[206:207], v9 offset:1024
    v_lshlrev_b32 v30, 16, v223
    v_mfma_f32_16x16x32_bf16 v[80:83], v[140:143], v[152:155], v[80:83]
    buffer_load_dwordx4 v2, s[48:51], s73 offen lds
    ds_read_b128 v[176:179], v10 offset:2048
    v_and_b32 v31, s77, v223
    v_mfma_f32_16x16x32_bf16 v[96:99], v[144:147], v[152:155], v[96:99]
    ds_read_b128 v[180:183], v10 offset:3072
    v_add_f32 v13, v13, v30
    v_fmac_f32 v14, v30, v30
    v_mfma_f32_16x16x32_bf16 v[100:103], v[144:147], v[156:159], v[100:103]
    ds_read_b128 v[184:187], v10 offset:4096
    v_add_f32 v13, v13, v31
    v_mfma_f32_16x16x32_bf16 v[104:107], v[144:147], v[160:163], v[104:107]
    buffer_load_dwordx4 v2, s[48:51], s73 offen offset:1024 lds
    ds_read_b128 v[188:191], v10 offset:5120
    v_fmac_f32 v14, v31, v31
    v_mfma_f32_16x16x32_bf16 v[108:111], v[144:147], v[164:167], v[108:111]
    v_mul_u32_u24 v227, 12288, v227
    v_mfma_f32_16x16x32_bf16 v[124:127], v[148:151], v[164:167], v[124:127]
    v_and_b32 v229, 1, v28
    v_lshl_add_u32 v227, v229, 11, v227
    v_mfma_f32_16x16x32_bf16 v[120:123], v[148:151], v[160:163], v[120:123]
    s_add_u32 m0, s72, 20480
    s_add_u32 s73, s73, 8192
    v_lshl_add_u32 v227, v228, 4, v227
    v_mfma_f32_16x16x32_bf16 v[116:119], v[148:151], v[156:159], v[116:119]
    buffer_load_dwordx4 v3, s[52:55], s74 offen offset:0 lds
    s_lshl_b32 s80, s69, 10
    v_mfma_f32_16x16x32_bf16 v[112:115], v[148:151], v[152:155], v[112:115]
    v_add_u32 v0, s80, v227
    s_waitcnt vmcnt(18)
    s_barrier
    s_waitcnt lgkmcnt(0)
    v_mfma_f32_16x16x32_bf16 v[32:35], v[168:171], v[192:195], v[32:35]
    ds_read_b128 v[128:131], v10 offset:20480
    v_permlane16_swap_b32 v16, v13
    v_mfma_f32_16x16x32_bf16 v[36:39], v[168:171], v[196:199], v[36:39]
    buffer_load_dwordx4 v3, s[52:55], s74 offen offset:1024 lds
    v_mfma_f32_16x16x32_bf16 v[40:43], v[168:171], v[200:203], v[40:43]
    ds_read_b64_tr_b16 v[152:153], v6 offset:20480
    v_permlane16_swap_b32 v17, v14
    v_mfma_f32_16x16x32_bf16 v[44:47], v[168:171], v[204:207], v[44:47]
    ds_read_b64_tr_b16 v[154:155], v6 offset:21504
    v_mfma_f32_16x16x32_bf16 v[60:63], v[172:175], v[204:207], v[60:63]
    buffer_load_dwordx4 v3, s[52:55], s74 offen offset:2048 lds
    v_add_f32 v16, v16, v13
    v_mfma_f32_16x16x32_bf16 v[56:59], v[172:175], v[200:203], v[56:59]
    s_add_u32 s74, s74, 12288
    s_add_u32 m0, s71, 40960
    ds_read_b64_tr_b16 v[156:157], v7 offset:20480
    v_mfma_f32_16x16x32_bf16 v[52:55], v[172:175], v[196:199], v[52:55]
    buffer_load_dwordx4 v2, s[48:51], s73 offen lds
    v_add_f32 v17, v17, v14
    v_mfma_f32_16x16x32_bf16 v[48:51], v[172:175], v[192:195], v[48:51]
    ds_read_b64_tr_b16 v[158:159], v7 offset:21504
    v_mfma_f32_16x16x32_bf16 v[64:67], v[176:179], v[192:195], v[64:67]
    ds_read_b128 v[132:135], v10 offset:21504
    v_mov_b32 v30, v16
    v_mfma_f32_16x16x32_bf16 v[68:71], v[176:179], v[196:199], v[68:71]
    buffer_load_dwordx4 v2, s[48:51], s73 offen offset:1024 lds
    v_mfma_f32_16x16x32_bf16 v[72:75], v[176:179], v[200:203], v[72:75]
    ds_read_b64_tr_b16 v[160:161], v8 offset:20480
    v_mov_b32 v31, v17
    v_mfma_f32_16x16x32_bf16 v[76:79], v[176:179], v[204:207], v[76:79]
    s_add_u32 m0, s72, 40960
    s_add_u32 s73, s73, 8192
    ds_read_b64_tr_b16 v[162:163], v8 offset:21504
    v_mfma_f32_16x16x32_bf16 v[92:95], v[180:183], v[204:207], v[92:95]
    buffer_load_dwordx4 v3, s[52:55], s74 offen offset:0 lds
    s_nop 0
    v_mfma_f32_16x16x32_bf16 v[88:91], v[180:183], v[200:203], v[88:91]
    ds_read_b64_tr_b16 v[164:165], v9 offset:20480
    v_mfma_f32_16x16x32_bf16 v[84:87], v[180:183], v[196:199], v[84:87]
    buffer_load_dwordx4 v3, s[52:55], s74 offen offset:1024 lds
    v_permlane32_swap_b32 v16, v30
    v_mfma_f32_16x16x32_bf16 v[80:83], v[180:183], v[192:195], v[80:83]
    ds_read_b64_tr_b16 v[166:167], v9 offset:21504
    v_mfma_f32_16x16x32_bf16 v[96:99], v[184:187], v[192:195], v[96:99]
    ds_read_b128 v[136:139], v10 offset:22528
    v_permlane32_swap_b32 v17, v31
    v_mfma_f32_16x16x32_bf16 v[100:103], v[184:187], v[196:199], v[100:103]
    buffer_load_dwordx4 v3, s[52:55], s74 offen offset:2048 lds
    v_mfma_f32_16x16x32_bf16 v[104:107], v[184:187], v[200:203], v[104:107]
    ds_read_b128 v[140:143], v10 offset:23552
    v_add_f32 v16, v16, v30
    v_mfma_f32_16x16x32_bf16 v[108:111], v[184:187], v[204:207], v[108:111]
    s_add_u32 s74, s74, 12288
    s_cmp_eq_u32 s73, 163840
    s_cselect_b32 s73, 0, s73
    s_cselect_b32 s74, 0, s74
    s_add_u32 s79, s75, 0
    ds_read_b128 v[144:147], v10 offset:24576
    v_mfma_f32_16x16x32_bf16 v[124:127], v[188:191], v[204:207], v[124:127]
    buffer_load_dwordx4 a[0:3], v4, s[56:59], s79 offen offset:0
    v_add_f32 v17, v17, v31
    v_mfma_f32_16x16x32_bf16 v[120:123], v[188:191], v[200:203], v[120:123]
    ds_read_b128 v[148:151], v10 offset:25600
    v_mfma_f32_16x16x32_bf16 v[116:119], v[188:191], v[196:199], v[116:119]
    buffer_load_dwordx4 a[4:7], v4, s[56:59], s79 offen offset:1024
    s_mov_b32 exec_hi, 0
    global_store_dwordx2 v25, v[16:17], s[46:47] sc1
    s_mov_b64 exec, -1
    v_mfma_f32_16x16x32_bf16 v[112:115], v[188:191], v[192:195], v[112:115]
    s_waitcnt vmcnt(23)
    s_barrier
    s_waitcnt lgkmcnt(0)
    v_mfma_f32_16x16x32_bf16 v[32:35], v[128:131], v[152:155], v[32:35]
    s_add_u32 m0, s71, 61440
    ds_read_b128 v[168:171], v10 offset:40960
    s_add_u32 s20, s64, 1
    v_mfma_f32_16x16x32_bf16 v[36:39], v[128:131], v[156:159], v[36:39]
    buffer_load_dwordx4 v2, s[48:51], s73 offen lds
    s_and_b32 s20, s20, 3
    v_mfma_f32_16x16x32_bf16 v[40:43], v[128:131], v[160:163], v[40:43]
    ds_read_b64_tr_b16 v[192:193], v6 offset:40960
    s_lshl_b32 s20, s20, 8
    v_mfma_f32_16x16x32_bf16 v[44:47], v[128:131], v[164:167], v[44:47]
    ds_read_b64_tr_b16 v[194:195], v6 offset:41984
    s_add_u32 s21, s64, 2
    v_mfma_f32_16x16x32_bf16 v[60:63], v[132:135], v[164:167], v[60:63]
    ds_read_b64_tr_b16 v[196:197], v7 offset:40960
    s_and_b32 s21, s21, 3
    v_mfma_f32_16x16x32_bf16 v[56:59], v[132:135], v[160:163], v[56:59]
    buffer_load_dwordx4 v2, s[48:51], s73 offen offset:1024 lds
    v_mfma_f32_16x16x32_bf16 v[52:55], v[132:135], v[156:159], v[52:55]
    ds_read_b64_tr_b16 v[198:199], v7 offset:41984
    s_lshl_b32 s21, s21, 8
    v_mfma_f32_16x16x32_bf16 v[48:51], v[132:135], v[152:155], v[48:51]
    s_add_u32 m0, s72, 61440
    s_add_u32 s73, s73, 8192
    ds_read_b128 v[172:175], v10 offset:41984
    s_add_u32 s22, s64, 3
    v_mfma_f32_16x16x32_bf16 v[64:67], v[136:139], v[152:155], v[64:67]
    buffer_load_dwordx4 v3, s[52:55], s74 offen offset:0 lds
    s_and_b32 s22, s22, 3
    v_mfma_f32_16x16x32_bf16 v[68:71], v[136:139], v[156:159], v[68:71]
    ds_read_b64_tr_b16 v[200:201], v8 offset:40960
    s_lshl_b32 s22, s22, 8
    v_mfma_f32_16x16x32_bf16 v[72:75], v[136:139], v[160:163], v[72:75]
    ds_read_b64_tr_b16 v[202:203], v8 offset:41984
    s_add_u32 s23, s64, 4
    v_mfma_f32_16x16x32_bf16 v[76:79], v[136:139], v[164:167], v[76:79]
    ds_read_b64_tr_b16 v[204:205], v9 offset:40960
    v_mfma_f32_16x16x32_bf16 v[92:95], v[140:143], v[164:167], v[92:95]
    buffer_load_dwordx4 v3, s[52:55], s74 offen offset:1024 lds
    s_and_b32 s23, s23, 3
    v_mfma_f32_16x16x32_bf16 v[88:91], v[140:143], v[160:163], v[88:91]
    ds_read_b64_tr_b16 v[206:207], v9 offset:41984
    s_lshl_b32 s23, s23, 8
    v_mfma_f32_16x16x32_bf16 v[84:87], v[140:143], v[156:159], v[84:87]
    ds_read_b128 v[176:179], v10 offset:43008
    s_mul_i32 s4, s84, 96
    v_mfma_f32_16x16x32_bf16 v[80:83], v[140:143], v[152:155], v[80:83]
    buffer_load_dwordx4 v3, s[52:55], s74 offen offset:2048 lds
    s_mul_i32 s5, s64, 24
    v_mfma_f32_16x16x32_bf16 v[96:99], v[144:147], v[152:155], v[96:99]
    ds_read_b128 v[180:183], v10 offset:44032
    s_add_u32 s4, s4, s5
    v_mfma_f32_16x16x32_bf16 v[100:103], v[144:147], v[156:159], v[100:103]
    s_add_u32 s74, s74, 12288
    ds_read_b128 v[184:187], v10 offset:45056
    v_mfma_f32_16x16x32_bf16 v[104:107], v[144:147], v[160:163], v[104:107]
    buffer_load_dwordx4 a[8:11], v4, s[56:59], s79 offen offset:2048
    s_lshl_b32 s4, s4, 12
    v_mfma_f32_16x16x32_bf16 v[108:111], v[144:147], v[164:167], v[108:111]
    ds_read_b128 v[188:191], v10 offset:46080
    s_add_u32 s5, s4, 4096
    v_mfma_f32_16x16x32_bf16 v[124:127], v[148:151], v[164:167], v[124:127]
    s_add_u32 s6, s4, 8192
    v_mfma_f32_16x16x32_bf16 v[120:123], v[148:151], v[160:163], v[120:123]
    s_add_u32 s7, s4, 24576
    v_mfma_f32_16x16x32_bf16 v[116:119], v[148:151], v[156:159], v[116:119]
    buffer_load_dwordx4 a[12:15], v4, s[56:59], s79 offen offset:3072
    s_add_u32 s8, s4, 28672
    v_mfma_f32_16x16x32_bf16 v[112:115], v[148:151], v[152:155], v[112:115]
    s_waitcnt vmcnt(25)
    s_barrier
    s_waitcnt lgkmcnt(0)
    v_mfma_f32_16x16x32_bf16 v[32:35], v[168:171], v[192:195], v[32:35]
    s_add_u32 m0, s71, 81920
    v_add_u32 v6, 61440, v6
    s_add_u32 s9, s4, 32768
    v_mfma_f32_16x16x32_bf16 v[36:39], v[168:171], v[196:199], v[36:39]
    buffer_load_dwordx4 v2, s[48:51], s73 offen lds
    v_add_u32 v7, 61440, v7
    s_add_u32 s10, s4, 49152
    v_mfma_f32_16x16x32_bf16 v[40:43], v[168:171], v[200:203], v[40:43]
    v_add_u32 v8, 61440, v8
    s_add_u32 s11, s4, 53248
    v_mfma_f32_16x16x32_bf16 v[44:47], v[168:171], v[204:207], v[44:47]
    v_add_u32 v9, 61440, v9
    v_mfma_f32_16x16x32_bf16 v[60:63], v[172:175], v[204:207], v[60:63]
    buffer_load_dwordx4 v2, s[48:51], s73 offen offset:1024 lds
    v_add_u32 v10, 61440, v10
    s_add_u32 s12, s4, 57344
    v_mfma_f32_16x16x32_bf16 v[56:59], v[172:175], v[200:203], v[56:59]
    ds_read_b128 v[128:131], v10 offset:0
    s_add_u32 s13, s4, 73728
    v_mfma_f32_16x16x32_bf16 v[52:55], v[172:175], v[196:199], v[52:55]
    s_add_u32 m0, s72, 81920
    s_add_u32 s73, s73, 8192
    ds_read_b64_tr_b16 v[152:153], v6 offset:0
    v_mfma_f32_16x16x32_bf16 v[48:51], v[172:175], v[192:195], v[48:51]
    buffer_load_dwordx4 v3, s[52:55], s74 offen offset:0 lds
    ds_read_b64_tr_b16 v[154:155], v6 offset:1024
    s_add_u32 s14, s4, 77824
    v_mfma_f32_16x16x32_bf16 v[64:67], v[176:179], v[192:195], v[64:67]
    ds_read_b64_tr_b16 v[156:157], v7 offset:0
    s_add_u32 s15, s4, 81920
    v_mfma_f32_16x16x32_bf16 v[68:71], v[176:179], v[196:199], v[68:71]
    ds_read_b64_tr_b16 v[158:159], v7 offset:1024
    s_mul_i32 s85, s67, 96
    v_mfma_f32_16x16x32_bf16 v[72:75], v[176:179], v[200:203], v[72:75]
    buffer_load_dwordx4 v3, s[52:55], s74 offen offset:1024 lds
    ds_read_b128 v[132:135], v10 offset:1024
    v_mfma_f32_16x16x32_bf16 v[76:79], v[176:179], v[204:207], v[76:79]
    ds_read_b64_tr_b16 v[160:161], v8 offset:0
    s_mul_i32 s24, s68, 6
    v_mfma_f32_16x16x32_bf16 v[92:95], v[180:183], v[204:207], v[92:95]
    ds_read_b64_tr_b16 v[162:163], v8 offset:1024
    s_add_u32 s85, s85, s24
    v_mfma_f32_16x16x32_bf16 v[88:91], v[180:183], v[200:203], v[88:91]
    buffer_load_dwordx4 v3, s[52:55], s74 offen offset:2048 lds
    ds_read_b64_tr_b16 v[164:165], v9 offset:0
    v_mfma_f32_16x16x32_bf16 v[84:87], v[180:183], v[196:199], v[84:87]
    ds_read_b64_tr_b16 v[166:167], v9 offset:1024
    s_and_b32 s24, s64, 1
    v_mfma_f32_16x16x32_bf16 v[80:83], v[180:183], v[192:195], v[80:83]
    s_add_u32 s74, s74, 12288
    s_cmp_eq_u32 s73, 163840
    s_cselect_b32 s73, 0, s73
    s_cselect_b32 s74, 0, s74
    ds_read_b128 v[136:139], v10 offset:2048
    s_mul_i32 s24, s24, 3
    v_mfma_f32_16x16x32_bf16 v[96:99], v[184:187], v[192:195], v[96:99]
    buffer_load_dwordx4 a[16:19], v5, s[56:59], s79 offen offset:0
    ds_read_b128 v[140:143], v10 offset:3072
    s_add_u32 s85, s85, s24
    v_mfma_f32_16x16x32_bf16 v[100:103], v[184:187], v[196:199], v[100:103]
    ds_read_b128 v[144:147], v10 offset:4096
    v_mfma_f32_16x16x32_bf16 v[104:107], v[184:187], v[200:203], v[104:107]
    s_add_u32 s79, s75, 15360
    ds_read_b128 v[148:151], v10 offset:5120
    s_lshl_b32 s85, s85, 12
    v_mfma_f32_16x16x32_bf16 v[108:111], v[184:187], v[204:207], v[108:111]
    buffer_load_dwordx4 a[60:63], v4, s[56:59], s79 offen offset:0
    s_mov_b32 s26, 0x9e3779b1
    v_mfma_f32_16x16x32_bf16 v[124:127], v[188:191], v[204:207], v[124:127]
    v_mfma_f32_16x16x32_bf16 v[120:123], v[188:191], v[200:203], v[120:123]
    v_mov_b32 v29, 2879488
    s_mov_b32 s27, 0xfffefffe
    v_mfma_f32_16x16x32_bf16 v[116:119], v[188:191], v[196:199], v[116:119]
    global_load_dword v29, v29, s[46:47]
    s_mov_b32 s28, 0x10001
    v_mfma_f32_16x16x32_bf16 v[112:115], v[188:191], v[192:195], v[112:115]
    s_waitcnt vmcnt(28)
    s_barrier
    s_waitcnt lgkmcnt(0)
    v_mfma_f32_16x16x32_bf16 v[32:35], v[128:131], v[152:155], v[32:35]
    s_add_u32 m0, s71, 102400
    v_add_u32 v6, 4294844416, v6
    v_mfma_f32_16x16x32_bf16 v[36:39], v[128:131], v[156:159], v[36:39]
    buffer_load_dwordx4 v2, s[48:51], s73 offen lds
    v_add_u32 v7, 4294844416, v7
    v_mfma_f32_16x16x32_bf16 v[40:43], v[128:131], v[160:163], v[40:43]
    v_add_u32 v8, 4294844416, v8
    v_mfma_f32_16x16x32_bf16 v[44:47], v[128:131], v[164:167], v[44:47]
    v_add_u32 v9, 4294844416, v9
    v_mfma_f32_16x16x32_bf16 v[60:63], v[132:135], v[164:167], v[60:63]
    buffer_load_dwordx4 v2, s[48:51], s73 offen offset:1024 lds
    v_add_u32 v10, 4294844416, v10
    v_mfma_f32_16x16x32_bf16 v[56:59], v[132:135], v[160:163], v[56:59]
    ds_read_b128 v[168:171], v10 offset:0
    v_mfma_f32_16x16x32_bf16 v[52:55], v[132:135], v[156:159], v[52:55]
    s_add_u32 m0, s72, 102400
    s_add_u32 s73, s73, 8192
    ds_read_b64_tr_b16 v[192:193], v6 offset:0
    v_mfma_f32_16x16x32_bf16 v[48:51], v[132:135], v[152:155], v[48:51]
    buffer_load_dwordx4 v3, s[52:55], s74 offen offset:0 lds
    ds_read_b64_tr_b16 v[194:195], v6 offset:1024
    v_mfma_f32_16x16x32_bf16 v[64:67], v[136:139], v[152:155], v[64:67]
    ds_read_b64_tr_b16 v[196:197], v7 offset:0
    v_mfma_f32_16x16x32_bf16 v[68:71], v[136:139], v[156:159], v[68:71]
    ds_read_b64_tr_b16 v[198:199], v7 offset:1024
    v_mfma_f32_16x16x32_bf16 v[72:75], v[136:139], v[160:163], v[72:75]
    buffer_load_dwordx4 v3, s[52:55], s74 offen offset:1024 lds
    ds_read_b128 v[172:175], v10 offset:1024
    v_mfma_f32_16x16x32_bf16 v[76:79], v[136:139], v[164:167], v[76:79]
    ds_read_b64_tr_b16 v[200:201], v8 offset:0
    v_mfma_f32_16x16x32_bf16 v[92:95], v[140:143], v[164:167], v[92:95]
    ds_read_b64_tr_b16 v[202:203], v8 offset:1024
    v_mfma_f32_16x16x32_bf16 v[88:91], v[140:143], v[160:163], v[88:91]
    buffer_load_dwordx4 v3, s[52:55], s74 offen offset:2048 lds
    ds_read_b64_tr_b16 v[204:205], v9 offset:0
    v_mfma_f32_16x16x32_bf16 v[84:87], v[140:143], v[156:159], v[84:87]
    ds_read_b64_tr_b16 v[206:207], v9 offset:1024
    v_mfma_f32_16x16x32_bf16 v[80:83], v[140:143], v[152:155], v[80:83]
    s_add_u32 s74, s74, 12288
    ds_read_b128 v[176:179], v10 offset:2048
    v_mfma_f32_16x16x32_bf16 v[96:99], v[144:147], v[152:155], v[96:99]
    buffer_load_dwordx4 a[64:67], v4, s[56:59], s79 offen offset:1024
    ds_read_b128 v[180:183], v10 offset:3072
    v_mfma_f32_16x16x32_bf16 v[100:103], v[144:147], v[156:159], v[100:103]
    ds_read_b128 v[184:187], v10 offset:4096
    v_mfma_f32_16x16x32_bf16 v[104:107], v[144:147], v[160:163], v[104:107]
    ds_read_b128 v[188:191], v10 offset:5120
    v_mfma_f32_16x16x32_bf16 v[108:111], v[144:147], v[164:167], v[108:111]
    buffer_load_dwordx4 a[68:71], v4, s[56:59], s79 offen offset:2048
    v_mfma_f32_16x16x32_bf16 v[124:127], v[148:151], v[164:167], v[124:127]
    v_mfma_f32_16x16x32_bf16 v[120:123], v[148:151], v[160:163], v[120:123]
    s_add_u32 m0, s76, 151552
    s_movk_i32 s80, 0
    v_mfma_f32_16x16x32_bf16 v[116:119], v[148:151], v[156:159], v[116:119]
    buffer_load_dwordx4 v21, s[16:19], s80 offen offset:0 lds
    v_mfma_f32_16x16x32_bf16 v[112:115], v[148:151], v[152:155], v[112:115]
    s_waitcnt vmcnt(31)
    s_barrier
    s_waitcnt lgkmcnt(0)
    v_mfma_f32_16x16x32_bf16 v[32:35], v[168:171], v[192:195], v[32:35]
    s_add_u32 m0, s71, 122880
    ds_read_b128 v[128:131], v10 offset:20480
    v_mfma_f32_16x16x32_bf16 v[36:39], v[168:171], v[196:199], v[36:39]
    buffer_load_dwordx4 v2, s[48:51], s73 offen lds
    v_mfma_f32_16x16x32_bf16 v[40:43], v[168:171], v[200:203], v[40:43]
    ds_read_b64_tr_b16 v[152:153], v6 offset:20480
    v_mfma_f32_16x16x32_bf16 v[44:47], v[168:171], v[204:207], v[44:47]
    ds_read_b64_tr_b16 v[154:155], v6 offset:21504
    v_mfma_f32_16x16x32_bf16 v[60:63], v[172:175], v[204:207], v[60:63]
    buffer_load_dwordx4 v2, s[48:51], s73 offen offset:1024 lds
    v_mfma_f32_16x16x32_bf16 v[56:59], v[172:175], v[200:203], v[56:59]
    ds_read_b64_tr_b16 v[156:157], v7 offset:20480
    v_mfma_f32_16x16x32_bf16 v[52:55], v[172:175], v[196:199], v[52:55]
    s_add_u32 m0, s72, 122880
    s_add_u32 s73, s73, 8192
    ds_read_b64_tr_b16 v[158:159], v7 offset:21504
    v_mfma_f32_16x16x32_bf16 v[48:51], v[172:175], v[192:195], v[48:51]
    buffer_load_dwordx4 v3, s[52:55], s74 offen offset:0 lds
    v_mfma_f32_16x16x32_bf16 v[64:67], v[176:179], v[192:195], v[64:67]
    ds_read_b128 v[132:135], v10 offset:21504
    v_mfma_f32_16x16x32_bf16 v[68:71], v[176:179], v[196:199], v[68:71]
    ds_read_b64_tr_b16 v[160:161], v8 offset:20480
    v_mfma_f32_16x16x32_bf16 v[72:75], v[176:179], v[200:203], v[72:75]
    buffer_load_dwordx4 v3, s[52:55], s74 offen offset:1024 lds
    v_mfma_f32_16x16x32_bf16 v[76:79], v[176:179], v[204:207], v[76:79]
    ds_read_b64_tr_b16 v[162:163], v8 offset:21504
    v_mfma_f32_16x16x32_bf16 v[92:95], v[180:183], v[204:207], v[92:95]
    ds_read_b64_tr_b16 v[164:165], v9 offset:20480
    v_mfma_f32_16x16x32_bf16 v[88:91], v[180:183], v[200:203], v[88:91]
    buffer_load_dwordx4 v3, s[52:55], s74 offen offset:2048 lds
    v_mfma_f32_16x16x32_bf16 v[84:87], v[180:183], v[196:199], v[84:87]
    ds_read_b64_tr_b16 v[166:167], v9 offset:21504
    v_mfma_f32_16x16x32_bf16 v[80:83], v[180:183], v[192:195], v[80:83]
    s_add_u32 s74, s74, 12288
    s_cmp_eq_u32 s73, 163840
    s_cselect_b32 s73, 0, s73
    s_cselect_b32 s74, 0, s74
    ds_read_b128 v[136:139], v10 offset:22528
    v_mfma_f32_16x16x32_bf16 v[96:99], v[184:187], v[192:195], v[96:99]
    buffer_load_dwordx4 a[72:75], v4, s[56:59], s79 offen offset:3072
    v_mfma_f32_16x16x32_bf16 v[100:103], v[184:187], v[196:199], v[100:103]
    ds_read_b128 v[140:143], v10 offset:23552
    v_mfma_f32_16x16x32_bf16 v[104:107], v[184:187], v[200:203], v[104:107]
    ds_read_b128 v[144:147], v10 offset:24576
    v_mfma_f32_16x16x32_bf16 v[108:111], v[184:187], v[204:207], v[108:111]
    buffer_load_dwordx4 a[76:79], v5, s[56:59], s79 offen offset:0
    v_mfma_f32_16x16x32_bf16 v[124:127], v[188:191], v[204:207], v[124:127]
    ds_read_b128 v[148:151], v10 offset:25600
    v_mfma_f32_16x16x32_bf16 v[120:123], v[188:191], v[200:203], v[120:123]
    s_add_u32 m0, s76, 151552
    s_movk_i32 s80, 1024
    v_mfma_f32_16x16x32_bf16 v[116:119], v[188:191], v[196:199], v[116:119]
    buffer_load_dwordx4 v21, s[16:19], s80 offen offset:1024 lds
    v_mfma_f32_16x16x32_bf16 v[112:115], v[188:191], v[192:195], v[112:115]
    s_waitcnt vmcnt(34)
    s_barrier
    s_waitcnt lgkmcnt(0)
    v_mfma_f32_16x16x32_bf16 v[32:35], v[128:131], v[152:155], v[32:35]
    s_add_u32 m0, s71, 0
    ds_read_b128 v[168:171], v10 offset:40960
    v_mfma_f32_16x16x32_bf16 v[36:39], v[128:131], v[156:159], v[36:39]
    buffer_load_dwordx4 v2, s[48:51], s73 offen lds
    v_mfma_f32_16x16x32_bf16 v[40:43], v[128:131], v[160:163], v[40:43]
    ds_read_b64_tr_b16 v[192:193], v6 offset:40960
    v_mfma_f32_16x16x32_bf16 v[44:47], v[128:131], v[164:167], v[44:47]
    ds_read_b64_tr_b16 v[194:195], v6 offset:41984
    v_mfma_f32_16x16x32_bf16 v[60:63], v[132:135], v[164:167], v[60:63]
    buffer_load_dwordx4 v2, s[48:51], s73 offen offset:1024 lds
    v_mfma_f32_16x16x32_bf16 v[56:59], v[132:135], v[160:163], v[56:59]
    ds_read_b64_tr_b16 v[196:197], v7 offset:40960
    v_mfma_f32_16x16x32_bf16 v[52:55], v[132:135], v[156:159], v[52:55]
    s_add_u32 m0, s72, 0
    s_add_u32 s73, s73, 8192
    ds_read_b64_tr_b16 v[198:199], v7 offset:41984
    v_mfma_f32_16x16x32_bf16 v[48:51], v[132:135], v[152:155], v[48:51]
    buffer_load_dwordx4 v3, s[52:55], s74 offen offset:0 lds
    v_mfma_f32_16x16x32_bf16 v[64:67], v[136:139], v[152:155], v[64:67]
    ds_read_b128 v[172:175], v10 offset:41984
    v_mfma_f32_16x16x32_bf16 v[68:71], v[136:139], v[156:159], v[68:71]
    ds_read_b64_tr_b16 v[200:201], v8 offset:40960
    v_mfma_f32_16x16x32_bf16 v[72:75], v[136:139], v[160:163], v[72:75]
    buffer_load_dwordx4 v3, s[52:55], s74 offen offset:1024 lds
    v_mfma_f32_16x16x32_bf16 v[76:79], v[136:139], v[164:167], v[76:79]
    ds_read_b64_tr_b16 v[202:203], v8 offset:41984
    v_mfma_f32_16x16x32_bf16 v[92:95], v[140:143], v[164:167], v[92:95]
    ds_read_b64_tr_b16 v[204:205], v9 offset:40960
    v_mfma_f32_16x16x32_bf16 v[88:91], v[140:143], v[160:163], v[88:91]
    buffer_load_dwordx4 v3, s[52:55], s74 offen offset:2048 lds
    v_mfma_f32_16x16x32_bf16 v[84:87], v[140:143], v[156:159], v[84:87]
    ds_read_b64_tr_b16 v[206:207], v9 offset:41984
    v_mfma_f32_16x16x32_bf16 v[80:83], v[140:143], v[152:155], v[80:83]
    s_add_u32 s74, s74, 12288
    s_add_u32 s79, s75, 30720
    ds_read_b128 v[176:179], v10 offset:43008
    v_mfma_f32_16x16x32_bf16 v[96:99], v[144:147], v[152:155], v[96:99]
    buffer_load_dwordx4 a[120:123], v4, s[56:59], s79 offen offset:0
    v_mfma_f32_16x16x32_bf16 v[100:103], v[144:147], v[156:159], v[100:103]
    ds_read_b128 v[180:183], v10 offset:44032
    v_mfma_f32_16x16x32_bf16 v[104:107], v[144:147], v[160:163], v[104:107]
    ds_read_b128 v[184:187], v10 offset:45056
    v_mfma_f32_16x16x32_bf16 v[108:111], v[144:147], v[164:167], v[108:111]
    buffer_load_dwordx4 a[124:127], v4, s[56:59], s79 offen offset:1024
    v_mfma_f32_16x16x32_bf16 v[124:127], v[148:151], v[164:167], v[124:127]
    ds_read_b128 v[188:191], v10 offset:46080
    v_mfma_f32_16x16x32_bf16 v[120:123], v[148:151], v[160:163], v[120:123]
    s_add_u32 m0, s76, 151552
    s_movk_i32 s80, 2048
    v_mfma_f32_16x16x32_bf16 v[116:119], v[148:151], v[156:159], v[116:119]
    buffer_load_dwordx4 v21, s[16:19], s80 offen offset:2048 lds
    v_mfma_f32_16x16x32_bf16 v[112:115], v[148:151], v[152:155], v[112:115]
    s_waitcnt vmcnt(34)
    s_barrier
    s_waitcnt lgkmcnt(0)
    v_mfma_f32_16x16x32_bf16 v[32:35], v[168:171], v[192:195], v[32:35]
    s_add_u32 m0, s71, 20480
    v_add_u32 v6, 61440, v6
    v_mfma_f32_16x16x32_bf16 v[36:39], v[168:171], v[196:199], v[36:39]
    buffer_load_dwordx4 v2, s[48:51], s73 offen lds
    v_add_u32 v7, 61440, v7
    v_mfma_f32_16x16x32_bf16 v[40:43], v[168:171], v[200:203], v[40:43]
    v_add_u32 v8, 61440, v8
    v_mfma_f32_16x16x32_bf16 v[44:47], v[168:171], v[204:207], v[44:47]
    v_add_u32 v9, 61440, v9
    v_mfma_f32_16x16x32_bf16 v[60:63], v[172:175], v[204:207], v[60:63]
    buffer_load_dwordx4 v2, s[48:51], s73 offen offset:1024 lds
    v_add_u32 v10, 61440, v10
    v_mfma_f32_16x16x32_bf16 v[56:59], v[172:175], v[200:203], v[56:59]
    s_add_u32 m0, s72, 20480
    s_add_u32 s73, s73, 8192
    ds_read_b128 v[128:131], v10 offset:0
    v_mfma_f32_16x16x32_bf16 v[52:55], v[172:175], v[196:199], v[52:55]
    buffer_load_dwordx4 v3, s[52:55], s74 offen offset:0 lds
    ds_read_b64_tr_b16 v[152:153], v6 offset:0
    v_mfma_f32_16x16x32_bf16 v[48:51], v[172:175], v[192:195], v[48:51]
    ds_read_b64_tr_b16 v[154:155], v6 offset:1024
    v_mfma_f32_16x16x32_bf16 v[64:67], v[176:179], v[192:195], v[64:67]
    ds_read_b64_tr_b16 v[156:157], v7 offset:0
    v_mfma_f32_16x16x32_bf16 v[68:71], v[176:179], v[196:199], v[68:71]
    buffer_load_dwordx4 v3, s[52:55], s74 offen offset:1024 lds
    ds_read_b64_tr_b16 v[158:159], v7 offset:1024
    v_mfma_f32_16x16x32_bf16 v[72:75], v[176:179], v[200:203], v[72:75]
    ds_read_b128 v[132:135], v10 offset:1024
    v_mfma_f32_16x16x32_bf16 v[76:79], v[176:179], v[204:207], v[76:79]
    ds_read_b64_tr_b16 v[160:161], v8 offset:0
    v_mfma_f32_16x16x32_bf16 v[92:95], v[180:183], v[204:207], v[92:95]
    buffer_load_dwordx4 v3, s[52:55], s74 offen offset:2048 lds
    ds_read_b64_tr_b16 v[162:163], v8 offset:1024
    v_mfma_f32_16x16x32_bf16 v[88:91], v[180:183], v[200:203], v[88:91]
    s_add_u32 s74, s74, 12288
    s_cmp_eq_u32 s73, 163840
    s_cselect_b32 s73, 0, s73
    s_cselect_b32 s74, 0, s74
    ds_read_b64_tr_b16 v[164:165], v9 offset:0
    v_mfma_f32_16x16x32_bf16 v[84:87], v[180:183], v[196:199], v[84:87]
    buffer_load_dwordx4 a[128:131], v4, s[56:59], s79 offen offset:2048
    ds_read_b64_tr_b16 v[166:167], v9 offset:1024
    v_mfma_f32_16x16x32_bf16 v[80:83], v[180:183], v[192:195], v[80:83]
    ds_read_b128 v[136:139], v10 offset:2048
    v_mfma_f32_16x16x32_bf16 v[96:99], v[184:187], v[192:195], v[96:99]
    ds_read_b128 v[140:143], v10 offset:3072
    v_mfma_f32_16x16x32_bf16 v[100:103], v[184:187], v[196:199], v[100:103]
    buffer_load_dwordx4 a[132:135], v4, s[56:59], s79 offen offset:3072
    ds_read_b128 v[144:147], v10 offset:4096
    v_mfma_f32_16x16x32_bf16 v[104:107], v[184:187], v[200:203], v[104:107]
    ds_read_b128 v[148:151], v10 offset:5120
    v_mfma_f32_16x16x32_bf16 v[108:111], v[184:187], v[204:207], v[108:111]
    s_mov_b32 m0, s83
    v_mfma_f32_16x16x32_bf16 v[124:127], v[188:191], v[204:207], v[124:127]
    global_load_lds_dwordx4 v18, s[46:47]
    v_mfma_f32_16x16x32_bf16 v[120:123], v[188:191], v[200:203], v[120:123]
    v_mfma_f32_16x16x32_bf16 v[116:119], v[188:191], v[196:199], v[116:119]
    global_load_lds_dwordx4 v20, s[46:47] offset:1024
    v_mfma_f32_16x16x32_bf16 v[112:115], v[188:191], v[192:195], v[112:115]
    s_waitcnt vmcnt(36)
    s_barrier
    s_waitcnt lgkmcnt(0)
    v_mfma_f32_16x16x32_bf16 v[32:35], v[128:131], v[152:155], v[32:35]
    s_add_u32 m0, s71, 40960
    ds_read_b128 v[168:171], v10 offset:20480
    v_mfma_f32_16x16x32_bf16 v[36:39], v[128:131], v[156:159], v[36:39]
    buffer_load_dwordx4 v2, s[48:51], s73 offen lds
    v_mfma_f32_16x16x32_bf16 v[40:43], v[128:131], v[160:163], v[40:43]
    ds_read_b64_tr_b16 v[192:193], v6 offset:20480
    v_mfma_f32_16x16x32_bf16 v[44:47], v[128:131], v[164:167], v[44:47]
    ds_read_b64_tr_b16 v[194:195], v6 offset:21504
    v_mfma_f32_16x16x32_bf16 v[60:63], v[132:135], v[164:167], v[60:63]
    ds_read_b64_tr_b16 v[196:197], v7 offset:20480
    v_mfma_f32_16x16x32_bf16 v[56:59], v[132:135], v[160:163], v[56:59]
    buffer_load_dwordx4 v2, s[48:51], s73 offen offset:1024 lds
    v_mfma_f32_16x16x32_bf16 v[52:55], v[132:135], v[156:159], v[52:55]
    ds_read_b64_tr_b16 v[198:199], v7 offset:21504
    v_mfma_f32_16x16x32_bf16 v[48:51], v[132:135], v[152:155], v[48:51]
    s_add_u32 m0, s72, 40960
    s_add_u32 s73, s73, 8192
    ds_read_b128 v[172:175], v10 offset:21504
    v_mfma_f32_16x16x32_bf16 v[64:67], v[136:139], v[152:155], v[64:67]
    buffer_load_dwordx4 v3, s[52:55], s74 offen offset:0 lds
    v_mfma_f32_16x16x32_bf16 v[68:71], v[136:139], v[156:159], v[68:71]
    ds_read_b64_tr_b16 v[200:201], v8 offset:20480
    v_mfma_f32_16x16x32_bf16 v[72:75], v[136:139], v[160:163], v[72:75]
    ds_read_b64_tr_b16 v[202:203], v8 offset:21504
    v_mfma_f32_16x16x32_bf16 v[76:79], v[136:139], v[164:167], v[76:79]
    ds_read_b64_tr_b16 v[204:205], v9 offset:20480
    v_mfma_f32_16x16x32_bf16 v[92:95], v[140:143], v[164:167], v[92:95]
    buffer_load_dwordx4 v3, s[52:55], s74 offen offset:1024 lds
    v_mfma_f32_16x16x32_bf16 v[88:91], v[140:143], v[160:163], v[88:91]
    ds_read_b64_tr_b16 v[206:207], v9 offset:21504
    v_mfma_f32_16x16x32_bf16 v[84:87], v[140:143], v[156:159], v[84:87]
    ds_read_b128 v[176:179], v10 offset:22528
    v_mfma_f32_16x16x32_bf16 v[80:83], v[140:143], v[152:155], v[80:83]
    buffer_load_dwordx4 v3, s[52:55], s74 offen offset:2048 lds
    v_mfma_f32_16x16x32_bf16 v[96:99], v[144:147], v[152:155], v[96:99]
    ds_read_b128 v[180:183], v10 offset:23552
    v_mfma_f32_16x16x32_bf16 v[100:103], v[144:147], v[156:159], v[100:103]
    s_add_u32 s74, s74, 12288
    ds_read_b128 v[184:187], v10 offset:24576
    v_mfma_f32_16x16x32_bf16 v[104:107], v[144:147], v[160:163], v[104:107]
    buffer_load_dwordx4 a[136:139], v5, s[56:59], s79 offen offset:0
    v_mfma_f32_16x16x32_bf16 v[108:111], v[144:147], v[164:167], v[108:111]
    ds_read_b128 v[188:191], v10 offset:25600
    v_mfma_f32_16x16x32_bf16 v[124:127], v[148:151], v[164:167], v[124:127]
    v_mfma_f32_16x16x32_bf16 v[120:123], v[148:151], v[160:163], v[120:123]
    s_add_u32 s79, s75, 46080
    v_mfma_f32_16x16x32_bf16 v[116:119], v[148:151], v[156:159], v[116:119]
    buffer_load_dwordx4 a[180:183], v4, s[56:59], s79 offen offset:0
    v_mfma_f32_16x16x32_bf16 v[112:115], v[148:151], v[152:155], v[112:115]
    s_waitcnt vmcnt(35)
    s_barrier
    s_waitcnt lgkmcnt(0)
    v_mfma_f32_16x16x32_bf16 v[32:35], v[168:171], v[192:195], v[32:35]
    s_add_u32 m0, s71, 61440
    ds_read_b128 v[128:131], v10 offset:40960
    v_mfma_f32_16x16x32_bf16 v[36:39], v[168:171], v[196:199], v[36:39]
    buffer_load_dwordx4 v2, s[48:51], s73 offen lds
    v_mfma_f32_16x16x32_bf16 v[40:43], v[168:171], v[200:203], v[40:43]
    ds_read_b64_tr_b16 v[152:153], v6 offset:40960
    v_mfma_f32_16x16x32_bf16 v[44:47], v[168:171], v[204:207], v[44:47]
    ds_read_b64_tr_b16 v[154:155], v6 offset:41984
    v_mfma_f32_16x16x32_bf16 v[60:63], v[172:175], v[204:207], v[60:63]
    ds_read_b64_tr_b16 v[156:157], v7 offset:40960
    v_mfma_f32_16x16x32_bf16 v[56:59], v[172:175], v[200:203], v[56:59]
    buffer_load_dwordx4 v2, s[48:51], s73 offen offset:1024 lds
    v_mfma_f32_16x16x32_bf16 v[52:55], v[172:175], v[196:199], v[52:55]
    ds_read_b64_tr_b16 v[158:159], v7 offset:41984
    v_mfma_f32_16x16x32_bf16 v[48:51], v[172:175], v[192:195], v[48:51]
    s_add_u32 m0, s72, 61440
    s_add_u32 s73, s73, 8192
    ds_read_b128 v[132:135], v10 offset:41984
    v_mfma_f32_16x16x32_bf16 v[64:67], v[176:179], v[192:195], v[64:67]
    buffer_load_dwordx4 v3, s[52:55], s74 offen offset:0 lds
    v_mfma_f32_16x16x32_bf16 v[68:71], v[176:179], v[196:199], v[68:71]
    ds_read_b64_tr_b16 v[160:161], v8 offset:40960
    v_mfma_f32_16x16x32_bf16 v[72:75], v[176:179], v[200:203], v[72:75]
    ds_read_b64_tr_b16 v[162:163], v8 offset:41984
    v_mfma_f32_16x16x32_bf16 v[76:79], v[176:179], v[204:207], v[76:79]
    ds_read_b64_tr_b16 v[164:165], v9 offset:40960
    v_mfma_f32_16x16x32_bf16 v[92:95], v[180:183], v[204:207], v[92:95]
    buffer_load_dwordx4 v3, s[52:55], s74 offen offset:1024 lds
    v_mfma_f32_16x16x32_bf16 v[88:91], v[180:183], v[200:203], v[88:91]
    ds_read_b64_tr_b16 v[166:167], v9 offset:41984
    v_mfma_f32_16x16x32_bf16 v[84:87], v[180:183], v[196:199], v[84:87]
    ds_read_b128 v[136:139], v10 offset:43008
    v_mfma_f32_16x16x32_bf16 v[80:83], v[180:183], v[192:195], v[80:83]
    buffer_load_dwordx4 v3, s[52:55], s74 offen offset:2048 lds
    v_mfma_f32_16x16x32_bf16 v[96:99], v[184:187], v[192:195], v[96:99]
    ds_read_b128 v[140:143], v10 offset:44032
    v_mfma_f32_16x16x32_bf16 v[100:103], v[184:187], v[196:199], v[100:103]
    s_add_u32 s74, s74, 12288
    s_cmp_eq_u32 s73, 163840
    s_cselect_b32 s73, 0, s73
    s_cselect_b32 s74, 0, s74
    ds_read_b128 v[144:147], v10 offset:45056
    v_mfma_f32_16x16x32_bf16 v[104:107], v[184:187], v[200:203], v[104:107]
    buffer_load_dwordx4 a[184:187], v4, s[56:59], s79 offen offset:1024
    v_mfma_f32_16x16x32_bf16 v[108:111], v[184:187], v[204:207], v[108:111]
    ds_read_b128 v[148:151], v10 offset:46080
    v_mfma_f32_16x16x32_bf16 v[124:127], v[188:191], v[204:207], v[124:127]
    v_mfma_f32_16x16x32_bf16 v[120:123], v[188:191], v[200:203], v[120:123]
    v_mfma_f32_16x16x32_bf16 v[116:119], v[188:191], v[196:199], v[116:119]
    buffer_load_dwordx4 a[188:191], v4, s[56:59], s79 offen offset:2048
    v_mfma_f32_16x16x32_bf16 v[112:115], v[188:191], v[192:195], v[112:115]
    s_waitcnt vmcnt(34)
    s_barrier
    s_waitcnt lgkmcnt(0)
    v_mfma_f32_16x16x32_bf16 v[32:35], v[128:131], v[152:155], v[32:35]
    s_add_u32 m0, s71, 81920
    v_add_u32 v6, 61440, v6
    v_mfma_f32_16x16x32_bf16 v[36:39], v[128:131], v[156:159], v[36:39]
    buffer_load_dwordx4 v2, s[48:51], s73 offen lds
    v_add_u32 v7, 61440, v7
    v_mfma_f32_16x16x32_bf16 v[40:43], v[128:131], v[160:163], v[40:43]
    v_add_u32 v8, 61440, v8
    v_mfma_f32_16x16x32_bf16 v[44:47], v[128:131], v[164:167], v[44:47]
    v_add_u32 v9, 61440, v9
    v_mfma_f32_16x16x32_bf16 v[60:63], v[132:135], v[164:167], v[60:63]
    v_add_u32 v10, 61440, v10
    v_mfma_f32_16x16x32_bf16 v[56:59], v[132:135], v[160:163], v[56:59]
    buffer_load_dwordx4 v2, s[48:51], s73 offen offset:1024 lds
    ds_read_b128 v[168:171], v10 offset:0
    v_mfma_f32_16x16x32_bf16 v[52:55], v[132:135], v[156:159], v[52:55]
    ds_read_b64_tr_b16 v[192:193], v6 offset:0
    v_mfma_f32_16x16x32_bf16 v[48:51], v[132:135], v[152:155], v[48:51]
    s_add_u32 m0, s72, 81920
    s_add_u32 s73, s73, 8192
    ds_read_b64_tr_b16 v[194:195], v6 offset:1024
    v_mfma_f32_16x16x32_bf16 v[64:67], v[136:139], v[152:155], v[64:67]
    buffer_load_dwordx4 v3, s[52:55], s74 offen offset:0 lds
    ds_read_b64_tr_b16 v[196:197], v7 offset:0
    v_mfma_f32_16x16x32_bf16 v[68:71], v[136:139], v[156:159], v[68:71]
    ds_read_b64_tr_b16 v[198:199], v7 offset:1024
    v_mfma_f32_16x16x32_bf16 v[72:75], v[136:139], v[160:163], v[72:75]
    ds_read_b128 v[172:175], v10 offset:1024
    v_mfma_f32_16x16x32_bf16 v[76:79], v[136:139], v[164:167], v[76:79]
    ds_read_b64_tr_b16 v[200:201], v8 offset:0
    v_mfma_f32_16x16x32_bf16 v[92:95], v[140:143], v[164:167], v[92:95]
    buffer_load_dwordx4 v3, s[52:55], s74 offen offset:1024 lds
    ds_read_b64_tr_b16 v[202:203], v8 offset:1024
    v_mfma_f32_16x16x32_bf16 v[88:91], v[140:143], v[160:163], v[88:91]
    ds_read_b64_tr_b16 v[204:205], v9 offset:0
    v_mfma_f32_16x16x32_bf16 v[84:87], v[140:143], v[156:159], v[84:87]
    ds_read_b64_tr_b16 v[206:207], v9 offset:1024
    v_mfma_f32_16x16x32_bf16 v[80:83], v[140:143], v[152:155], v[80:83]
    buffer_load_dwordx4 v3, s[52:55], s74 offen offset:2048 lds
    ds_read_b128 v[176:179], v10 offset:2048
    v_mfma_f32_16x16x32_bf16 v[96:99], v[144:147], v[152:155], v[96:99]
    ds_read_b128 v[180:183], v10 offset:3072
    v_mfma_f32_16x16x32_bf16 v[100:103], v[144:147], v[156:159], v[100:103]
    s_add_u32 s74, s74, 12288
    ds_read_b128 v[184:187], v10 offset:4096
    v_mfma_f32_16x16x32_bf16 v[104:107], v[144:147], v[160:163], v[104:107]
    buffer_load_dwordx4 a[192:195], v4, s[56:59], s79 offen offset:3072
    ds_read_b128 v[188:191], v10 offset:5120
    v_mfma_f32_16x16x32_bf16 v[108:111], v[144:147], v[164:167], v[108:111]
    v_mfma_f32_16x16x32_bf16 v[124:127], v[148:151], v[164:167], v[124:127]
    v_mfma_f32_16x16x32_bf16 v[120:123], v[148:151], v[160:163], v[120:123]
    v_mfma_f32_16x16x32_bf16 v[116:119], v[148:151], v[156:159], v[116:119]
    buffer_load_dwordx4 a[196:199], v5, s[56:59], s79 offen offset:0
    v_mfma_f32_16x16x32_bf16 v[112:115], v[148:151], v[152:155], v[112:115]
    s_waitcnt vmcnt(33)
    s_barrier
    s_waitcnt lgkmcnt(0)
    v_mfma_f32_16x16x32_bf16 v[32:35], v[168:171], v[192:195], v[32:35]
    s_add_u32 m0, s71, 102400
    v_add_u32 v6, 4294844416, v6
    v_mfma_f32_16x16x32_bf16 v[36:39], v[168:171], v[196:199], v[36:39]
    buffer_load_dwordx4 v2, s[48:51], s73 offen lds
    v_add_u32 v7, 4294844416, v7
    v_mfma_f32_16x16x32_bf16 v[40:43], v[168:171], v[200:203], v[40:43]
    v_add_u32 v8, 4294844416, v8
    v_mfma_f32_16x16x32_bf16 v[44:47], v[168:171], v[204:207], v[44:47]
    v_add_u32 v9, 4294844416, v9
    v_mfma_f32_16x16x32_bf16 v[60:63], v[172:175], v[204:207], v[60:63]
    v_add_u32 v10, 4294844416, v10
    v_mfma_f32_16x16x32_bf16 v[56:59], v[172:175], v[200:203], v[56:59]
    buffer_load_dwordx4 v2, s[48:51], s73 offen offset:1024 lds
    ds_read_b128 v[128:131], v10 offset:0
    v_mfma_f32_16x16x32_bf16 v[52:55], v[172:175], v[196:199], v[52:55]
    ds_read_b64_tr_b16 v[152:153], v6 offset:0
    v_mfma_f32_16x16x32_bf16 v[48:51], v[172:175], v[192:195], v[48:51]
    s_add_u32 m0, s72, 102400
    s_add_u32 s73, s73, 8192
    ds_read_b64_tr_b16 v[154:155], v6 offset:1024
    v_mfma_f32_16x16x32_bf16 v[64:67], v[176:179], v[192:195], v[64:67]
    buffer_load_dwordx4 v3, s[52:55], s74 offen offset:0 lds
    ds_read_b64_tr_b16 v[156:157], v7 offset:0
    v_mfma_f32_16x16x32_bf16 v[68:71], v[176:179], v[196:199], v[68:71]
    ds_read_b64_tr_b16 v[158:159], v7 offset:1024
    v_mfma_f32_16x16x32_bf16 v[72:75], v[176:179], v[200:203], v[72:75]
    ds_read_b128 v[132:135], v10 offset:1024
    v_mfma_f32_16x16x32_bf16 v[76:79], v[176:179], v[204:207], v[76:79]
    ds_read_b64_tr_b16 v[160:161], v8 offset:0
    v_mfma_f32_16x16x32_bf16 v[92:95], v[180:183], v[204:207], v[92:95]
    buffer_load_dwordx4 v3, s[52:55], s74 offen offset:1024 lds
    ds_read_b64_tr_b16 v[162:163], v8 offset:1024
    v_mfma_f32_16x16x32_bf16 v[88:91], v[180:183], v[200:203], v[88:91]
    ds_read_b64_tr_b16 v[164:165], v9 offset:0
    v_mfma_f32_16x16x32_bf16 v[84:87], v[180:183], v[196:199], v[84:87]
    ds_read_b64_tr_b16 v[166:167], v9 offset:1024
    v_mfma_f32_16x16x32_bf16 v[80:83], v[180:183], v[192:195], v[80:83]
    buffer_load_dwordx4 v3, s[52:55], s74 offen offset:2048 lds
    ds_read_b128 v[136:139], v10 offset:2048
    v_mfma_f32_16x16x32_bf16 v[96:99], v[184:187], v[192:195], v[96:99]
    ds_read_b128 v[140:143], v10 offset:3072
    v_mfma_f32_16x16x32_bf16 v[100:103], v[184:187], v[196:199], v[100:103]
    s_add_u32 s74, s74, 12288
    s_cmp_eq_u32 s73, 163840
    s_cselect_b32 s73, 0, s73
    s_cselect_b32 s74, 0, s74
    s_add_u32 s79, s75, 5120
    ds_read_b128 v[144:147], v10 offset:4096
    v_mfma_f32_16x16x32_bf16 v[104:107], v[184:187], v[200:203], v[104:107]
    buffer_load_dwordx4 a[20:23], v4, s[56:59], s79 offen offset:0
    ds_read_b128 v[148:151], v10 offset:5120
    v_mfma_f32_16x16x32_bf16 v[108:111], v[184:187], v[204:207], v[108:111]
    v_mfma_f32_16x16x32_bf16 v[124:127], v[188:191], v[204:207], v[124:127]
    v_mfma_f32_16x16x32_bf16 v[120:123], v[188:191], v[200:203], v[120:123]
    v_mfma_f32_16x16x32_bf16 v[116:119], v[188:191], v[196:199], v[116:119]
    buffer_load_dwordx4 a[24:27], v4, s[56:59], s79 offen offset:1024
    v_mfma_f32_16x16x32_bf16 v[112:115], v[188:191], v[192:195], v[112:115]
    s_waitcnt vmcnt(32)
    s_barrier
    s_waitcnt lgkmcnt(0)
    v_mfma_f32_16x16x32_bf16 v[32:35], v[128:131], v[152:155], v[32:35]
    ds_read_b128 v[168:171], v10 offset:20480
    v_mfma_f32_16x16x32_bf16 v[36:39], v[128:131], v[156:159], v[36:39]
    global_load_dwordx2 v[208:209], v15, s[46:47] offset:0 sc1
    v_mfma_f32_16x16x32_bf16 v[40:43], v[128:131], v[160:163], v[40:43]
    ds_read_b64_tr_b16 v[192:193], v6 offset:20480
    v_mfma_f32_16x16x32_bf16 v[44:47], v[128:131], v[164:167], v[44:47]
    global_load_dwordx2 v[210:211], v15, s[46:47] offset:1024 sc1
    v_mfma_f32_16x16x32_bf16 v[60:63], v[132:135], v[164:167], v[60:63]
    ds_read_b64_tr_b16 v[194:195], v6 offset:21504
    v_mfma_f32_16x16x32_bf16 v[56:59], v[132:135], v[160:163], v[56:59]
    ds_read_b64_tr_b16 v[196:197], v7 offset:20480
    v_mfma_f32_16x16x32_bf16 v[52:55], v[132:135], v[156:159], v[52:55]
    global_load_dwordx2 v[212:213], v15, s[46:47] offset:2048 sc1
    v_mfma_f32_16x16x32_bf16 v[48:51], v[132:135], v[152:155], v[48:51]
    ds_read_b64_tr_b16 v[198:199], v7 offset:21504
    v_mfma_f32_16x16x32_bf16 v[64:67], v[136:139], v[152:155], v[64:67]
    global_load_dwordx2 v[214:215], v15, s[46:47] offset:3072 sc1
    v_mfma_f32_16x16x32_bf16 v[68:71], v[136:139], v[156:159], v[68:71]
    ds_read_b128 v[172:175], v10 offset:21504
    v_mfma_f32_16x16x32_bf16 v[72:75], v[136:139], v[160:163], v[72:75]
    global_load_dwordx2 v[216:217], v24, s[46:47] offset:0 sc1
    v_mfma_f32_16x16x32_bf16 v[76:79], v[136:139], v[164:167], v[76:79]
    ds_read_b64_tr_b16 v[200:201], v8 offset:20480
    v_mfma_f32_16x16x32_bf16 v[92:95], v[140:143], v[164:167], v[92:95]
    ds_read_b64_tr_b16 v[202:203], v8 offset:21504
    v_mfma_f32_16x16x32_bf16 v[88:91], v[140:143], v[160:163], v[88:91]
    global_load_dwordx2 v[218:219], v15, s[46:47] offset:256 sc1
    v_mfma_f32_16x16x32_bf16 v[84:87], v[140:143], v[156:159], v[84:87]
    ds_read_b64_tr_b16 v[204:205], v9 offset:20480
    v_mfma_f32_16x16x32_bf16 v[80:83], v[140:143], v[152:155], v[80:83]
    global_load_dwordx2 v[220:221], v15, s[46:47] offset:1280 sc1
    v_mfma_f32_16x16x32_bf16 v[96:99], v[144:147], v[152:155], v[96:99]
    ds_read_b64_tr_b16 v[206:207], v9 offset:21504
    v_mfma_f32_16x16x32_bf16 v[100:103], v[144:147], v[156:159], v[100:103]
    ds_read_b128 v[176:179], v10 offset:22528
    v_mfma_f32_16x16x32_bf16 v[104:107], v[144:147], v[160:163], v[104:107]
    global_load_dwordx2 v[222:223], v15, s[46:47] offset:2304 sc1
    v_mfma_f32_16x16x32_bf16 v[108:111], v[144:147], v[164:167], v[108:111]
    ds_read_b128 v[180:183], v10 offset:23552
    v_mfma_f32_16x16x32_bf16 v[124:127], v[148:151], v[164:167], v[124:127]
    global_load_dwordx2 v[224:225], v15, s[46:47] offset:3328 sc1
    v_mfma_f32_16x16x32_bf16 v[120:123], v[148:151], v[160:163], v[120:123]
    ds_read_b128 v[184:187], v10 offset:24576
    v_mfma_f32_16x16x32_bf16 v[116:119], v[148:151], v[156:159], v[116:119]
    global_load_dwordx2 v[226:227], v24, s[46:47] offset:256 sc1
    v_mfma_f32_16x16x32_bf16 v[112:115], v[148:151], v[152:155], v[112:115]
    ds_read_b128 v[188:191], v10 offset:25600
    s_waitcnt vmcnt(33)
    s_barrier
    s_waitcnt lgkmcnt(0)
    v_mfma_f32_16x16x32_bf16 v[32:35], v[168:171], v[192:195], v[32:35]
    ds_read_b128 v[128:131], v10 offset:40960
    v_mfma_f32_16x16x32_bf16 v[36:39], v[168:171], v[196:199], v[36:39]
    ds_read_b64_tr_b16 v[152:153], v6 offset:40960
    v_mfma_f32_16x16x32_bf16 v[40:43], v[168:171], v[200:203], v[40:43]
    buffer_load_dwordx4 a[28:31], v4, s[56:59], s79 offen offset:2048
    v_mfma_f32_16x16x32_bf16 v[44:47], v[168:171], v[204:207], v[44:47]
    ds_read_b64_tr_b16 v[154:155], v6 offset:41984
    v_mfma_f32_16x16x32_bf16 v[60:63], v[172:175], v[204:207], v[60:63]
    ds_read_b64_tr_b16 v[156:157], v7 offset:40960
    v_mfma_f32_16x16x32_bf16 v[56:59], v[172:175], v[200:203], v[56:59]
    ds_read_b64_tr_b16 v[158:159], v7 offset:41984
    v_mfma_f32_16x16x32_bf16 v[52:55], v[172:175], v[196:199], v[52:55]
    buffer_load_dwordx4 a[32:35], v4, s[56:59], s79 offen offset:3072
    v_mfma_f32_16x16x32_bf16 v[48:51], v[172:175], v[192:195], v[48:51]
    ds_read_b128 v[132:135], v10 offset:41984
    v_mfma_f32_16x16x32_bf16 v[64:67], v[176:179], v[192:195], v[64:67]
    ds_read_b64_tr_b16 v[160:161], v8 offset:40960
    v_mfma_f32_16x16x32_bf16 v[68:71], v[176:179], v[196:199], v[68:71]
    ds_read_b64_tr_b16 v[162:163], v8 offset:41984
    v_mfma_f32_16x16x32_bf16 v[72:75], v[176:179], v[200:203], v[72:75]
    buffer_load_dwordx4 a[36:39], v5, s[56:59], s79 offen offset:0
    v_mfma_f32_16x16x32_bf16 v[76:79], v[176:179], v[204:207], v[76:79]
    ds_read_b64_tr_b16 v[164:165], v9 offset:40960
    v_mfma_f32_16x16x32_bf16 v[92:95], v[180:183], v[204:207], v[92:95]
    ds_read_b64_tr_b16 v[166:167], v9 offset:41984
    v_mfma_f32_16x16x32_bf16 v[88:91], v[180:183], v[200:203], v[88:91]
    s_add_u32 s79, s75, 20480
    ds_read_b128 v[136:139], v10 offset:43008
    v_mfma_f32_16x16x32_bf16 v[84:87], v[180:183], v[196:199], v[84:87]
    buffer_load_dwordx4 a[80:83], v4, s[56:59], s79 offen offset:0
    v_mfma_f32_16x16x32_bf16 v[80:83], v[180:183], v[192:195], v[80:83]
    ds_read_b128 v[140:143], v10 offset:44032
    v_mfma_f32_16x16x32_bf16 v[96:99], v[184:187], v[192:195], v[96:99]
    ds_read_b128 v[144:147], v10 offset:45056
    v_mfma_f32_16x16x32_bf16 v[100:103], v[184:187], v[196:199], v[100:103]
    ds_read_b128 v[148:151], v10 offset:46080
    v_mfma_f32_16x16x32_bf16 v[104:107], v[184:187], v[200:203], v[104:107]
    buffer_load_dwordx4 a[84:87], v4, s[56:59], s79 offen offset:1024
    v_mfma_f32_16x16x32_bf16 v[108:111], v[184:187], v[204:207], v[108:111]
    ds_read_b64 v[248:249], v22 offset:0
    v_mfma_f32_16x16x32_bf16 v[124:127], v[188:191], v[204:207], v[124:127]
    ds_read_b64 v[250:251], v22 offset:512
    v_mfma_f32_16x16x32_bf16 v[120:123], v[188:191], v[200:203], v[120:123]
    ds_read_b64 v[252:253], v22 offset:1024
    v_mfma_f32_16x16x32_bf16 v[116:119], v[188:191], v[196:199], v[116:119]
    buffer_load_dwordx4 a[88:91], v4, s[56:59], s79 offen offset:2048
    v_mfma_f32_16x16x32_bf16 v[112:115], v[188:191], v[192:195], v[112:115]
    ds_read_b64 v[254:255], v22 offset:1536
    s_waitcnt vmcnt(32)
    s_barrier
    s_waitcnt lgkmcnt(0)
    v_mfma_f32_16x16x32_bf16 v[32:35], v[128:131], v[152:155], v[32:35]
    v_add_u32 v6, 61440, v6
    v_add_f32 v248, v248, v250
    v_mfma_f32_16x16x32_bf16 v[36:39], v[128:131], v[156:159], v[36:39]
    v_add_u32 v7, 61440, v7
    v_mfma_f32_16x16x32_bf16 v[40:43], v[128:131], v[160:163], v[40:43]
    buffer_load_dwordx4 a[92:95], v4, s[56:59], s79 offen offset:3072
    v_add_u32 v8, 61440, v8
    v_mfma_f32_16x16x32_bf16 v[44:47], v[128:131], v[164:167], v[44:47]
    v_add_u32 v9, 61440, v9
    v_add_f32 v249, v249, v251
    v_mfma_f32_16x16x32_bf16 v[60:63], v[132:135], v[164:167], v[60:63]
    v_add_u32 v10, 61440, v10
    v_mfma_f32_16x16x32_bf16 v[56:59], v[132:135], v[160:163], v[56:59]
    ds_read_b128 v[168:171], v10 offset:0
    v_mfma_f32_16x16x32_bf16 v[52:55], v[132:135], v[156:159], v[52:55]
    buffer_load_dwordx4 a[96:99], v5, s[56:59], s79 offen offset:0
    ds_read_b64_tr_b16 v[192:193], v6 offset:0
    v_add_f32 v252, v252, v254
    v_mfma_f32_16x16x32_bf16 v[48:51], v[132:135], v[152:155], v[48:51]
    ds_read_b64_tr_b16 v[194:195], v6 offset:1024
    v_mfma_f32_16x16x32_bf16 v[64:67], v[136:139], v[152:155], v[64:67]
    ds_read_b64_tr_b16 v[196:197], v7 offset:0
    v_mfma_f32_16x16x32_bf16 v[68:71], v[136:139], v[156:159], v[68:71]
    s_add_u32 s79, s75, 35840
    ds_read_b64_tr_b16 v[198:199], v7 offset:1024
    v_mfma_f32_16x16x32_bf16 v[72:75], v[136:139], v[160:163], v[72:75]
    buffer_load_dwordx4 a[140:143], v4, s[56:59], s79 offen offset:0
    ds_read_b128 v[172:175], v10 offset:1024
    v_add_f32 v253, v253, v255
    v_mfma_f32_16x16x32_bf16 v[76:79], v[136:139], v[164:167], v[76:79]
    ds_read_b64_tr_b16 v[200:201], v8 offset:0
    v_mfma_f32_16x16x32_bf16 v[92:95], v[140:143], v[164:167], v[92:95]
    ds_read_b64_tr_b16 v[202:203], v8 offset:1024
    v_mfma_f32_16x16x32_bf16 v[88:91], v[140:143], v[160:163], v[88:91]
    ds_read_b64_tr_b16 v[204:205], v9 offset:0
    v_add_f32 v248, v248, v252
    v_mfma_f32_16x16x32_bf16 v[84:87], v[140:143], v[156:159], v[84:87]
    buffer_load_dwordx4 a[144:147], v4, s[56:59], s79 offen offset:1024
    ds_read_b64_tr_b16 v[206:207], v9 offset:1024
    v_mfma_f32_16x16x32_bf16 v[80:83], v[140:143], v[152:155], v[80:83]
    ds_read_b128 v[176:179], v10 offset:2048
    v_mfma_f32_16x16x32_bf16 v[96:99], v[144:147], v[152:155], v[96:99]
    ds_read_b128 v[180:183], v10 offset:3072
    v_mfma_f32_16x16x32_bf16 v[100:103], v[144:147], v[156:159], v[100:103]
    ds_read_b128 v[184:187], v10 offset:4096
    v_add_f32 v249, v249, v253
    v_mfma_f32_16x16x32_bf16 v[104:107], v[144:147], v[160:163], v[104:107]
    buffer_load_dwordx4 a[148:151], v4, s[56:59], s79 offen offset:2048
    ds_read_b128 v[188:191], v10 offset:5120
    v_mfma_f32_16x16x32_bf16 v[108:111], v[144:147], v[164:167], v[108:111]
    v_mfma_f32_16x16x32_bf16 v[124:127], v[148:151], v[164:167], v[124:127]
    ds_write_b64 v22, v[248:249]
    v_mfma_f32_16x16x32_bf16 v[120:123], v[148:151], v[160:163], v[120:123]
    v_mfma_f32_16x16x32_bf16 v[116:119], v[148:151], v[156:159], v[116:119]
    buffer_load_dwordx4 a[152:155], v4, s[56:59], s79 offen offset:3072
    v_mfma_f32_16x16x32_bf16 v[112:115], v[148:151], v[152:155], v[112:115]
    s_waitcnt vmcnt(31)
    s_barrier
    s_waitcnt vmcnt(12)
    s_waitcnt lgkmcnt(1)
    v_mfma_f32_16x16x32_bf16 v[32:35], v[168:171], v[192:195], v[32:35]
    ds_read_b128 v[128:131], v10 offset:20480
    v_max3_u32 v28, v208, v209, v210
    v_max3_u32 v28, v28, v211, v212
    v_mfma_f32_16x16x32_bf16 v[36:39], v[168:171], v[196:199], v[36:39]
    ds_read_b64_tr_b16 v[152:153], v6 offset:20480
    v_max3_u32 v28, v28, v213, v214
    v_max3_u32 v28, v28, v215, v216
    v_mfma_f32_16x16x32_bf16 v[40:43], v[168:171], v[200:203], v[40:43]
    buffer_load_dwordx4 a[156:159], v5, s[56:59], s79 offen offset:0
    v_max3_u32 v28, v28, v217, v218
    v_mfma_f32_16x16x32_bf16 v[44:47], v[168:171], v[204:207], v[44:47]
    ds_read_b64_tr_b16 v[154:155], v6 offset:21504
    v_max3_u32 v28, v28, v219, v220
    v_max3_u32 v28, v28, v221, v222
    v_mfma_f32_16x16x32_bf16 v[60:63], v[172:175], v[204:207], v[60:63]
    ds_read_b64_tr_b16 v[156:157], v7 offset:20480
    v_max3_u32 v28, v28, v223, v224
    v_max3_u32 v28, v28, v225, v226
    v_mfma_f32_16x16x32_bf16 v[56:59], v[172:175], v[200:203], v[56:59]
    s_add_u32 s79, s75, 51200
    ds_read_b64_tr_b16 v[158:159], v7 offset:21504
    v_max_u32 v28, v28, v227
    v_mfma_f32_16x16x32_bf16 v[52:55], v[172:175], v[196:199], v[52:55]
    buffer_load_dwordx4 a[200:203], v4, s[56:59], s79 offen offset:0
    v_add_f32 v208, v208, v210
    v_add_f32 v212, v212, v214
    v_mfma_f32_16x16x32_bf16 v[48:51], v[172:175], v[192:195], v[48:51]
    ds_read_b128 v[132:135], v10 offset:21504
    v_add_f32 v208, v208, v216
    v_add_f32 v208, v208, v212
    v_mfma_f32_16x16x32_bf16 v[64:67], v[176:179], v[192:195], v[64:67]
    ds_read_b64_tr_b16 v[160:161], v8 offset:20480
    v_mov_b32 v210, v208
    v_mfma_f32_16x16x32_bf16 v[68:71], v[176:179], v[196:199], v[68:71]
    ds_read_b64_tr_b16 v[162:163], v8 offset:21504
    v_add_f32 v209, v209, v211
    v_add_f32 v213, v213, v215
    v_mfma_f32_16x16x32_bf16 v[72:75], v[176:179], v[200:203], v[72:75]
    buffer_load_dwordx4 a[204:207], v4, s[56:59], s79 offen offset:1024
    v_add_f32 v209, v209, v217
    v_add_f32 v209, v209, v213
    v_mfma_f32_16x16x32_bf16 v[76:79], v[176:179], v[204:207], v[76:79]
    ds_read_b64_tr_b16 v[164:165], v9 offset:20480
    v_mov_b32 v211, v209
    v_mfma_f32_16x16x32_bf16 v[92:95], v[180:183], v[204:207], v[92:95]
    ds_read_b64_tr_b16 v[166:167], v9 offset:21504
    v_add_f32 v218, v218, v220
    v_add_f32 v222, v222, v224
    v_mfma_f32_16x16x32_bf16 v[88:91], v[180:183], v[200:203], v[88:91]
    ds_read_b128 v[136:139], v10 offset:22528
    v_add_f32 v218, v218, v226
    v_add_f32 v218, v218, v222
    v_mfma_f32_16x16x32_bf16 v[84:87], v[180:183], v[196:199], v[84:87]
    buffer_load_dwordx4 a[208:211], v4, s[56:59], s79 offen offset:2048
    v_mov_b32 v220, v218
    v_mfma_f32_16x16x32_bf16 v[80:83], v[180:183], v[192:195], v[80:83]
    ds_read_b128 v[140:143], v10 offset:23552
    v_add_f32 v219, v219, v221
    v_add_f32 v223, v223, v225
    v_mfma_f32_16x16x32_bf16 v[96:99], v[184:187], v[192:195], v[96:99]
    ds_read_b128 v[144:147], v10 offset:24576
    v_add_f32 v219, v219, v227
    v_add_f32 v219, v219, v223
    v_mfma_f32_16x16x32_bf16 v[100:103], v[184:187], v[196:199], v[100:103]
    ds_read_b128 v[148:151], v10 offset:25600
    v_mov_b32 v221, v219
    v_mfma_f32_16x16x32_bf16 v[104:107], v[184:187], v[200:203], v[104:107]
    buffer_load_dwordx4 a[212:215], v4, s[56:59], s79 offen offset:3072
    v_permlane32_swap_b32 v208, v210
    v_permlane32_swap_b32 v209, v211
    v_mfma_f32_16x16x32_bf16 v[108:111], v[184:187], v[204:207], v[108:111]
    v_permlane32_swap_b32 v218, v220
    v_permlane32_swap_b32 v219, v221
    v_mfma_f32_16x16x32_bf16 v[124:127], v[188:191], v[204:207], v[124:127]
    v_add_f32 v208, v208, v210
    v_mfma_f32_16x16x32_bf16 v[120:123], v[188:191], v[200:203], v[120:123]
    v_add_f32 v209, v209, v211
    v_mul_f32 v208, 0xbacccccd, v208
    v_mfma_f32_16x16x32_bf16 v[116:119], v[188:191], v[196:199], v[116:119]
    buffer_load_dwordx4 a[216:219], v5, s[56:59], s79 offen offset:0
    v_mul_f32 v209, 0x3acccccd, v209
    v_fma_f32 v209, -v208, v208, v209
    v_mfma_f32_16x16x32_bf16 v[112:115], v[188:191], v[192:195], v[112:115]
    v_max_f32 v209, 0, v209
    s_barrier
    s_waitcnt lgkmcnt(0)
    v_mfma_f32_16x16x32_bf16 v[32:35], v[128:131], v[152:155], v[32:35]
    ds_read_b128 v[168:171], v10 offset:40960
    v_cvt_pk_bf16_f32 v209, v208, v209
    v_lshlrev_b32 v232, 16, v209
    v_mfma_f32_16x16x32_bf16 v[36:39], v[128:131], v[156:159], v[36:39]
    s_add_u32 s79, s75, 10240
    ds_read_b64_tr_b16 v[192:193], v6 offset:40960
    v_and_b32 v209, s77, v209
    v_add_f32 v209, 0x3727c5ac, v209
    v_mfma_f32_16x16x32_bf16 v[40:43], v[128:131], v[160:163], v[40:43]
    buffer_load_dwordx4 a[40:43], v4, s[56:59], s79 offen offset:0
    v_cvt_pk_bf16_f32 v209, v209, v209
    v_and_b32 v209, s77, v209
    v_mfma_f32_16x16x32_bf16 v[44:47], v[128:131], v[164:167], v[44:47]
    ds_read_b64_tr_b16 v[194:195], v6 offset:41984
    v_sqrt_f32 v209, v209
    v_mov_b32 v234, v232
    v_mfma_f32_16x16x32_bf16 v[60:63], v[132:135], v[164:167], v[60:63]
    ds_read_b64_tr_b16 v[196:197], v7 offset:40960
    v_cvt_pk_bf16_f32 v209, v209, v209
    v_and_b32 v209, s77, v209
    v_mfma_f32_16x16x32_bf16 v[56:59], v[132:135], v[160:163], v[56:59]
    ds_read_b64_tr_b16 v[198:199], v7 offset:41984
    v_rcp_f32 v233, v209
    v_mfma_f32_16x16x32_bf16 v[52:55], v[132:135], v[156:159], v[52:55]
    buffer_load_dwordx4 a[44:47], v4, s[56:59], s79 offen offset:1024
    v_mul_f32 v240, v209, v209
    v_mul_f32 v240, 0x3f7f4f87, v240
    v_mfma_f32_16x16x32_bf16 v[48:51], v[132:135], v[152:155], v[48:51]
    ds_read_b128 v[172:175], v10 offset:41984
    v_mul_f32 v233, 0xbfb8aa3b, v233
    v_mov_b32 v241, v240
    v_mfma_f32_16x16x32_bf16 v[64:67], v[136:139], v[152:155], v[64:67]
    ds_read_b64_tr_b16 v[200:201], v8 offset:40960
    v_mov_b32 v235, v233
    v_add_f32 v218, v218, v220
    v_mfma_f32_16x16x32_bf16 v[68:71], v[136:139], v[156:159], v[68:71]
    ds_read_b64_tr_b16 v[202:203], v8 offset:41984
    v_add_f32 v219, v219, v221
    v_mul_f32 v218, 0xbacccccd, v218
    v_mfma_f32_16x16x32_bf16 v[72:75], v[136:139], v[160:163], v[72:75]
    buffer_load_dwordx4 a[48:51], v4, s[56:59], s79 offen offset:2048
    v_mul_f32 v219, 0x3acccccd, v219
    v_fma_f32 v219, -v218, v218, v219
    v_mfma_f32_16x16x32_bf16 v[76:79], v[136:139], v[164:167], v[76:79]
    ds_read_b64_tr_b16 v[204:205], v9 offset:40960
    v_max_f32 v219, 0, v219
    v_mfma_f32_16x16x32_bf16 v[92:95], v[140:143], v[164:167], v[92:95]
    ds_read_b64_tr_b16 v[206:207], v9 offset:41984
    v_cvt_pk_bf16_f32 v219, v218, v219
    v_lshlrev_b32 v236, 16, v219
    v_mfma_f32_16x16x32_bf16 v[88:91], v[140:143], v[160:163], v[88:91]
    ds_read_b128 v[176:179], v10 offset:43008
    v_and_b32 v219, s77, v219
    v_add_f32 v219, 0x3727c5ac, v219
    v_mfma_f32_16x16x32_bf16 v[84:87], v[140:143], v[156:159], v[84:87]
    buffer_load_dwordx4 a[52:55], v4, s[56:59], s79 offen offset:3072
    v_cvt_pk_bf16_f32 v219, v219, v219
    v_and_b32 v219, s77, v219
    v_mfma_f32_16x16x32_bf16 v[80:83], v[140:143], v[152:155], v[80:83]
    ds_read_b128 v[180:183], v10 offset:44032
    v_sqrt_f32 v219, v219
    v_mov_b32 v238, v236
    v_mfma_f32_16x16x32_bf16 v[96:99], v[144:147], v[152:155], v[96:99]
    ds_read_b128 v[184:187], v10 offset:45056
    v_cvt_pk_bf16_f32 v219, v219, v219
    v_and_b32 v219, s77, v219
    v_mfma_f32_16x16x32_bf16 v[100:103], v[144:147], v[156:159], v[100:103]
    ds_read_b128 v[188:191], v10 offset:46080
    v_rcp_f32 v237, v219
    v_mfma_f32_16x16x32_bf16 v[104:107], v[144:147], v[160:163], v[104:107]
    buffer_load_dwordx4 a[56:59], v5, s[56:59], s79 offen offset:0
    v_mul_f32 v242, v219, v219
    v_mul_f32 v242, 0x3f7f4f87, v242
    v_mfma_f32_16x16x32_bf16 v[108:111], v[144:147], v[164:167], v[108:111]
    v_mul_f32 v237, 0xbfb8aa3b, v237
    v_mov_b32 v243, v242
    v_mfma_f32_16x16x32_bf16 v[124:127], v[148:151], v[164:167], v[124:127]
    v_mov_b32 v239, v237
    v_permlane16_swap_b32 v232, v234
    v_mfma_f32_16x16x32_bf16 v[120:123], v[148:151], v[160:163], v[120:123]
    s_add_u32 s79, s75, 25600
    v_permlane16_swap_b32 v240, v241
    v_permlane16_swap_b32 v233, v235
    v_mfma_f32_16x16x32_bf16 v[116:119], v[148:151], v[156:159], v[116:119]
    buffer_load_dwordx4 a[100:103], v4, s[56:59], s79 offen offset:0
    v_permlane16_swap_b32 v236, v238
    v_permlane16_swap_b32 v242, v243
    v_mfma_f32_16x16x32_bf16 v[112:115], v[148:151], v[152:155], v[112:115]
    v_permlane16_swap_b32 v237, v239
    s_waitcnt lgkmcnt(0)
    v_mfma_f32_16x16x32_bf16 v[32:35], v[168:171], v[192:195], v[32:35]
    ds_read_b128 v[244:247], v23 offset:0
    s_mov_b32 s80, s85
    v_mfma_f32_16x16x32_bf16 v[36:39], v[168:171], v[196:199], v[36:39]
    ds_read_b128 v[248:251], v23 offset:64
    v_mul_lo_u32 v29, v29, s26
    v_mfma_f32_16x16x32_bf16 v[40:43], v[168:171], v[200:203], v[40:43]
    buffer_load_dwordx4 a[104:107], v4, s[56:59], s79 offen offset:1024
    v_and_b32 v30, 3, v1
    v_mfma_f32_16x16x32_bf16 v[44:47], v[168:171], v[204:207], v[44:47]
    ds_read_b128 v[252:255], v23 offset:128
    v_mfma_f32_16x16x32_bf16 v[60:63], v[172:175], v[204:207], v[60:63]
    ds_read_b128 v[216:219], v23 offset:192
    v_lshlrev_b32 v30, 3, v30
    v_mfma_f32_16x16x32_bf16 v[56:59], v[172:175], v[200:203], v[56:59]
    ds_read_b128 v[220:223], v23 offset:256
    v_lshrrev_b32 v30, v30, v29
    v_mfma_f32_16x16x32_bf16 v[52:55], v[172:175], v[196:199], v[52:55]
    buffer_load_dwordx4 a[108:111], v4, s[56:59], s79 offen offset:2048
    v_mfma_f32_16x16x32_bf16 v[48:51], v[172:175], v[192:195], v[48:51]
    ds_read_b128 v[224:227], v23 offset:320
    v_bfe_u32 v31, v30, 1, 1
    v_mfma_f32_16x16x32_bf16 v[64:67], v[176:179], v[192:195], v[64:67]
    v_bfe_u32 v6, v30, 0, 1
    v_mfma_f32_16x16x32_bf16 v[68:71], v[176:179], v[196:199], v[68:71]
    v_lshl_or_b32 v6, v31, 16, v6
    v_mfma_f32_16x16x32_bf16 v[72:75], v[176:179], v[200:203], v[72:75]
    buffer_load_dwordx4 a[112:115], v4, s[56:59], s79 offen offset:3072
    v_mfma_f32_16x16x32_bf16 v[76:79], v[176:179], v[204:207], v[76:79]
    v_bfe_u32 v31, v30, 3, 1
    v_mfma_f32_16x16x32_bf16 v[92:95], v[180:183], v[204:207], v[92:95]
    v_bfe_u32 v7, v30, 2, 1
    v_mfma_f32_16x16x32_bf16 v[88:91], v[180:183], v[200:203], v[88:91]
    v_mfma_f32_16x16x32_bf16 v[84:87], v[180:183], v[196:199], v[84:87]
    buffer_load_dwordx4 a[116:119], v5, s[56:59], s79 offen offset:0
    v_lshl_or_b32 v7, v31, 16, v7
    v_mfma_f32_16x16x32_bf16 v[80:83], v[180:183], v[192:195], v[80:83]
    v_bfe_u32 v31, v30, 5, 1
    v_mfma_f32_16x16x32_bf16 v[96:99], v[184:187], v[192:195], v[96:99]
    v_bfe_u32 v8, v30, 4, 1
    v_mfma_f32_16x16x32_bf16 v[100:103], v[184:187], v[196:199], v[100:103]
    s_add_u32 s79, s75, 40960
    v_mfma_f32_16x16x32_bf16 v[104:107], v[184:187], v[200:203], v[104:107]
    buffer_load_dwordx4 a[160:163], v4, s[56:59], s79 offen offset:0
    v_lshl_or_b32 v8, v31, 16, v8
    v_mfma_f32_16x16x32_bf16 v[108:111], v[184:187], v[204:207], v[108:111]
    v_bfe_u32 v31, v30, 7, 1
    v_mfma_f32_16x16x32_bf16 v[124:127], v[188:191], v[204:207], v[124:127]
    v_mfma_f32_16x16x32_bf16 v[120:123], v[188:191], v[200:203], v[120:123]
    v_bfe_u32 v9, v30, 6, 1
    v_mfma_f32_16x16x32_bf16 v[116:119], v[188:191], v[196:199], v[116:119]
    buffer_load_dwordx4 a[164:167], v4, s[56:59], s79 offen offset:1024
    v_lshl_or_b32 v9, v31, 16, v9
    v_mfma_f32_16x16x32_bf16 v[112:115], v[188:191], v[192:195], v[112:115]
    v_cmp_eq_u32 vcc, -1, v28
    s_cbranch_vccnz LB_restat
LB_g1:
    s_waitcnt lgkmcnt(0)
    v_pk_fma_f32 v[32:33], v[244:245], v[232:233], v[32:33] op_sel_hi:[1,0,1]
    v_pk_fma_f32 v[48:49], v[248:249], v[232:233], v[48:49] op_sel_hi:[1,0,1]
    v_pk_mul_f32 v[128:129], v[32:33], v[232:233] op_sel:[0,1] op_sel_hi:[1,1]
    v_exp_f32 v128, v128
    v_exp_f32 v129, v129
    v_pk_mul_f32 v[32:33], v[32:33], v[48:49]
    v_pk_fma_f32 v[128:129], v[128:129], v[240:241], v[240:241] op_sel:[0,0,0] op_sel_hi:[1,0,0]
    v_rcp_f32 v128, v128
    v_rcp_f32 v129, v129
    v_pk_fma_f32 v[34:35], v[246:247], v[232:233], v[34:35] op_sel_hi:[1,0,1]
    v_pk_fma_f32 v[50:51], v[250:251], v[232:233], v[50:51] op_sel_hi:[1,0,1]
    v_pk_mul_f32 v[132:133], v[34:35], v[232:233] op_sel:[0,1] op_sel_hi:[1,1]
    v_exp_f32 v132, v132
    v_exp_f32 v133, v133
    v_pk_mul_f32 v[34:35], v[34:35], v[50:51]
    buffer_load_dwordx4 a[168:171], v4, s[56:59], s79 offen offset:2048
    v_pk_fma_f32 v[132:133], v[132:133], v[240:241], v[240:241] op_sel:[0,0,0] op_sel_hi:[1,0,0]
    v_rcp_f32 v132, v132
    v_rcp_f32 v133, v133
    v_pk_fma_f32 v[36:37], v[244:245], v[234:235], v[36:37] op_sel_hi:[1,0,1]
    v_pk_fma_f32 v[52:53], v[248:249], v[234:235], v[52:53] op_sel_hi:[1,0,1]
    v_pk_mul_f32 v[136:137], v[36:37], v[234:235] op_sel:[0,1] op_sel_hi:[1,1]
    v_exp_f32 v136, v136
    v_exp_f32 v137, v137
    v_pk_mul_f32 v[36:37], v[36:37], v[52:53]
    v_pk_fma_f32 v[136:137], v[136:137], v[240:241], v[240:241] op_sel:[0,1,1] op_sel_hi:[1,1,1]
    v_rcp_f32 v136, v136
    v_rcp_f32 v137, v137
    v_pk_fma_f32 v[38:39], v[246:247], v[234:235], v[38:39] op_sel_hi:[1,0,1]
    v_pk_fma_f32 v[54:55], v[250:251], v[234:235], v[54:55] op_sel_hi:[1,0,1]
    v_pk_mul_f32 v[140:141], v[38:39], v[234:235] op_sel:[0,1] op_sel_hi:[1,1]
    buffer_load_dwordx4 a[172:175], v4, s[56:59], s79 offen offset:3072
    v_exp_f32 v140, v140
    v_exp_f32 v141, v141
    v_pk_mul_f32 v[38:39], v[38:39], v[54:55]
    v_pk_fma_f32 v[140:141], v[140:141], v[240:241], v[240:241] op_sel:[0,1,1] op_sel_hi:[1,1,1]
    v_rcp_f32 v140, v140
    v_rcp_f32 v141, v141
    v_pk_mul_f32 v[32:33], v[32:33], v[128:129]
    v_cvt_pk_bf16_f32 v160, v32, v33
    v_pk_mul_f32 v[36:37], v[36:37], v[136:137]
    v_cvt_pk_bf16_f32 v162, v36, v37
    v_pk_mul_f32 v[34:35], v[34:35], v[132:133]
    v_cvt_pk_bf16_f32 v161, v34, v35
    v_pk_mul_f32 v[38:39], v[38:39], v[140:141]
    v_cvt_pk_bf16_f32 v163, v38, v39
    v_permlane16_swap_b32 v160, v162
    s_nop 0
    v_permlane16_swap_b32 v161, v163
    v_and_or_b32 v160, v160, s27, v6
    v_and_or_b32 v162, v162, s27, v8
    v_and_or_b32 v161, v161, s27, v7
    v_and_or_b32 v163, v163, s27, v9
    buffer_store_dwordx4 v[160:163], v26, s[60:63], s80 offen offset:0 sc1
    v_pk_fma_f32 v[40:41], v[244:245], v[236:237], v[40:41] op_sel_hi:[1,0,1]
    v_pk_fma_f32 v[56:57], v[248:249], v[236:237], v[56:57] op_sel_hi:[1,0,1]
    v_pk_mul_f32 v[128:129], v[40:41], v[236:237] op_sel:[0,1] op_sel_hi:[1,1]
    v_exp_f32 v128, v128
    v_exp_f32 v129, v129
    v_pk_mul_f32 v[40:41], v[40:41], v[56:57]
    v_pk_fma_f32 v[128:129], v[128:129], v[242:243], v[242:243] op_sel:[0,0,0] op_sel_hi:[1,0,0]
    v_rcp_f32 v128, v128
    v_rcp_f32 v129, v129
    v_pk_fma_f32 v[42:43], v[246:247], v[236:237], v[42:43] op_sel_hi:[1,0,1]
    v_pk_fma_f32 v[58:59], v[250:251], v[236:237], v[58:59] op_sel_hi:[1,0,1]
    v_pk_mul_f32 v[132:133], v[42:43], v[236:237] op_sel:[0,1] op_sel_hi:[1,1]
    v_exp_f32 v132, v132
    v_exp_f32 v133, v133
    v_pk_mul_f32 v[42:43], v[42:43], v[58:59]
    buffer_load_dwordx4 a[176:179], v5, s[56:59], s79 offen offset:0
    v_pk_fma_f32 v[132:133], v[132:133], v[242:243], v[242:243] op_sel:[0,0,0] op_sel_hi:[1,0,0]
    v_rcp_f32 v132, v132
    v_rcp_f32 v133, v133
    v_pk_fma_f32 v[44:45], v[244:245], v[238:239], v[44:45] op_sel_hi:[1,0,1]
    v_pk_fma_f32 v[60:61], v[248:249], v[238:239], v[60:61] op_sel_hi:[1,0,1]
    v_pk_mul_f32 v[136:137], v[44:45], v[238:239] op_sel:[0,1] op_sel_hi:[1,1]
    v_exp_f32 v136, v136
    v_exp_f32 v137, v137
    v_pk_mul_f32 v[44:45], v[44:45], v[60:61]
    v_pk_fma_f32 v[136:137], v[136:137], v[242:243], v[242:243] op_sel:[0,1,1] op_sel_hi:[1,1,1]
    v_rcp_f32 v136, v136
    v_rcp_f32 v137, v137
    v_pk_fma_f32 v[46:47], v[246:247], v[238:239], v[46:47] op_sel_hi:[1,0,1]
    v_pk_fma_f32 v[62:63], v[250:251], v[238:239], v[62:63] op_sel_hi:[1,0,1]
    v_pk_mul_f32 v[140:141], v[46:47], v[238:239] op_sel:[0,1] op_sel_hi:[1,1]
    s_add_u32 s79, s75, 56320
    buffer_load_dwordx4 a[220:223], v4, s[56:59], s79 offen offset:0
    v_exp_f32 v140, v140
    v_exp_f32 v141, v141
    v_pk_mul_f32 v[46:47], v[46:47], v[62:63]
    v_pk_fma_f32 v[140:141], v[140:141], v[242:243], v[242:243] op_sel:[0,1,1] op_sel_hi:[1,1,1]
    v_rcp_f32 v140, v140
    v_rcp_f32 v141, v141
    v_pk_mul_f32 v[40:41], v[40:41], v[128:129]
    v_cvt_pk_bf16_f32 v164, v40, v41
    v_pk_mul_f32 v[44:45], v[44:45], v[136:137]
    v_cvt_pk_bf16_f32 v166, v44, v45
    v_pk_mul_f32 v[42:43], v[42:43], v[132:133]
    v_cvt_pk_bf16_f32 v165, v42, v43
    v_pk_mul_f32 v[46:47], v[46:47], v[140:141]
    v_cvt_pk_bf16_f32 v167, v46, v47
    v_permlane16_swap_b32 v164, v166
    s_nop 0
    v_permlane16_swap_b32 v165, v167
    v_and_or_b32 v164, v164, s27, v6
    v_and_or_b32 v166, v166, s27, v8
    v_and_or_b32 v165, v165, s27, v7
    v_and_or_b32 v167, v167, s27, v9
    buffer_store_dwordx4 v[164:167], v26, s[60:63], s80 offen offset:512 sc1
    s_add_u32 s80, s80, 4096
    v_pk_fma_f32 v[64:65], v[252:253], v[232:233], v[64:65] op_sel_hi:[1,0,1]
    v_pk_fma_f32 v[80:81], v[216:217], v[232:233], v[80:81] op_sel_hi:[1,0,1]
    v_pk_mul_f32 v[128:129], v[64:65], v[232:233] op_sel:[0,1] op_sel_hi:[1,1]
    v_exp_f32 v128, v128
    v_exp_f32 v129, v129
    v_pk_mul_f32 v[64:65], v[64:65], v[80:81]
    v_pk_fma_f32 v[128:129], v[128:129], v[240:241], v[240:241] op_sel:[0,0,0] op_sel_hi:[1,0,0]
    v_rcp_f32 v128, v128
    v_rcp_f32 v129, v129
    v_pk_fma_f32 v[66:67], v[254:255], v[232:233], v[66:67] op_sel_hi:[1,0,1]
    v_pk_fma_f32 v[82:83], v[218:219], v[232:233], v[82:83] op_sel_hi:[1,0,1]
    v_pk_mul_f32 v[132:133], v[66:67], v[232:233] op_sel:[0,1] op_sel_hi:[1,1]
    v_exp_f32 v132, v132
    v_exp_f32 v133, v133
    v_pk_mul_f32 v[66:67], v[66:67], v[82:83]
    buffer_load_dwordx4 a[224:227], v4, s[56:59], s79 offen offset:1024
    v_pk_fma_f32 v[132:133], v[132:133], v[240:241], v[240:241] op_sel:[0,0,0] op_sel_hi:[1,0,0]
    v_rcp_f32 v132, v132
    v_rcp_f32 v133, v133
    v_pk_fma_f32 v[68:69], v[252:253], v[234:235], v[68:69] op_sel_hi:[1,0,1]
    v_pk_fma_f32 v[84:85], v[216:217], v[234:235], v[84:85] op_sel_hi:[1,0,1]
    v_pk_mul_f32 v[136:137], v[68:69], v[234:235] op_sel:[0,1] op_sel_hi:[1,1]
    v_exp_f32 v136, v136
    v_exp_f32 v137, v137
    v_pk_mul_f32 v[68:69], v[68:69], v[84:85]
    v_pk_fma_f32 v[136:137], v[136:137], v[240:241], v[240:241] op_sel:[0,1,1] op_sel_hi:[1,1,1]
    v_rcp_f32 v136, v136
    v_rcp_f32 v137, v137
    v_pk_fma_f32 v[70:71], v[254:255], v[234:235], v[70:71] op_sel_hi:[1,0,1]
    v_pk_fma_f32 v[86:87], v[218:219], v[234:235], v[86:87] op_sel_hi:[1,0,1]
    v_pk_mul_f32 v[140:141], v[70:71], v[234:235] op_sel:[0,1] op_sel_hi:[1,1]
    buffer_load_dwordx4 a[228:231], v4, s[56:59], s79 offen offset:2048
    v_exp_f32 v140, v140
    v_exp_f32 v141, v141
    v_pk_mul_f32 v[70:71], v[70:71], v[86:87]
    v_pk_fma_f32 v[140:141], v[140:141], v[240:241], v[240:241] op_sel:[0,1,1] op_sel_hi:[1,1,1]
    v_rcp_f32 v140, v140
    v_rcp_f32 v141, v141
    v_pk_mul_f32 v[64:65], v[64:65], v[128:129]
    v_cvt_pk_bf16_f32 v160, v64, v65
    v_pk_mul_f32 v[68:69], v[68:69], v[136:137]
    v_cvt_pk_bf16_f32 v162, v68, v69
    v_pk_mul_f32 v[66:67], v[66:67], v[132:133]
    v_cvt_pk_bf16_f32 v161, v66, v67
    v_pk_mul_f32 v[70:71], v[70:71], v[140:141]
    v_cvt_pk_bf16_f32 v163, v70, v71
    v_permlane16_swap_b32 v160, v162
    s_nop 0
    v_permlane16_swap_b32 v161, v163
    v_and_or_b32 v160, v160, s27, v6
    v_and_or_b32 v162, v162, s27, v8
    v_and_or_b32 v161, v161, s27, v7
    v_and_or_b32 v163, v163, s27, v9
    buffer_store_dwordx4 v[160:163], v26, s[60:63], s80 offen offset:0 sc1
    v_pk_fma_f32 v[72:73], v[252:253], v[236:237], v[72:73] op_sel_hi:[1,0,1]
    v_pk_fma_f32 v[88:89], v[216:217], v[236:237], v[88:89] op_sel_hi:[1,0,1]
    v_pk_mul_f32 v[128:129], v[72:73], v[236:237] op_sel:[0,1] op_sel_hi:[1,1]
    v_exp_f32 v128, v128
    v_exp_f32 v129, v129
    v_pk_mul_f32 v[72:73], v[72:73], v[88:89]
    v_pk_fma_f32 v[128:129], v[128:129], v[242:243], v[242:243] op_sel:[0,0,0] op_sel_hi:[1,0,0]
    v_rcp_f32 v128, v128
    v_rcp_f32 v129, v129
    v_pk_fma_f32 v[74:75], v[254:255], v[236:237], v[74:75] op_sel_hi:[1,0,1]
    v_pk_fma_f32 v[90:91], v[218:219], v[236:237], v[90:91] op_sel_hi:[1,0,1]
    v_pk_mul_f32 v[132:133], v[74:75], v[236:237] op_sel:[0,1] op_sel_hi:[1,1]
    v_exp_f32 v132, v132
    v_exp_f32 v133, v133
    v_pk_mul_f32 v[74:75], v[74:75], v[90:91]
    buffer_load_dwordx4 a[232:235], v4, s[56:59], s79 offen offset:3072
    v_pk_fma_f32 v[132:133], v[132:133], v[242:243], v[242:243] op_sel:[0,0,0] op_sel_hi:[1,0,0]
    v_rcp_f32 v132, v132
    v_rcp_f32 v133, v133
    v_pk_fma_f32 v[76:77], v[252:253], v[238:239], v[76:77] op_sel_hi:[1,0,1]
    v_pk_fma_f32 v[92:93], v[216:217], v[238:239], v[92:93] op_sel_hi:[1,0,1]
    v_pk_mul_f32 v[136:137], v[76:77], v[238:239] op_sel:[0,1] op_sel_hi:[1,1]
    v_exp_f32 v136, v136
    v_exp_f32 v137, v137
    v_pk_mul_f32 v[76:77], v[76:77], v[92:93]
    v_pk_fma_f32 v[136:137], v[136:137], v[242:243], v[242:243] op_sel:[0,1,1] op_sel_hi:[1,1,1]
    v_rcp_f32 v136, v136
    v_rcp_f32 v137, v137
    v_pk_fma_f32 v[78:79], v[254:255], v[238:239], v[78:79] op_sel_hi:[1,0,1]
    v_pk_fma_f32 v[94:95], v[218:219], v[238:239], v[94:95] op_sel_hi:[1,0,1]
    v_pk_mul_f32 v[140:141], v[78:79], v[238:239] op_sel:[0,1] op_sel_hi:[1,1]
    buffer_load_dwordx4 a[236:239], v5, s[56:59], s79 offen offset:0
    v_exp_f32 v140, v140
    v_exp_f32 v141, v141
    v_pk_mul_f32 v[78:79], v[78:79], v[94:95]
    v_pk_fma_f32 v[140:141], v[140:141], v[242:243], v[242:243] op_sel:[0,1,1] op_sel_hi:[1,1,1]
    v_rcp_f32 v140, v140
    v_rcp_f32 v141, v141
    v_pk_mul_f32 v[72:73], v[72:73], v[128:129]
    v_cvt_pk_bf16_f32 v164, v72, v73
    v_pk_mul_f32 v[76:77], v[76:77], v[136:137]
    v_cvt_pk_bf16_f32 v166, v76, v77
    v_pk_mul_f32 v[74:75], v[74:75], v[132:133]
    v_cvt_pk_bf16_f32 v165, v74, v75
    v_pk_mul_f32 v[78:79], v[78:79], v[140:141]
    v_cvt_pk_bf16_f32 v167, v78, v79
    v_permlane16_swap_b32 v164, v166
    s_nop 0
    v_permlane16_swap_b32 v165, v167
    v_and_or_b32 v164, v164, s27, v6
    v_and_or_b32 v166, v166, s27, v8
    v_and_or_b32 v165, v165, s27, v7
    v_and_or_b32 v167, v167, s27, v9
    buffer_store_dwordx4 v[164:167], v26, s[60:63], s80 offen offset:512 sc1
    s_add_u32 s80, s80, 4096
    v_pk_fma_f32 v[96:97], v[220:221], v[232:233], v[96:97] op_sel_hi:[1,0,1]
    v_pk_fma_f32 v[112:113], v[224:225], v[232:233], v[112:113] op_sel_hi:[1,0,1]
    v_pk_mul_f32 v[128:129], v[96:97], v[232:233] op_sel:[0,1] op_sel_hi:[1,1]
    v_exp_f32 v128, v128
    v_exp_f32 v129, v129
    v_pk_mul_f32 v[96:97], v[96:97], v[112:113]
    v_pk_fma_f32 v[128:129], v[128:129], v[240:241], v[240:241] op_sel:[0,0,0] op_sel_hi:[1,0,0]
    v_rcp_f32 v128, v128
    v_rcp_f32 v129, v129
    v_pk_fma_f32 v[98:99], v[222:223], v[232:233], v[98:99] op_sel_hi:[1,0,1]
    v_pk_fma_f32 v[114:115], v[226:227], v[232:233], v[114:115] op_sel_hi:[1,0,1]
    v_pk_mul_f32 v[132:133], v[98:99], v[232:233] op_sel:[0,1] op_sel_hi:[1,1]
    v_exp_f32 v132, v132
    v_exp_f32 v133, v133
    v_pk_mul_f32 v[98:99], v[98:99], v[114:115]
    v_pk_fma_f32 v[132:133], v[132:133], v[240:241], v[240:241] op_sel:[0,0,0] op_sel_hi:[1,0,0]
    v_rcp_f32 v132, v132
    v_rcp_f32 v133, v133
    v_pk_fma_f32 v[100:101], v[220:221], v[234:235], v[100:101] op_sel_hi:[1,0,1]
    v_pk_fma_f32 v[116:117], v[224:225], v[234:235], v[116:117] op_sel_hi:[1,0,1]
    v_pk_mul_f32 v[136:137], v[100:101], v[234:235] op_sel:[0,1] op_sel_hi:[1,1]
    v_exp_f32 v136, v136
    v_exp_f32 v137, v137
    v_pk_mul_f32 v[100:101], v[100:101], v[116:117]
    v_pk_fma_f32 v[136:137], v[136:137], v[240:241], v[240:241] op_sel:[0,1,1] op_sel_hi:[1,1,1]
    v_rcp_f32 v136, v136
    v_rcp_f32 v137, v137
    v_pk_fma_f32 v[102:103], v[222:223], v[234:235], v[102:103] op_sel_hi:[1,0,1]
    v_pk_fma_f32 v[118:119], v[226:227], v[234:235], v[118:119] op_sel_hi:[1,0,1]
    v_pk_mul_f32 v[140:141], v[102:103], v[234:235] op_sel:[0,1] op_sel_hi:[1,1]
    v_exp_f32 v140, v140
    v_exp_f32 v141, v141
    v_pk_mul_f32 v[102:103], v[102:103], v[118:119]
    v_pk_fma_f32 v[140:141], v[140:141], v[240:241], v[240:241] op_sel:[0,1,1] op_sel_hi:[1,1,1]
    v_rcp_f32 v140, v140
    v_rcp_f32 v141, v141
    v_pk_mul_f32 v[96:97], v[96:97], v[128:129]
    v_cvt_pk_bf16_f32 v160, v96, v97
    v_pk_mul_f32 v[100:101], v[100:101], v[136:137]
    v_cvt_pk_bf16_f32 v162, v100, v101
    v_pk_mul_f32 v[98:99], v[98:99], v[132:133]
    v_cvt_pk_bf16_f32 v161, v98, v99
    v_pk_mul_f32 v[102:103], v[102:103], v[140:141]
    v_cvt_pk_bf16_f32 v163, v102, v103
    v_permlane16_swap_b32 v160, v162
    s_nop 0
    v_permlane16_swap_b32 v161, v163
    v_and_or_b32 v160, v160, s27, v6
    v_and_or_b32 v162, v162, s27, v8
    v_and_or_b32 v161, v161, s27, v7
    v_and_or_b32 v163, v163, s27, v9
    buffer_store_dwordx4 v[160:163], v26, s[60:63], s80 offen offset:0 sc1
    v_pk_fma_f32 v[104:105], v[220:221], v[236:237], v[104:105] op_sel_hi:[1,0,1]
    v_pk_fma_f32 v[120:121], v[224:225], v[236:237], v[120:121] op_sel_hi:[1,0,1]
    v_pk_mul_f32 v[128:129], v[104:105], v[236:237] op_sel:[0,1] op_sel_hi:[1,1]
    v_exp_f32 v128, v128
    v_exp_f32 v129, v129
    v_pk_mul_f32 v[104:105], v[104:105], v[120:121]
    v_pk_fma_f32 v[128:129], v[128:129], v[242:243], v[242:243] op_sel:[0,0,0] op_sel_hi:[1,0,0]
    v_rcp_f32 v128, v128
    v_rcp_f32 v129, v129
    v_pk_fma_f32 v[106:107], v[222:223], v[236:237], v[106:107] op_sel_hi:[1,0,1]
    v_pk_fma_f32 v[122:123], v[226:227], v[236:237], v[122:123] op_sel_hi:[1,0,1]
    v_pk_mul_f32 v[132:133], v[106:107], v[236:237] op_sel:[0,1] op_sel_hi:[1,1]
    v_exp_f32 v132, v132
    v_exp_f32 v133, v133
    v_pk_mul_f32 v[106:107], v[106:107], v[122:123]
    v_pk_fma_f32 v[132:133], v[132:133], v[242:243], v[242:243] op_sel:[0,0,0] op_sel_hi:[1,0,0]
    v_rcp_f32 v132, v132
    v_rcp_f32 v133, v133
    v_pk_fma_f32 v[108:109], v[220:221], v[238:239], v[108:109] op_sel_hi:[1,0,1]
    v_pk_fma_f32 v[124:125], v[224:225], v[238:239], v[124:125] op_sel_hi:[1,0,1]
    v_pk_mul_f32 v[136:137], v[108:109], v[238:239] op_sel:[0,1] op_sel_hi:[1,1]
    v_exp_f32 v136, v136
    v_exp_f32 v137, v137
    v_pk_mul_f32 v[108:109], v[108:109], v[124:125]
    v_pk_fma_f32 v[136:137], v[136:137], v[242:243], v[242:243] op_sel:[0,1,1] op_sel_hi:[1,1,1]
    v_rcp_f32 v136, v136
    v_rcp_f32 v137, v137
    v_pk_fma_f32 v[110:111], v[222:223], v[238:239], v[110:111] op_sel_hi:[1,0,1]
    v_pk_fma_f32 v[126:127], v[226:227], v[238:239], v[126:127] op_sel_hi:[1,0,1]
    v_pk_mul_f32 v[140:141], v[110:111], v[238:239] op_sel:[0,1] op_sel_hi:[1,1]
    v_exp_f32 v140, v140
    v_exp_f32 v141, v141
    v_pk_mul_f32 v[110:111], v[110:111], v[126:127]
    v_pk_fma_f32 v[140:141], v[140:141], v[242:243], v[242:243] op_sel:[0,1,1] op_sel_hi:[1,1,1]
    v_rcp_f32 v140, v140
    v_rcp_f32 v141, v141
    v_pk_mul_f32 v[104:105], v[104:105], v[128:129]
    v_cvt_pk_bf16_f32 v164, v104, v105
    v_pk_mul_f32 v[108:109], v[108:109], v[136:137]
    v_cvt_pk_bf16_f32 v166, v108, v109
    v_pk_mul_f32 v[106:107], v[106:107], v[132:133]
    v_cvt_pk_bf16_f32 v165, v106, v107
    v_pk_mul_f32 v[110:111], v[110:111], v[140:141]
    v_cvt_pk_bf16_f32 v167, v110, v111
    v_permlane16_swap_b32 v164, v166
    s_nop 0
    v_permlane16_swap_b32 v165, v167
    v_and_or_b32 v164, v164, s27, v6
    v_and_or_b32 v166, v166, s27, v8
    v_and_or_b32 v165, v165, s27, v7
    v_and_or_b32 v167, v167, s27, v9
    buffer_store_dwordx4 v[164:167], v26, s[60:63], s80 offen offset:512 sc1
    s_add_u32 s24, s4, s20
    buffer_load_dwordx4 v[32:35], v0, s[60:63], s24 offen sc1
    s_add_u32 s25, s7, s20
    buffer_load_dwordx4 v[36:39], v0, s[60:63], s25 offen sc1
    s_add_u32 s24, s10, s20
    buffer_load_dwordx4 v[40:43], v0, s[60:63], s24 offen sc1
    s_add_u32 s25, s13, s20
    buffer_load_dwordx4 v[44:47], v0, s[60:63], s25 offen sc1
    s_add_u32 s24, s4, s21
    buffer_load_dwordx4 v[48:51], v0, s[60:63], s24 offen sc1
    s_add_u32 s25, s7, s21
    buffer_load_dwordx4 v[52:55], v0, s[60:63], s25 offen sc1
    s_add_u32 s24, s10, s21
    buffer_load_dwordx4 v[56:59], v0, s[60:63], s24 offen sc1
    s_add_u32 s25, s13, s21
    buffer_load_dwordx4 v[60:63], v0, s[60:63], s25 offen sc1
    s_add_u32 s24, s4, s22
    buffer_load_dwordx4 v[64:67], v0, s[60:63], s24 offen sc1
    s_add_u32 s25, s7, s22
    buffer_load_dwordx4 v[68:71], v0, s[60:63], s25 offen sc1
    s_add_u32 s24, s10, s22
    buffer_load_dwordx4 v[72:75], v0, s[60:63], s24 offen sc1
    s_add_u32 s25, s13, s22
    buffer_load_dwordx4 v[76:79], v0, s[60:63], s25 offen sc1
    v_lshrrev_b32 v128, 4, v1
    v_bfe_u32 v131, v1, 2, 2
    v_lshl_add_u32 v131, v128, 2, v131
    v_lshlrev_b32 v131, 7, v131
    v_and_b32 v132, 3, v1
    v_lshl_add_u32 v131, v132, 3, v131
    s_lshl_b32 s80, s64, 5
    s_add_u32 s80, s80, 151552
    v_add_u32 v152, s80, v131
    ds_read_b64_tr_b16 v[168:169], v152 offset:0
    ds_read_b64_tr_b16 v[170:171], v152 offset:2048
    ds_read_b64_tr_b16 v[172:173], v152 offset:4096
    ds_read_b64_tr_b16 v[174:175], v152 offset:6144
    ds_read_b64_tr_b16 v[176:177], v152 offset:8192
    s_mul_i32 s80, s64, 15360
    v_add_u32 v148, s80, v4
    s_sub_u32 s80, s64, 1
    s_and_b32 s80, s80, 3
    s_mul_i32 s80, s80, 15360
    s_add_u32 s80, s80, 0
    v_add_u32 v149, s80, v4
    s_sub_u32 s80, s64, 2
    s_and_b32 s80, s80, 3
    s_mul_i32 s80, s80, 15360
    s_add_u32 s80, s80, 5120
    v_add_u32 v150, s80, v4
    s_sub_u32 s80, s64, 3
    s_and_b32 s80, s80, 3
    s_mul_i32 s80, s80, 15360
    s_add_u32 s80, s80, 10240
    v_add_u32 v151, s80, v4
    s_lshl_b32 s80, s84, 7
    s_lshl_b32 s81, s69, 6
    s_add_u32 s80, s80, s81
    s_lshl_b32 s81, s64, 4
    s_add_u32 s80, s80, s81
    s_mul_i32 s80, s80, 1280
    s_mul_i32 s81, s70, 160
    s_add_u32 s80, s80, s81
    v_and_b32 v130, 15, v1
    v_mul_u32_u24 v131, 1280, v130
    v_lshl_add_u32 v132, v128, 3, v131
    v_add_u32 v153, s80, v132
    v_and_b32 v132, 1, v128
    v_lshl_add_u32 v131, v132, 5, v131
    v_lshrrev_b32 v132, 1, v128
    v_lshl_add_u32 v131, v132, 4, v131
    v_add_u32 v154, s80, v131
    s_waitcnt lgkmcnt(0)
    v_lshlrev_b32 v220, 16, v168
    v_and_b32 v221, s77, v168
    v_lshlrev_b32 v222, 16, v169
    v_and_b32 v223, s77, v169
    v_lshlrev_b32 v224, 16, v170
    v_and_b32 v225, s77, v170
    v_lshlrev_b32 v226, 16, v171
    v_and_b32 v227, s77, v171
    v_lshlrev_b32 v228, 16, v172
    v_and_b32 v229, s77, v172
    v_lshlrev_b32 v230, 16, v173
    v_and_b32 v231, s77, v173
    v_lshlrev_b32 v232, 16, v174
    v_and_b32 v233, s77, v174
    v_lshlrev_b32 v234, 16, v175
    v_and_b32 v235, s77, v175
    v_lshlrev_b32 v236, 16, v176
    v_and_b32 v237, s77, v176
    v_lshlrev_b32 v238, 16, v177
    v_and_b32 v239, s77, v177
    s_barrier
    s_waitcnt vmcnt(8)
    v_xor_b32 v32, v32, v6
    v_xor_b32 v33, v33, v7
    v_or_b32 v18, v32, v33
    v_xor_b32 v34, v34, v8
    v_xor_b32 v35, v35, v9
    v_or3_b32 v18, v18, v34, v35
    v_xor_b32 v36, v36, v6
    v_xor_b32 v37, v37, v7
    v_or3_b32 v18, v18, v36, v37
    v_xor_b32 v38, v38, v8
    v_xor_b32 v39, v39, v9
    v_or3_b32 v18, v18, v38, v39
    v_xor_b32 v40, v40, v6
    v_xor_b32 v41, v41, v7
    v_or3_b32 v18, v18, v40, v41
    v_xor_b32 v42, v42, v8
    v_xor_b32 v43, v43, v9
    v_or3_b32 v18, v18, v42, v43
    v_xor_b32 v44, v44, v6
    v_xor_b32 v45, v45, v7
    v_or3_b32 v18, v18, v44, v45
    v_xor_b32 v46, v46, v8
    v_xor_b32 v47, v47, v9
    v_or3_b32 v18, v18, v46, v47
    v_and_b32 v18, s28, v18
    v_cmp_ne_u32 vcc, 0, v18
    s_cbranch_vccnz LB_re0
LB_ok0:
    s_waitcnt vmcnt(7)
    v_mfma_f32_16x16x32_bf16 v[160:163], a[0:3], v[32:35], 0
    s_add_u32 s24, s4, s23
    buffer_load_dwordx4 v[80:83], v0, s[60:63], s24 offen sc1
    v_xor_b32 v48, v48, v6
    v_xor_b32 v49, v49, v7
    v_mfma_f32_16x16x32_bf16 v[164:167], a[4:7], v[32:35], 0
    v_or_b32 v18, v48, v49
    v_mfma_f32_16x16x32_bf16 v[168:171], a[8:11], v[32:35], 0
    v_xor_b32 v50, v50, v8
    v_mfma_f32_16x16x32_bf16 v[172:175], a[12:15], v[32:35], 0
    v_xor_b32 v51, v51, v9
    v_mfma_f32_16x16x32_bf16 v[176:179], a[16:19], v[32:35], 0
    v_or3_b32 v18, v18, v50, v51
    s_waitcnt vmcnt(7)
    v_mfma_f32_16x16x32_bf16 v[160:163], a[60:63], v[36:39], v[160:163]
    s_add_u32 s25, s7, s23
    buffer_load_dwordx4 v[84:87], v0, s[60:63], s25 offen sc1
    v_xor_b32 v52, v52, v6
    v_xor_b32 v53, v53, v7
    v_mfma_f32_16x16x32_bf16 v[164:167], a[64:67], v[36:39], v[164:167]
    v_or3_b32 v18, v18, v52, v53
    v_mfma_f32_16x16x32_bf16 v[168:171], a[68:71], v[36:39], v[168:171]
    v_xor_b32 v54, v54, v8
    v_mfma_f32_16x16x32_bf16 v[172:175], a[72:75], v[36:39], v[172:175]
    v_xor_b32 v55, v55, v9
    v_mfma_f32_16x16x32_bf16 v[176:179], a[76:79], v[36:39], v[176:179]
    v_or3_b32 v18, v18, v54, v55
    s_waitcnt vmcnt(7)
    v_mfma_f32_16x16x32_bf16 v[160:163], a[120:123], v[40:43], v[160:163]
    s_add_u32 s24, s10, s23
    buffer_load_dwordx4 v[88:91], v0, s[60:63], s24 offen sc1
    v_xor_b32 v56, v56, v6
    v_xor_b32 v57, v57, v7
    v_mfma_f32_16x16x32_bf16 v[164:167], a[124:127], v[40:43], v[164:167]
    v_or3_b32 v18, v18, v56, v57
    v_mfma_f32_16x16x32_bf16 v[168:171], a[128:131], v[40:43], v[168:171]
    v_xor_b32 v58, v58, v8
    v_mfma_f32_16x16x32_bf16 v[172:175], a[132:135], v[40:43], v[172:175]
    v_xor_b32 v59, v59, v9
    v_mfma_f32_16x16x32_bf16 v[176:179], a[136:139], v[40:43], v[176:179]
    v_or3_b32 v18, v18, v58, v59
    s_waitcnt vmcnt(7)
    v_mfma_f32_16x16x32_bf16 v[160:163], a[180:183], v[44:47], v[160:163]
    s_add_u32 s25, s13, s23
    buffer_load_dwordx4 v[92:95], v0, s[60:63], s25 offen sc1
    v_xor_b32 v60, v60, v6
    v_xor_b32 v61, v61, v7
    v_mfma_f32_16x16x32_bf16 v[164:167], a[184:187], v[44:47], v[164:167]
    v_or3_b32 v18, v18, v60, v61
    v_xor_b32 v62, v62, v8
    v_mfma_f32_16x16x32_bf16 v[168:171], a[188:191], v[44:47], v[168:171]
    v_xor_b32 v63, v63, v9
    v_or3_b32 v18, v18, v62, v63
    v_mfma_f32_16x16x32_bf16 v[172:175], a[192:195], v[44:47], v[172:175]
    v_and_b32 v18, s28, v18
    v_mfma_f32_16x16x32_bf16 v[176:179], a[196:199], v[44:47], v[176:179]
    v_cmp_ne_u32 vcc, 0, v18
    s_cbranch_vccnz LB_re1
LB_ok1:
    s_waitcnt vmcnt(7)
    v_mfma_f32_16x16x32_bf16 v[180:183], a[0:3], v[48:51], 0
    s_add_u32 s24, s5, s20
    buffer_load_dwordx4 v[96:99], v0, s[60:63], s24 offen sc1
    v_xor_b32 v64, v64, v6
    v_xor_b32 v65, v65, v7
    v_mfma_f32_16x16x32_bf16 v[184:187], a[4:7], v[48:51], 0
    v_or_b32 v18, v64, v65
    v_mfma_f32_16x16x32_bf16 v[188:191], a[8:11], v[48:51], 0
    v_xor_b32 v66, v66, v8
    v_mfma_f32_16x16x32_bf16 v[192:195], a[12:15], v[48:51], 0
    v_xor_b32 v67, v67, v9
    v_mfma_f32_16x16x32_bf16 v[196:199], a[16:19], v[48:51], 0
    v_or3_b32 v18, v18, v66, v67
    s_waitcnt vmcnt(7)
    v_mfma_f32_16x16x32_bf16 v[180:183], a[60:63], v[52:55], v[180:183]
    s_add_u32 s25, s8, s20
    buffer_load_dwordx4 v[100:103], v0, s[60:63], s25 offen sc1
    v_xor_b32 v68, v68, v6
    v_xor_b32 v69, v69, v7
    v_mfma_f32_16x16x32_bf16 v[184:187], a[64:67], v[52:55], v[184:187]
    v_or3_b32 v18, v18, v68, v69
    v_mfma_f32_16x16x32_bf16 v[188:191], a[68:71], v[52:55], v[188:191]
    v_xor_b32 v70, v70, v8
    v_mfma_f32_16x16x32_bf16 v[192:195], a[72:75], v[52:55], v[192:195]
    v_xor_b32 v71, v71, v9
    v_mfma_f32_16x16x32_bf16 v[196:199], a[76:79], v[52:55], v[196:199]
    v_or3_b32 v18, v18, v70, v71
    s_waitcnt vmcnt(7)
    v_mfma_f32_16x16x32_bf16 v[180:183], a[120:123], v[56:59], v[180:183]
    s_add_u32 s24, s11, s20
    buffer_load_dwordx4 v[104:107], v0, s[60:63], s24 offen sc1
    v_xor_b32 v72, v72, v6
    v_xor_b32 v73, v73, v7
    v_mfma_f32_16x16x32_bf16 v[184:187], a[124:127], v[56:59], v[184:187]
    v_or3_b32 v18, v18, v72, v73
    v_mfma_f32_16x16x32_bf16 v[188:191], a[128:131], v[56:59], v[188:191]
    v_xor_b32 v74, v74, v8
    v_mfma_f32_16x16x32_bf16 v[192:195], a[132:135], v[56:59], v[192:195]
    v_xor_b32 v75, v75, v9
    v_mfma_f32_16x16x32_bf16 v[196:199], a[136:139], v[56:59], v[196:199]
    v_or3_b32 v18, v18, v74, v75
    s_waitcnt vmcnt(7)
    v_mfma_f32_16x16x32_bf16 v[180:183], a[180:183], v[60:63], v[180:183]
    s_add_u32 s25, s14, s20
    buffer_load_dwordx4 v[108:111], v0, s[60:63], s25 offen sc1
    v_xor_b32 v76, v76, v6
    v_xor_b32 v77, v77, v7
    v_mfma_f32_16x16x32_bf16 v[184:187], a[184:187], v[60:63], v[184:187]
    v_or3_b32 v18, v18, v76, v77
    v_xor_b32 v78, v78, v8
    v_mfma_f32_16x16x32_bf16 v[188:191], a[188:191], v[60:63], v[188:191]
    v_xor_b32 v79, v79, v9
    v_or3_b32 v18, v18, v78, v79
    v_mfma_f32_16x16x32_bf16 v[192:195], a[192:195], v[60:63], v[192:195]
    v_and_b32 v18, s28, v18
    v_mfma_f32_16x16x32_bf16 v[196:199], a[196:199], v[60:63], v[196:199]
    v_cmp_ne_u32 vcc, 0, v18
    s_cbranch_vccnz LB_re2
LB_ok2:
    s_waitcnt vmcnt(7)
    v_mfma_f32_16x16x32_bf16 v[200:203], a[0:3], v[64:67], 0
    s_add_u32 s24, s5, s21
    buffer_load_dwordx4 v[112:115], v0, s[60:63], s24 offen sc1
    v_xor_b32 v80, v80, v6
    v_xor_b32 v81, v81, v7
    v_mfma_f32_16x16x32_bf16 v[204:207], a[4:7], v[64:67], 0
    v_or_b32 v18, v80, v81
    v_mfma_f32_16x16x32_bf16 v[208:211], a[8:11], v[64:67], 0
    v_xor_b32 v82, v82, v8
    v_mfma_f32_16x16x32_bf16 v[212:215], a[12:15], v[64:67], 0
    v_xor_b32 v83, v83, v9
    v_mfma_f32_16x16x32_bf16 v[216:219], a[16:19], v[64:67], 0
    v_or3_b32 v18, v18, v82, v83
    s_waitcnt vmcnt(7)
    v_mfma_f32_16x16x32_bf16 v[200:203], a[60:63], v[68:71], v[200:203]
    s_add_u32 s25, s8, s21
    buffer_load_dwordx4 v[116:119], v0, s[60:63], s25 offen sc1
    v_xor_b32 v84, v84, v6
    v_xor_b32 v85, v85, v7
    v_mfma_f32_16x16x32_bf16 v[204:207], a[64:67], v[68:71], v[204:207]
    v_or3_b32 v18, v18, v84, v85
    v_mfma_f32_16x16x32_bf16 v[208:211], a[68:71], v[68:71], v[208:211]
    v_xor_b32 v86, v86, v8
    v_mfma_f32_16x16x32_bf16 v[212:215], a[72:75], v[68:71], v[212:215]
    v_xor_b32 v87, v87, v9
    v_mfma_f32_16x16x32_bf16 v[216:219], a[76:79], v[68:71], v[216:219]
    v_or3_b32 v18, v18, v86, v87
    s_waitcnt vmcnt(7)
    v_mfma_f32_16x16x32_bf16 v[200:203], a[120:123], v[72:75], v[200:203]
    s_add_u32 s24, s11, s21
    buffer_load_dwordx4 v[120:123], v0, s[60:63], s24 offen sc1
    v_xor_b32 v88, v88, v6
    v_xor_b32 v89, v89, v7
    v_mfma_f32_16x16x32_bf16 v[204:207], a[124:127], v[72:75], v[204:207]
    v_or3_b32 v18, v18, v88, v89
    v_mfma_f32_16x16x32_bf16 v[208:211], a[128:131], v[72:75], v[208:211]
    v_xor_b32 v90, v90, v8
    v_mfma_f32_16x16x32_bf16 v[212:215], a[132:135], v[72:75], v[212:215]
    v_xor_b32 v91, v91, v9
    v_mfma_f32_16x16x32_bf16 v[216:219], a[136:139], v[72:75], v[216:219]
    v_or3_b32 v18, v18, v90, v91
    s_waitcnt vmcnt(7)
    v_mfma_f32_16x16x32_bf16 v[200:203], a[180:183], v[76:79], v[200:203]
    s_add_u32 s25, s14, s21
    buffer_load_dwordx4 v[124:127], v0, s[60:63], s25 offen sc1
    v_xor_b32 v92, v92, v6
    v_xor_b32 v93, v93, v7
    v_mfma_f32_16x16x32_bf16 v[204:207], a[184:187], v[76:79], v[204:207]
    v_or3_b32 v18, v18, v92, v93
    v_xor_b32 v94, v94, v8
    v_mfma_f32_16x16x32_bf16 v[208:211], a[188:191], v[76:79], v[208:211]
    v_xor_b32 v95, v95, v9
    v_or3_b32 v18, v18, v94, v95
    v_mfma_f32_16x16x32_bf16 v[212:215], a[192:195], v[76:79], v[212:215]
    v_and_b32 v18, s28, v18
    v_mfma_f32_16x16x32_bf16 v[216:219], a[196:199], v[76:79], v[216:219]
    v_cmp_ne_u32 vcc, 0, v18
    s_cbranch_vccnz LB_re3
LB_ok3:
    s_waitcnt vmcnt(7)
    v_mfma_f32_16x16x32_bf16 v[220:223], a[0:3], v[80:83], v[220:223]
    s_add_u32 s24, s5, s22
    buffer_load_dwordx4 v[128:131], v0, s[60:63], s24 offen sc1
    v_xor_b32 v96, v96, v6
    v_xor_b32 v97, v97, v7
    v_mfma_f32_16x16x32_bf16 v[224:227], a[4:7], v[80:83], v[224:227]
    v_or_b32 v18, v96, v97
    v_mfma_f32_16x16x32_bf16 v[228:231], a[8:11], v[80:83], v[228:231]
    v_xor_b32 v98, v98, v8
    v_mfma_f32_16x16x32_bf16 v[232:235], a[12:15], v[80:83], v[232:235]
    v_xor_b32 v99, v99, v9
    v_mfma_f32_16x16x32_bf16 v[236:239], a[16:19], v[80:83], v[236:239]
    v_or3_b32 v18, v18, v98, v99
    s_waitcnt vmcnt(7)
    v_mfma_f32_16x16x32_bf16 v[220:223], a[60:63], v[84:87], v[220:223]
    s_add_u32 s25, s8, s22
    buffer_load_dwordx4 v[132:135], v0, s[60:63], s25 offen sc1
    v_xor_b32 v100, v100, v6
    v_xor_b32 v101, v101, v7
    v_mfma_f32_16x16x32_bf16 v[224:227], a[64:67], v[84:87], v[224:227]
    v_or3_b32 v18, v18, v100, v101
    v_mfma_f32_16x16x32_bf16 v[228:231], a[68:71], v[84:87], v[228:231]
    v_xor_b32 v102, v102, v8
    v_mfma_f32_16x16x32_bf16 v[232:235], a[72:75], v[84:87], v[232:235]
    v_xor_b32 v103, v103, v9
    v_mfma_f32_16x16x32_bf16 v[236:239], a[76:79], v[84:87], v[236:239]
    v_or3_b32 v18, v18, v102, v103
    s_waitcnt vmcnt(7)
    v_mfma_f32_16x16x32_bf16 v[220:223], a[120:123], v[88:91], v[220:223]
    s_add_u32 s24, s11, s22
    buffer_load_dwordx4 v[136:139], v0, s[60:63], s24 offen sc1
    v_xor_b32 v104, v104, v6
    v_xor_b32 v105, v105, v7
    v_mfma_f32_16x16x32_bf16 v[224:227], a[124:127], v[88:91], v[224:227]
    v_or3_b32 v18, v18, v104, v105
    v_mfma_f32_16x16x32_bf16 v[228:231], a[128:131], v[88:91], v[228:231]
    v_xor_b32 v106, v106, v8
    v_mfma_f32_16x16x32_bf16 v[232:235], a[132:135], v[88:91], v[232:235]
    v_xor_b32 v107, v107, v9
    v_mfma_f32_16x16x32_bf16 v[236:239], a[136:139], v[88:91], v[236:239]
    v_or3_b32 v18, v18, v106, v107
    s_waitcnt vmcnt(7)
    v_mfma_f32_16x16x32_bf16 v[220:223], a[180:183], v[92:95], v[220:223]
    s_add_u32 s25, s14, s22
    buffer_load_dwordx4 v[140:143], v0, s[60:63], s25 offen sc1
    v_xor_b32 v108, v108, v6
    v_xor_b32 v109, v109, v7
    v_mfma_f32_16x16x32_bf16 v[224:227], a[184:187], v[92:95], v[224:227]
    v_or3_b32 v18, v18, v108, v109
    v_xor_b32 v110, v110, v8
    v_mfma_f32_16x16x32_bf16 v[228:231], a[188:191], v[92:95], v[228:231]
    v_xor_b32 v111, v111, v9
    v_or3_b32 v18, v18, v110, v111
    v_mfma_f32_16x16x32_bf16 v[232:235], a[192:195], v[92:95], v[232:235]
    v_and_b32 v18, s28, v18
    v_mfma_f32_16x16x32_bf16 v[236:239], a[196:199], v[92:95], v[236:239]
    v_cmp_ne_u32 vcc, 0, v18
    s_cbranch_vccnz LB_re4
LB_ok4:
    s_waitcnt vmcnt(7)
    v_mfma_f32_16x16x32_bf16 v[160:163], a[20:23], v[96:99], v[160:163]
    s_add_u32 s24, s6, s20
    buffer_load_dwordx4 v[240:243], v0, s[60:63], s24 offen sc1
    v_xor_b32 v112, v112, v6
    v_xor_b32 v113, v113, v7
    v_mfma_f32_16x16x32_bf16 v[164:167], a[24:27], v[96:99], v[164:167]
    v_or_b32 v18, v112, v113
    v_mfma_f32_16x16x32_bf16 v[168:171], a[28:31], v[96:99], v[168:171]
    v_xor_b32 v114, v114, v8
    v_mfma_f32_16x16x32_bf16 v[172:175], a[32:35], v[96:99], v[172:175]
    v_xor_b32 v115, v115, v9
    v_mfma_f32_16x16x32_bf16 v[176:179], a[36:39], v[96:99], v[176:179]
    v_or3_b32 v18, v18, v114, v115
    s_waitcnt vmcnt(7)
    v_mfma_f32_16x16x32_bf16 v[160:163], a[80:83], v[100:103], v[160:163]
    s_add_u32 s25, s9, s20
    buffer_load_dwordx4 v[244:247], v0, s[60:63], s25 offen sc1
    v_xor_b32 v116, v116, v6
    v_xor_b32 v117, v117, v7
    v_mfma_f32_16x16x32_bf16 v[164:167], a[84:87], v[100:103], v[164:167]
    v_or3_b32 v18, v18, v116, v117
    v_mfma_f32_16x16x32_bf16 v[168:171], a[88:91], v[100:103], v[168:171]
    v_xor_b32 v118, v118, v8
    v_mfma_f32_16x16x32_bf16 v[172:175], a[92:95], v[100:103], v[172:175]
    v_xor_b32 v119, v119, v9
    v_mfma_f32_16x16x32_bf16 v[176:179], a[96:99], v[100:103], v[176:179]
    v_or3_b32 v18, v18, v118, v119
    s_waitcnt vmcnt(7)
    v_mfma_f32_16x16x32_bf16 v[160:163], a[140:143], v[104:107], v[160:163]
    s_add_u32 s24, s12, s20
    buffer_load_dwordx4 v[248:251], v0, s[60:63], s24 offen sc1
    v_xor_b32 v120, v120, v6
    v_xor_b32 v121, v121, v7
    v_mfma_f32_16x16x32_bf16 v[164:167], a[144:147], v[104:107], v[164:167]
    v_or3_b32 v18, v18, v120, v121
    v_mfma_f32_16x16x32_bf16 v[168:171], a[148:151], v[104:107], v[168:171]
    v_xor_b32 v122, v122, v8
    v_mfma_f32_16x16x32_bf16 v[172:175], a[152:155], v[104:107], v[172:175]
    v_xor_b32 v123, v123, v9
    v_mfma_f32_16x16x32_bf16 v[176:179], a[156:159], v[104:107], v[176:179]
    v_or3_b32 v18, v18, v122, v123
    s_waitcnt vmcnt(7)
    v_mfma_f32_16x16x32_bf16 v[160:163], a[200:203], v[108:111], v[160:163]
    s_add_u32 s25, s15, s20
    buffer_load_dwordx4 v[252:255], v0, s[60:63], s25 offen sc1
    v_xor_b32 v124, v124, v6
    v_xor_b32 v125, v125, v7
    v_mfma_f32_16x16x32_bf16 v[164:167], a[204:207], v[108:111], v[164:167]
    v_or3_b32 v18, v18, v124, v125
    v_xor_b32 v126, v126, v8
    v_mfma_f32_16x16x32_bf16 v[168:171], a[208:211], v[108:111], v[168:171]
    v_xor_b32 v127, v127, v9
    v_or3_b32 v18, v18, v126, v127
    v_mfma_f32_16x16x32_bf16 v[172:175], a[212:215], v[108:111], v[172:175]
    v_and_b32 v18, s28, v18
    v_mfma_f32_16x16x32_bf16 v[176:179], a[216:219], v[108:111], v[176:179]
    v_cmp_ne_u32 vcc, 0, v18
    s_cbranch_vccnz LB_re5
LB_ok5:
    s_waitcnt vmcnt(7)
    v_mfma_f32_16x16x32_bf16 v[180:183], a[20:23], v[112:115], v[180:183]
    s_add_u32 s24, s6, s21
    buffer_load_dwordx4 v[32:35], v0, s[60:63], s24 offen sc1
    v_xor_b32 v128, v128, v6
    v_xor_b32 v129, v129, v7
    v_mfma_f32_16x16x32_bf16 v[184:187], a[24:27], v[112:115], v[184:187]
    v_or_b32 v18, v128, v129
    v_mfma_f32_16x16x32_bf16 v[188:191], a[28:31], v[112:115], v[188:191]
    v_xor_b32 v130, v130, v8
    v_mfma_f32_16x16x32_bf16 v[192:195], a[32:35], v[112:115], v[192:195]
    v_xor_b32 v131, v131, v9
    v_mfma_f32_16x16x32_bf16 v[196:199], a[36:39], v[112:115], v[196:199]
    v_or3_b32 v18, v18, v130, v131
    s_waitcnt vmcnt(7)
    v_mfma_f32_16x16x32_bf16 v[180:183], a[80:83], v[116:119], v[180:183]
    s_add_u32 s25, s9, s21
    buffer_load_dwordx4 v[36:39], v0, s[60:63], s25 offen sc1
    v_xor_b32 v132, v132, v6
    v_xor_b32 v133, v133, v7
    v_mfma_f32_16x16x32_bf16 v[184:187], a[84:87], v[116:119], v[184:187]
    v_or3_b32 v18, v18, v132, v133
    v_mfma_f32_16x16x32_bf16 v[188:191], a[88:91], v[116:119], v[188:191]
    v_xor_b32 v134, v134, v8
    v_mfma_f32_16x16x32_bf16 v[192:195], a[92:95], v[116:119], v[192:195]
    v_xor_b32 v135, v135, v9
    v_mfma_f32_16x16x32_bf16 v[196:199], a[96:99], v[116:119], v[196:199]
    v_or3_b32 v18, v18, v134, v135
    s_waitcnt vmcnt(7)
    v_mfma_f32_16x16x32_bf16 v[180:183], a[140:143], v[120:123], v[180:183]
    s_add_u32 s24, s12, s21
    buffer_load_dwordx4 v[40:43], v0, s[60:63], s24 offen sc1
    v_xor_b32 v136, v136, v6
    v_xor_b32 v137, v137, v7
    v_mfma_f32_16x16x32_bf16 v[184:187], a[144:147], v[120:123], v[184:187]
    v_or3_b32 v18, v18, v136, v137
    v_mfma_f32_16x16x32_bf16 v[188:191], a[148:151], v[120:123], v[188:191]
    v_xor_b32 v138, v138, v8
    v_mfma_f32_16x16x32_bf16 v[192:195], a[152:155], v[120:123], v[192:195]
    v_xor_b32 v139, v139, v9
    v_mfma_f32_16x16x32_bf16 v[196:199], a[156:159], v[120:123], v[196:199]
    v_or3_b32 v18, v18, v138, v139
    s_waitcnt vmcnt(7)
    v_mfma_f32_16x16x32_bf16 v[180:183], a[200:203], v[124:127], v[180:183]
    s_add_u32 s25, s15, s21
    buffer_load_dwordx4 v[44:47], v0, s[60:63], s25 offen sc1
    v_xor_b32 v140, v140, v6
    v_xor_b32 v141, v141, v7
    v_mfma_f32_16x16x32_bf16 v[184:187], a[204:207], v[124:127], v[184:187]
    v_or3_b32 v18, v18, v140, v141
    v_xor_b32 v142, v142, v8
    v_mfma_f32_16x16x32_bf16 v[188:191], a[208:211], v[124:127], v[188:191]
    v_xor_b32 v143, v143, v9
    v_or3_b32 v18, v18, v142, v143
    v_mfma_f32_16x16x32_bf16 v[192:195], a[212:215], v[124:127], v[192:195]
    v_and_b32 v18, s28, v18
    v_mfma_f32_16x16x32_bf16 v[196:199], a[216:219], v[124:127], v[196:199]
    v_cmp_ne_u32 vcc, 0, v18
    s_cbranch_vccnz LB_re6
LB_ok6:
    s_waitcnt vmcnt(7)
    v_mfma_f32_16x16x32_bf16 v[200:203], a[20:23], v[128:131], v[200:203]
    s_add_u32 s24, s6, s22
    buffer_load_dwordx4 v[48:51], v0, s[60:63], s24 offen sc1
    v_xor_b32 v240, v240, v6
    v_xor_b32 v241, v241, v7
    v_mfma_f32_16x16x32_bf16 v[204:207], a[24:27], v[128:131], v[204:207]
    v_or_b32 v18, v240, v241
    v_mfma_f32_16x16x32_bf16 v[208:211], a[28:31], v[128:131], v[208:211]
    v_xor_b32 v242, v242, v8
    v_mfma_f32_16x16x32_bf16 v[212:215], a[32:35], v[128:131], v[212:215]
    v_xor_b32 v243, v243, v9
    v_mfma_f32_16x16x32_bf16 v[216:219], a[36:39], v[128:131], v[216:219]
    v_or3_b32 v18, v18, v242, v243
    s_waitcnt vmcnt(7)
    v_mfma_f32_16x16x32_bf16 v[200:203], a[80:83], v[132:135], v[200:203]
    s_add_u32 s25, s9, s22
    buffer_load_dwordx4 v[52:55], v0, s[60:63], s25 offen sc1
    v_xor_b32 v244, v244, v6
    v_xor_b32 v245, v245, v7
    v_mfma_f32_16x16x32_bf16 v[204:207], a[84:87], v[132:135], v[204:207]
    v_or3_b32 v18, v18, v244, v245
    v_mfma_f32_16x16x32_bf16 v[208:211], a[88:91], v[132:135], v[208:211]
    v_xor_b32 v246, v246, v8
    v_mfma_f32_16x16x32_bf16 v[212:215], a[92:95], v[132:135], v[212:215]
    v_xor_b32 v247, v247, v9
    v_mfma_f32_16x16x32_bf16 v[216:219], a[96:99], v[132:135], v[216:219]
    v_or3_b32 v18, v18, v246, v247
    s_waitcnt vmcnt(7)
    v_mfma_f32_16x16x32_bf16 v[200:203], a[140:143], v[136:139], v[200:203]
    s_add_u32 s24, s12, s22
    buffer_load_dwordx4 v[56:59], v0, s[60:63], s24 offen sc1
    v_xor_b32 v248, v248, v6
    v_xor_b32 v249, v249, v7
    v_mfma_f32_16x16x32_bf16 v[204:207], a[144:147], v[136:139], v[204:207]
    v_or3_b32 v18, v18, v248, v249
    v_mfma_f32_16x16x32_bf16 v[208:211], a[148:151], v[136:139], v[208:211]
    v_xor_b32 v250, v250, v8
    v_mfma_f32_16x16x32_bf16 v[212:215], a[152:155], v[136:139], v[212:215]
    v_xor_b32 v251, v251, v9
    v_mfma_f32_16x16x32_bf16 v[216:219], a[156:159], v[136:139], v[216:219]
    v_or3_b32 v18, v18, v250, v251
    s_waitcnt vmcnt(7)
    v_mfma_f32_16x16x32_bf16 v[200:203], a[200:203], v[140:143], v[200:203]
    s_add_u32 s25, s15, s22
    buffer_load_dwordx4 v[60:63], v0, s[60:63], s25 offen sc1
    v_xor_b32 v252, v252, v6
    v_xor_b32 v253, v253, v7
    v_mfma_f32_16x16x32_bf16 v[204:207], a[204:207], v[140:143], v[204:207]
    v_or3_b32 v18, v18, v252, v253
    v_xor_b32 v254, v254, v8
    v_mfma_f32_16x16x32_bf16 v[208:211], a[208:211], v[140:143], v[208:211]
    v_xor_b32 v255, v255, v9
    v_or3_b32 v18, v18, v254, v255
    v_mfma_f32_16x16x32_bf16 v[212:215], a[212:215], v[140:143], v[212:215]
    v_and_b32 v18, s28, v18
    v_mfma_f32_16x16x32_bf16 v[216:219], a[216:219], v[140:143], v[216:219]
    v_cmp_ne_u32 vcc, 0, v18
    s_cbranch_vccnz LB_re7
LB_ok7:
    s_waitcnt vmcnt(7)
    v_mfma_f32_16x16x32_bf16 v[160:163], a[40:43], v[240:243], v[160:163]
    s_add_u32 s24, s5, s23
    buffer_load_dwordx4 v[64:67], v0, s[60:63], s24 offen sc1
    v_xor_b32 v32, v32, v6
    v_xor_b32 v33, v33, v7
    v_mfma_f32_16x16x32_bf16 v[164:167], a[44:47], v[240:243], v[164:167]
    v_or_b32 v18, v32, v33
    v_mfma_f32_16x16x32_bf16 v[168:171], a[48:51], v[240:243], v[168:171]
    v_xor_b32 v34, v34, v8
    v_mfma_f32_16x16x32_bf16 v[172:175], a[52:55], v[240:243], v[172:175]
    v_xor_b32 v35, v35, v9
    v_mfma_f32_16x16x32_bf16 v[176:179], a[56:59], v[240:243], v[176:179]
    v_or3_b32 v18, v18, v34, v35
    s_waitcnt vmcnt(7)
    v_mfma_f32_16x16x32_bf16 v[160:163], a[100:103], v[244:247], v[160:163]
    s_add_u32 s25, s8, s23
    buffer_load_dwordx4 v[68:71], v0, s[60:63], s25 offen sc1
    v_xor_b32 v36, v36, v6
    v_xor_b32 v37, v37, v7
    v_mfma_f32_16x16x32_bf16 v[164:167], a[104:107], v[244:247], v[164:167]
    v_or3_b32 v18, v18, v36, v37
    v_mfma_f32_16x16x32_bf16 v[168:171], a[108:111], v[244:247], v[168:171]
    v_xor_b32 v38, v38, v8
    v_mfma_f32_16x16x32_bf16 v[172:175], a[112:115], v[244:247], v[172:175]
    v_xor_b32 v39, v39, v9
    v_mfma_f32_16x16x32_bf16 v[176:179], a[116:119], v[244:247], v[176:179]
    v_or3_b32 v18, v18, v38, v39
    s_waitcnt vmcnt(7)
    v_mfma_f32_16x16x32_bf16 v[160:163], a[160:163], v[248:251], v[160:163]
    s_add_u32 s24, s11, s23
    buffer_load_dwordx4 v[72:75], v0, s[60:63], s24 offen sc1
    v_xor_b32 v40, v40, v6
    v_xor_b32 v41, v41, v7
    v_mfma_f32_16x16x32_bf16 v[164:167], a[164:167], v[248:251], v[164:167]
    v_or3_b32 v18, v18, v40, v41
    v_mfma_f32_16x16x32_bf16 v[168:171], a[168:171], v[248:251], v[168:171]
    v_xor_b32 v42, v42, v8
    v_mfma_f32_16x16x32_bf16 v[172:175], a[172:175], v[248:251], v[172:175]
    v_xor_b32 v43, v43, v9
    v_mfma_f32_16x16x32_bf16 v[176:179], a[176:179], v[248:251], v[176:179]
    v_or3_b32 v18, v18, v42, v43
    s_waitcnt vmcnt(7)
    v_mfma_f32_16x16x32_bf16 v[160:163], a[220:223], v[252:255], v[160:163]
    s_add_u32 s25, s14, s23
    buffer_load_dwordx4 v[76:79], v0, s[60:63], s25 offen sc1
    v_xor_b32 v44, v44, v6
    v_xor_b32 v45, v45, v7
    v_mfma_f32_16x16x32_bf16 v[164:167], a[224:227], v[252:255], v[164:167]
    v_or3_b32 v18, v18, v44, v45
    v_xor_b32 v46, v46, v8
    v_mfma_f32_16x16x32_bf16 v[168:171], a[228:231], v[252:255], v[168:171]
    v_xor_b32 v47, v47, v9
    v_or3_b32 v18, v18, v46, v47
    v_mfma_f32_16x16x32_bf16 v[172:175], a[232:235], v[252:255], v[172:175]
    v_and_b32 v18, s28, v18
    v_mfma_f32_16x16x32_bf16 v[176:179], a[236:239], v[252:255], v[176:179]
    v_cmp_ne_u32 vcc, 0, v18
    s_cbranch_vccnz LB_re8
LB_ok8:
    s_waitcnt vmcnt(7)
    v_mfma_f32_16x16x32_bf16 v[180:183], a[40:43], v[32:35], v[180:183]
    s_add_u32 s24, s6, s23
    buffer_load_dwordx4 v[80:83], v0, s[60:63], s24 offen sc1
    v_xor_b32 v48, v48, v6
    v_xor_b32 v49, v49, v7
    v_mfma_f32_16x16x32_bf16 v[184:187], a[44:47], v[32:35], v[184:187]
    v_or_b32 v18, v48, v49
    v_mfma_f32_16x16x32_bf16 v[188:191], a[48:51], v[32:35], v[188:191]
    v_xor_b32 v50, v50, v8
    v_mfma_f32_16x16x32_bf16 v[192:195], a[52:55], v[32:35], v[192:195]
    v_xor_b32 v51, v51, v9
    v_mfma_f32_16x16x32_bf16 v[196:199], a[56:59], v[32:35], v[196:199]
    v_or3_b32 v18, v18, v50, v51
    s_waitcnt vmcnt(7)
    v_mfma_f32_16x16x32_bf16 v[180:183], a[100:103], v[36:39], v[180:183]
    s_add_u32 s25, s9, s23
    buffer_load_dwordx4 v[84:87], v0, s[60:63], s25 offen sc1
    v_xor_b32 v52, v52, v6
    v_xor_b32 v53, v53, v7
    v_mfma_f32_16x16x32_bf16 v[184:187], a[104:107], v[36:39], v[184:187]
    v_or3_b32 v18, v18, v52, v53
    ds_write_b128 v148, v[160:163] offset:0
    v_mfma_f32_16x16x32_bf16 v[188:191], a[108:111], v[36:39], v[188:191]
    v_xor_b32 v54, v54, v8
    v_mfma_f32_16x16x32_bf16 v[192:195], a[112:115], v[36:39], v[192:195]
    v_xor_b32 v55, v55, v9
    ds_write_b128 v148, v[164:167] offset:1024
    v_mfma_f32_16x16x32_bf16 v[196:199], a[116:119], v[36:39], v[196:199]
    v_or3_b32 v18, v18, v54, v55
    ds_write_b128 v148, v[168:171] offset:2048
    s_waitcnt vmcnt(7)
    v_mfma_f32_16x16x32_bf16 v[180:183], a[160:163], v[40:43], v[180:183]
    s_add_u32 s24, s12, s23
    buffer_load_dwordx4 v[88:91], v0, s[60:63], s24 offen sc1
    v_xor_b32 v56, v56, v6
    v_xor_b32 v57, v57, v7
    v_mfma_f32_16x16x32_bf16 v[184:187], a[164:167], v[40:43], v[184:187]
    v_or3_b32 v18, v18, v56, v57
    ds_write_b128 v148, v[172:175] offset:3072
    v_mfma_f32_16x16x32_bf16 v[188:191], a[168:171], v[40:43], v[188:191]
    v_xor_b32 v58, v58, v8
    v_mfma_f32_16x16x32_bf16 v[192:195], a[172:175], v[40:43], v[192:195]
    v_xor_b32 v59, v59, v9
    ds_write_b128 v148, v[176:179] offset:4096
    v_mfma_f32_16x16x32_bf16 v[196:199], a[176:179], v[40:43], v[196:199]
    v_or3_b32 v18, v18, v58, v59
    s_waitcnt vmcnt(7)
    v_mfma_f32_16x16x32_bf16 v[180:183], a[220:223], v[44:47], v[180:183]
    s_add_u32 s25, s15, s23
    buffer_load_dwordx4 v[92:95], v0, s[60:63], s25 offen sc1
    v_xor_b32 v60, v60, v6
    v_xor_b32 v61, v61, v7
    v_mfma_f32_16x16x32_bf16 v[184:187], a[224:227], v[44:47], v[184:187]
    v_or3_b32 v18, v18, v60, v61
    v_xor_b32 v62, v62, v8
    v_mfma_f32_16x16x32_bf16 v[188:191], a[228:231], v[44:47], v[188:191]
    v_xor_b32 v63, v63, v9
    v_or3_b32 v18, v18, v62, v63
    v_mfma_f32_16x16x32_bf16 v[192:195], a[232:235], v[44:47], v[192:195]
    v_and_b32 v18, s28, v18
    v_mfma_f32_16x16x32_bf16 v[196:199], a[236:239], v[44:47], v[196:199]
    v_cmp_ne_u32 vcc, 0, v18
    s_cbranch_vccnz LB_re9
LB_ok9:
    s_waitcnt vmcnt(7)
    v_mfma_f32_16x16x32_bf16 v[200:203], a[40:43], v[48:51], v[200:203]
    v_xor_b32 v64, v64, v6
    v_xor_b32 v65, v65, v7
    v_mfma_f32_16x16x32_bf16 v[204:207], a[44:47], v[48:51], v[204:207]
    v_or_b32 v18, v64, v65
    v_mfma_f32_16x16x32_bf16 v[208:211], a[48:51], v[48:51], v[208:211]
    v_xor_b32 v66, v66, v8
    v_mfma_f32_16x16x32_bf16 v[212:215], a[52:55], v[48:51], v[212:215]
    v_xor_b32 v67, v67, v9
    v_mfma_f32_16x16x32_bf16 v[216:219], a[56:59], v[48:51], v[216:219]
    v_or3_b32 v18, v18, v66, v67
    s_waitcnt vmcnt(6)
    v_mfma_f32_16x16x32_bf16 v[200:203], a[100:103], v[52:55], v[200:203]
    v_xor_b32 v68, v68, v6
    v_xor_b32 v69, v69, v7
    v_mfma_f32_16x16x32_bf16 v[204:207], a[104:107], v[52:55], v[204:207]
    v_or3_b32 v18, v18, v68, v69
    ds_write_b128 v148, v[180:183] offset:5120
    v_mfma_f32_16x16x32_bf16 v[208:211], a[108:111], v[52:55], v[208:211]
    v_xor_b32 v70, v70, v8
    v_mfma_f32_16x16x32_bf16 v[212:215], a[112:115], v[52:55], v[212:215]
    v_xor_b32 v71, v71, v9
    ds_write_b128 v148, v[184:187] offset:6144
    v_mfma_f32_16x16x32_bf16 v[216:219], a[116:119], v[52:55], v[216:219]
    v_or3_b32 v18, v18, v70, v71
    ds_write_b128 v148, v[188:191] offset:7168
    s_waitcnt vmcnt(5)
    v_mfma_f32_16x16x32_bf16 v[200:203], a[160:163], v[56:59], v[200:203]
    v_xor_b32 v72, v72, v6
    v_xor_b32 v73, v73, v7
    v_mfma_f32_16x16x32_bf16 v[204:207], a[164:167], v[56:59], v[204:207]
    v_or3_b32 v18, v18, v72, v73
    ds_write_b128 v148, v[192:195] offset:8192
    v_mfma_f32_16x16x32_bf16 v[208:211], a[168:171], v[56:59], v[208:211]
    v_xor_b32 v74, v74, v8
    v_mfma_f32_16x16x32_bf16 v[212:215], a[172:175], v[56:59], v[212:215]
    v_xor_b32 v75, v75, v9
    ds_write_b128 v148, v[196:199] offset:9216
    v_mfma_f32_16x16x32_bf16 v[216:219], a[176:179], v[56:59], v[216:219]
    v_or3_b32 v18, v18, v74, v75
    s_waitcnt vmcnt(4)
    v_mfma_f32_16x16x32_bf16 v[200:203], a[220:223], v[60:63], v[200:203]
    v_xor_b32 v76, v76, v6
    v_xor_b32 v77, v77, v7
    v_mfma_f32_16x16x32_bf16 v[204:207], a[224:227], v[60:63], v[204:207]
    v_or3_b32 v18, v18, v76, v77
    v_xor_b32 v78, v78, v8
    v_mfma_f32_16x16x32_bf16 v[208:211], a[228:231], v[60:63], v[208:211]
    v_xor_b32 v79, v79, v9
    v_or3_b32 v18, v18, v78, v79
    v_mfma_f32_16x16x32_bf16 v[212:215], a[232:235], v[60:63], v[212:215]
    v_and_b32 v18, s28, v18
    v_mfma_f32_16x16x32_bf16 v[216:219], a[236:239], v[60:63], v[216:219]
    v_cmp_ne_u32 vcc, 0, v18
    s_cbranch_vccnz LB_re10
LB_ok10:
    s_waitcnt vmcnt(3)
    v_mfma_f32_16x16x32_bf16 v[220:223], a[20:23], v[64:67], v[220:223]
    v_xor_b32 v80, v80, v6
    v_xor_b32 v81, v81, v7
    v_mfma_f32_16x16x32_bf16 v[224:227], a[24:27], v[64:67], v[224:227]
    v_or_b32 v18, v80, v81
    v_mfma_f32_16x16x32_bf16 v[228:231], a[28:31], v[64:67], v[228:231]
    v_xor_b32 v82, v82, v8
    v_mfma_f32_16x16x32_bf16 v[232:235], a[32:35], v[64:67], v[232:235]
    v_xor_b32 v83, v83, v9
    v_mfma_f32_16x16x32_bf16 v[236:239], a[36:39], v[64:67], v[236:239]
    v_or3_b32 v18, v18, v82, v83
    s_waitcnt vmcnt(2)
    v_mfma_f32_16x16x32_bf16 v[220:223], a[80:83], v[68:71], v[220:223]
    v_xor_b32 v84, v84, v6
    v_xor_b32 v85, v85, v7
    v_mfma_f32_16x16x32_bf16 v[224:227], a[84:87], v[68:71], v[224:227]
    v_or3_b32 v18, v18, v84, v85
    ds_write_b128 v148, v[200:203] offset:10240
    v_mfma_f32_16x16x32_bf16 v[228:231], a[88:91], v[68:71], v[228:231]
    v_xor_b32 v86, v86, v8
    v_mfma_f32_16x16x32_bf16 v[232:235], a[92:95], v[68:71], v[232:235]
    v_xor_b32 v87, v87, v9
    ds_write_b128 v148, v[204:207] offset:11264
    v_mfma_f32_16x16x32_bf16 v[236:239], a[96:99], v[68:71], v[236:239]
    v_or3_b32 v18, v18, v86, v87
    ds_write_b128 v148, v[208:211] offset:12288
    s_waitcnt vmcnt(1)
    v_mfma_f32_16x16x32_bf16 v[220:223], a[140:143], v[72:75], v[220:223]
    v_xor_b32 v88, v88, v6
    v_xor_b32 v89, v89, v7
    v_mfma_f32_16x16x32_bf16 v[224:227], a[144:147], v[72:75], v[224:227]
    v_or3_b32 v18, v18, v88, v89
    ds_write_b128 v148, v[212:215] offset:13312
    v_mfma_f32_16x16x32_bf16 v[228:231], a[148:151], v[72:75], v[228:231]
    v_xor_b32 v90, v90, v8
    v_mfma_f32_16x16x32_bf16 v[232:235], a[152:155], v[72:75], v[232:235]
    v_xor_b32 v91, v91, v9
    ds_write_b128 v148, v[216:219] offset:14336
    v_mfma_f32_16x16x32_bf16 v[236:239], a[156:159], v[72:75], v[236:239]
    v_or3_b32 v18, v18, v90, v91
    s_waitcnt vmcnt(0)
    v_mfma_f32_16x16x32_bf16 v[220:223], a[200:203], v[76:79], v[220:223]
    v_xor_b32 v92, v92, v6
    v_xor_b32 v93, v93, v7
    v_mfma_f32_16x16x32_bf16 v[224:227], a[204:207], v[76:79], v[224:227]
    v_or3_b32 v18, v18, v92, v93
    v_xor_b32 v94, v94, v8
    v_mfma_f32_16x16x32_bf16 v[228:231], a[208:211], v[76:79], v[228:231]
    v_xor_b32 v95, v95, v9
    v_or3_b32 v18, v18, v94, v95
    v_mfma_f32_16x16x32_bf16 v[232:235], a[212:215], v[76:79], v[232:235]
    v_and_b32 v18, s28, v18
    v_mfma_f32_16x16x32_bf16 v[236:239], a[216:219], v[76:79], v[236:239]
    v_cmp_ne_u32 vcc, 0, v18
    s_waitcnt lgkmcnt(0)
    s_barrier
    s_cbranch_vccnz LB_re11
LB_ok11:
    v_mfma_f32_16x16x32_bf16 v[220:223], a[40:43], v[80:83], v[220:223]
    ds_read_b128 v[160:163], v149 offset:0
    v_mfma_f32_16x16x32_bf16 v[224:227], a[44:47], v[80:83], v[224:227]
    ds_read_b128 v[164:167], v150 offset:0
    v_mfma_f32_16x16x32_bf16 v[228:231], a[48:51], v[80:83], v[228:231]
    ds_read_b128 v[168:171], v151 offset:0
    v_mfma_f32_16x16x32_bf16 v[232:235], a[52:55], v[80:83], v[232:235]
    ds_read_b128 v[172:175], v149 offset:1024
    v_mfma_f32_16x16x32_bf16 v[236:239], a[56:59], v[80:83], v[236:239]
    ds_read_b128 v[176:179], v150 offset:1024
    v_mfma_f32_16x16x32_bf16 v[220:223], a[100:103], v[84:87], v[220:223]
    ds_read_b128 v[180:183], v151 offset:1024
    v_mfma_f32_16x16x32_bf16 v[224:227], a[104:107], v[84:87], v[224:227]
    ds_read_b128 v[184:187], v149 offset:2048
    v_mfma_f32_16x16x32_bf16 v[228:231], a[108:111], v[84:87], v[228:231]
    ds_read_b128 v[188:191], v150 offset:2048
    v_mfma_f32_16x16x32_bf16 v[232:235], a[112:115], v[84:87], v[232:235]
    ds_read_b128 v[192:195], v151 offset:2048
    v_mfma_f32_16x16x32_bf16 v[236:239], a[116:119], v[84:87], v[236:239]
    ds_read_b128 v[196:199], v149 offset:3072
    v_mfma_f32_16x16x32_bf16 v[220:223], a[160:163], v[88:91], v[220:223]
    ds_read_b128 v[200:203], v150 offset:3072
    v_mfma_f32_16x16x32_bf16 v[224:227], a[164:167], v[88:91], v[224:227]
    ds_read_b128 v[204:207], v151 offset:3072
    v_mfma_f32_16x16x32_bf16 v[228:231], a[168:171], v[88:91], v[228:231]
    ds_read_b128 v[208:211], v149 offset:4096
    v_mfma_f32_16x16x32_bf16 v[232:235], a[172:175], v[88:91], v[232:235]
    ds_read_b128 v[212:215], v150 offset:4096
    v_mfma_f32_16x16x32_bf16 v[236:239], a[176:179], v[88:91], v[236:239]
    ds_read_b128 v[216:219], v151 offset:4096
    v_mfma_f32_16x16x32_bf16 v[220:223], a[220:223], v[92:95], v[220:223]
    v_mfma_f32_16x16x32_bf16 v[224:227], a[224:227], v[92:95], v[224:227]
    v_mfma_f32_16x16x32_bf16 v[228:231], a[228:231], v[92:95], v[228:231]
    v_mfma_f32_16x16x32_bf16 v[232:235], a[232:235], v[92:95], v[232:235]
    v_mfma_f32_16x16x32_bf16 v[236:239], a[236:239], v[92:95], v[236:239]
    s_waitcnt lgkmcnt(12)
    v_pk_add_f32 v[160:161], v[160:161], v[164:165]
    v_pk_add_f32 v[162:163], v[162:163], v[166:167]
    v_pk_add_f32 v[160:161], v[160:161], v[168:169]
    v_pk_add_f32 v[162:163], v[162:163], v[170:171]
    s_waitcnt lgkmcnt(9)
    v_pk_add_f32 v[172:173], v[172:173], v[176:177]
    v_pk_add_f32 v[174:175], v[174:175], v[178:179]
    v_pk_add_f32 v[172:173], v[172:173], v[180:181]
    v_pk_add_f32 v[174:175], v[174:175], v[182:183]
    s_waitcnt lgkmcnt(6)
    v_pk_add_f32 v[184:185], v[184:185], v[188:189]
    v_pk_add_f32 v[186:187], v[186:187], v[190:191]
    v_pk_add_f32 v[184:185], v[184:185], v[192:193]
    v_pk_add_f32 v[186:187], v[186:187], v[194:195]
    s_waitcnt lgkmcnt(3)
    v_pk_add_f32 v[196:197], v[196:197], v[200:201]
    v_pk_add_f32 v[198:199], v[198:199], v[202:203]
    v_pk_add_f32 v[196:197], v[196:197], v[204:205]
    v_pk_add_f32 v[198:199], v[198:199], v[206:207]
    s_waitcnt lgkmcnt(0)
    v_pk_add_f32 v[208:209], v[208:209], v[212:213]
    v_pk_add_f32 v[210:211], v[210:211], v[214:215]
    v_pk_add_f32 v[208:209], v[208:209], v[216:217]
    v_pk_add_f32 v[210:211], v[210:211], v[218:219]
    v_pk_add_f32 v[220:221], v[220:221], v[160:161]
    v_pk_add_f32 v[222:223], v[222:223], v[162:163]
    v_cvt_pk_bf16_f32 v32, v220, v221
    v_cvt_pk_bf16_f32 v33, v222, v223
    v_pk_add_f32 v[224:225], v[224:225], v[172:173]
    v_pk_add_f32 v[226:227], v[226:227], v[174:175]
    v_cvt_pk_bf16_f32 v34, v224, v225
    v_cvt_pk_bf16_f32 v35, v226, v227
    s_nop 0
    v_permlane16_swap_b32 v32, v34
    v_permlane16_swap_b32 v33, v35
    global_store_dwordx4 v154, v[32:35], s[42:43] offset:0
    v_pk_add_f32 v[228:229], v[228:229], v[184:185]
    v_pk_add_f32 v[230:231], v[230:231], v[186:187]
    v_cvt_pk_bf16_f32 v36, v228, v229
    v_cvt_pk_bf16_f32 v37, v230, v231
    v_pk_add_f32 v[232:233], v[232:233], v[196:197]
    v_pk_add_f32 v[234:235], v[234:235], v[198:199]
    v_cvt_pk_bf16_f32 v38, v232, v233
    v_cvt_pk_bf16_f32 v39, v234, v235
    s_nop 0
    v_permlane16_swap_b32 v36, v38
    v_permlane16_swap_b32 v37, v39
    global_store_dwordx4 v154, v[36:39], s[42:43] offset:64
    v_pk_add_f32 v[236:237], v[236:237], v[208:209]
    v_pk_add_f32 v[238:239], v[238:239], v[210:211]
    v_cvt_pk_bf16_f32 v40, v236, v237
    v_cvt_pk_bf16_f32 v41, v238, v239
    global_store_dwordx2 v153, v[40:41], s[42:43] offset:128
LB_exit:
    s_endpgm
LB_re0:
    s_mov_b32 s81, 0x40000
LB_rl0:
    s_add_u32 s24, s4, s20
    buffer_load_dwordx4 v[32:35], v0, s[60:63], s24 offen sc1
    s_add_u32 s25, s7, s20
    buffer_load_dwordx4 v[36:39], v0, s[60:63], s25 offen sc1
    s_add_u32 s24, s10, s20
    buffer_load_dwordx4 v[40:43], v0, s[60:63], s24 offen sc1
    s_add_u32 s25, s13, s20
    buffer_load_dwordx4 v[44:47], v0, s[60:63], s25 offen sc1
    s_waitcnt vmcnt(0)
    v_xor_b32 v32, v32, v6
    v_xor_b32 v33, v33, v7
    v_or_b32 v18, v32, v33
    v_xor_b32 v34, v34, v8
    v_xor_b32 v35, v35, v9
    v_or3_b32 v18, v18, v34, v35
    v_xor_b32 v36, v36, v6
    v_xor_b32 v37, v37, v7
    v_or3_b32 v18, v18, v36, v37
    v_xor_b32 v38, v38, v8
    v_xor_b32 v39, v39, v9
    v_or3_b32 v18, v18, v38, v39
    v_xor_b32 v40, v40, v6
    v_xor_b32 v41, v41, v7
    v_or3_b32 v18, v18, v40, v41
    v_xor_b32 v42, v42, v8
    v_xor_b32 v43, v43, v9
    v_or3_b32 v18, v18, v42, v43
    v_xor_b32 v44, v44, v6
    v_xor_b32 v45, v45, v7
    v_or3_b32 v18, v18, v44, v45
    v_xor_b32 v46, v46, v8
    v_xor_b32 v47, v47, v9
    v_or3_b32 v18, v18, v46, v47
    v_and_b32 v18, s28, v18
    v_cmp_ne_u32 vcc, 0, v18
    s_cbranch_vccz LB_ok0
    s_sub_u32 s81, s81, 1
    s_cmp_lg_u32 s81, 0
    s_cbranch_scc1 LB_rl0
    s_branch LB_ok0
LB_re1:
    s_mov_b32 s81, 0x40000
LB_rl1:
    s_add_u32 s24, s4, s21
    buffer_load_dwordx4 v[48:51], v0, s[60:63], s24 offen sc1
    s_add_u32 s25, s7, s21
    buffer_load_dwordx4 v[52:55], v0, s[60:63], s25 offen sc1
    s_add_u32 s24, s10, s21
    buffer_load_dwordx4 v[56:59], v0, s[60:63], s24 offen sc1
    s_add_u32 s25, s13, s21
    buffer_load_dwordx4 v[60:63], v0, s[60:63], s25 offen sc1
    s_waitcnt vmcnt(0)
    v_xor_b32 v48, v48, v6
    v_xor_b32 v49, v49, v7
    v_or_b32 v18, v48, v49
    v_xor_b32 v50, v50, v8
    v_xor_b32 v51, v51, v9
    v_or3_b32 v18, v18, v50, v51
    v_xor_b32 v52, v52, v6
    v_xor_b32 v53, v53, v7
    v_or3_b32 v18, v18, v52, v53
    v_xor_b32 v54, v54, v8
    v_xor_b32 v55, v55, v9
    v_or3_b32 v18, v18, v54, v55
    v_xor_b32 v56, v56, v6
    v_xor_b32 v57, v57, v7
    v_or3_b32 v18, v18, v56, v57
    v_xor_b32 v58, v58, v8
    v_xor_b32 v59, v59, v9
    v_or3_b32 v18, v18, v58, v59
    v_xor_b32 v60, v60, v6
    v_xor_b32 v61, v61, v7
    v_or3_b32 v18, v18, v60, v61
    v_xor_b32 v62, v62, v8
    v_xor_b32 v63, v63, v9
    v_or3_b32 v18, v18, v62, v63
    v_and_b32 v18, s28, v18
    v_cmp_ne_u32 vcc, 0, v18
    s_cbranch_vccz LB_ok1
    s_sub_u32 s81, s81, 1
    s_cmp_lg_u32 s81, 0
    s_cbranch_scc1 LB_rl1
    s_branch LB_ok1
LB_re2:
    s_mov_b32 s81, 0x40000
LB_rl2:
    s_add_u32 s24, s4, s22
    buffer_load_dwordx4 v[64:67], v0, s[60:63], s24 offen sc1
    s_add_u32 s25, s7, s22
    buffer_load_dwordx4 v[68:71], v0, s[60:63], s25 offen sc1
    s_add_u32 s24, s10, s22
    buffer_load_dwordx4 v[72:75], v0, s[60:63], s24 offen sc1
    s_add_u32 s25, s13, s22
    buffer_load_dwordx4 v[76:79], v0, s[60:63], s25 offen sc1
    s_waitcnt vmcnt(0)
    v_xor_b32 v64, v64, v6
    v_xor_b32 v65, v65, v7
    v_or_b32 v18, v64, v65
    v_xor_b32 v66, v66, v8
    v_xor_b32 v67, v67, v9
    v_or3_b32 v18, v18, v66, v67
    v_xor_b32 v68, v68, v6
    v_xor_b32 v69, v69, v7
    v_or3_b32 v18, v18, v68, v69
    v_xor_b32 v70, v70, v8
    v_xor_b32 v71, v71, v9
    v_or3_b32 v18, v18, v70, v71
    v_xor_b32 v72, v72, v6
    v_xor_b32 v73, v73, v7
    v_or3_b32 v18, v18, v72, v73
    v_xor_b32 v74, v74, v8
    v_xor_b32 v75, v75, v9
    v_or3_b32 v18, v18, v74, v75
    v_xor_b32 v76, v76, v6
    v_xor_b32 v77, v77, v7
    v_or3_b32 v18, v18, v76, v77
    v_xor_b32 v78, v78, v8
    v_xor_b32 v79, v79, v9
    v_or3_b32 v18, v18, v78, v79
    v_and_b32 v18, s28, v18
    v_cmp_ne_u32 vcc, 0, v18
    s_cbranch_vccz LB_ok2
    s_sub_u32 s81, s81, 1
    s_cmp_lg_u32 s81, 0
    s_cbranch_scc1 LB_rl2
    s_branch LB_ok2
LB_re3:
    s_mov_b32 s81, 0x40000
LB_rl3:
    s_add_u32 s24, s4, s23
    buffer_load_dwordx4 v[80:83], v0, s[60:63], s24 offen sc1
    s_add_u32 s25, s7, s23
    buffer_load_dwordx4 v[84:87], v0, s[60:63], s25 offen sc1
    s_add_u32 s24, s10, s23
    buffer_load_dwordx4 v[88:91], v0, s[60:63], s24 offen sc1
    s_add_u32 s25, s13, s23
    buffer_load_dwordx4 v[92:95], v0, s[60:63], s25 offen sc1
    s_waitcnt vmcnt(0)
    v_xor_b32 v80, v80, v6
    v_xor_b32 v81, v81, v7
    v_or_b32 v18, v80, v81
    v_xor_b32 v82, v82, v8
    v_xor_b32 v83, v83, v9
    v_or3_b32 v18, v18, v82, v83
    v_xor_b32 v84, v84, v6
    v_xor_b32 v85, v85, v7
    v_or3_b32 v18, v18, v84, v85
    v_xor_b32 v86, v86, v8
    v_xor_b32 v87, v87, v9
    v_or3_b32 v18, v18, v86, v87
    v_xor_b32 v88, v88, v6
    v_xor_b32 v89, v89, v7
    v_or3_b32 v18, v18, v88, v89
    v_xor_b32 v90, v90, v8
    v_xor_b32 v91, v91, v9
    v_or3_b32 v18, v18, v90, v91
    v_xor_b32 v92, v92, v6
    v_xor_b32 v93, v93, v7
    v_or3_b32 v18, v18, v92, v93
    v_xor_b32 v94, v94, v8
    v_xor_b32 v95, v95, v9
    v_or3_b32 v18, v18, v94, v95
    v_and_b32 v18, s28, v18
    v_cmp_ne_u32 vcc, 0, v18
    s_cbranch_vccz LB_ok3
    s_sub_u32 s81, s81, 1
    s_cmp_lg_u32 s81, 0
    s_cbranch_scc1 LB_rl3
    s_branch LB_ok3
LB_re4:
    s_mov_b32 s81, 0x40000
LB_rl4:
    s_add_u32 s24, s5, s20
    buffer_load_dwordx4 v[96:99], v0, s[60:63], s24 offen sc1
    s_add_u32 s25, s8, s20
    buffer_load_dwordx4 v[100:103], v0, s[60:63], s25 offen sc1
    s_add_u32 s24, s11, s20
    buffer_load_dwordx4 v[104:107], v0, s[60:63], s24 offen sc1
    s_add_u32 s25, s14, s20
    buffer_load_dwordx4 v[108:111], v0, s[60:63], s25 offen sc1
    s_waitcnt vmcnt(0)
    v_xor_b32 v96, v96, v6
    v_xor_b32 v97, v97, v7
    v_or_b32 v18, v96, v97
    v_xor_b32 v98, v98, v8
    v_xor_b32 v99, v99, v9
    v_or3_b32 v18, v18, v98, v99
    v_xor_b32 v100, v100, v6
    v_xor_b32 v101, v101, v7
    v_or3_b32 v18, v18, v100, v101
    v_xor_b32 v102, v102, v8
    v_xor_b32 v103, v103, v9
    v_or3_b32 v18, v18, v102, v103
    v_xor_b32 v104, v104, v6
    v_xor_b32 v105, v105, v7
    v_or3_b32 v18, v18, v104, v105
    v_xor_b32 v106, v106, v8
    v_xor_b32 v107, v107, v9
    v_or3_b32 v18, v18, v106, v107
    v_xor_b32 v108, v108, v6
    v_xor_b32 v109, v109, v7
    v_or3_b32 v18, v18, v108, v109
    v_xor_b32 v110, v110, v8
    v_xor_b32 v111, v111, v9
    v_or3_b32 v18, v18, v110, v111
    v_and_b32 v18, s28, v18
    v_cmp_ne_u32 vcc, 0, v18
    s_cbranch_vccz LB_ok4
    s_sub_u32 s81, s81, 1
    s_cmp_lg_u32 s81, 0
    s_cbranch_scc1 LB_rl4
    s_branch LB_ok4
LB_re5:
    s_mov_b32 s81, 0x40000
LB_rl5:
    s_add_u32 s24, s5, s21
    buffer_load_dwordx4 v[112:115], v0, s[60:63], s24 offen sc1
    s_add_u32 s25, s8, s21
    buffer_load_dwordx4 v[116:119], v0, s[60:63], s25 offen sc1
    s_add_u32 s24, s11, s21
    buffer_load_dwordx4 v[120:123], v0, s[60:63], s24 offen sc1
    s_add_u32 s25, s14, s21
    buffer_load_dwordx4 v[124:127], v0, s[60:63], s25 offen sc1
    s_waitcnt vmcnt(0)
    v_xor_b32 v112, v112, v6
    v_xor_b32 v113, v113, v7
    v_or_b32 v18, v112, v113
    v_xor_b32 v114, v114, v8
    v_xor_b32 v115, v115, v9
    v_or3_b32 v18, v18, v114, v115
    v_xor_b32 v116, v116, v6
    v_xor_b32 v117, v117, v7
    v_or3_b32 v18, v18, v116, v117
    v_xor_b32 v118, v118, v8
    v_xor_b32 v119, v119, v9
    v_or3_b32 v18, v18, v118, v119
    v_xor_b32 v120, v120, v6
    v_xor_b32 v121, v121, v7
    v_or3_b32 v18, v18, v120, v121
    v_xor_b32 v122, v122, v8
    v_xor_b32 v123, v123, v9
    v_or3_b32 v18, v18, v122, v123
    v_xor_b32 v124, v124, v6
    v_xor_b32 v125, v125, v7
    v_or3_b32 v18, v18, v124, v125
    v_xor_b32 v126, v126, v8
    v_xor_b32 v127, v127, v9
    v_or3_b32 v18, v18, v126, v127
    v_and_b32 v18, s28, v18
    v_cmp_ne_u32 vcc, 0, v18
    s_cbranch_vccz LB_ok5
    s_sub_u32 s81, s81, 1
    s_cmp_lg_u32 s81, 0
    s_cbranch_scc1 LB_rl5
    s_branch LB_ok5
LB_re6:
    s_mov_b32 s81, 0x40000
LB_rl6:
    s_add_u32 s24, s5, s22
    buffer_load_dwordx4 v[128:131], v0, s[60:63], s24 offen sc1
    s_add_u32 s25, s8, s22
    buffer_load_dwordx4 v[132:135], v0, s[60:63], s25 offen sc1
    s_add_u32 s24, s11, s22
    buffer_load_dwordx4 v[136:139], v0, s[60:63], s24 offen sc1
    s_add_u32 s25, s14, s22
    buffer_load_dwordx4 v[140:143], v0, s[60:63], s25 offen sc1
    s_waitcnt vmcnt(0)
    v_xor_b32 v128, v128, v6
    v_xor_b32 v129, v129, v7
    v_or_b32 v18, v128, v129
    v_xor_b32 v130, v130, v8
    v_xor_b32 v131, v131, v9
    v_or3_b32 v18, v18, v130, v131
    v_xor_b32 v132, v132, v6
    v_xor_b32 v133, v133, v7
    v_or3_b32 v18, v18, v132, v133
    v_xor_b32 v134, v134, v8
    v_xor_b32 v135, v135, v9
    v_or3_b32 v18, v18, v134, v135
    v_xor_b32 v136, v136, v6
    v_xor_b32 v137, v137, v7
    v_or3_b32 v18, v18, v136, v137
    v_xor_b32 v138, v138, v8
    v_xor_b32 v139, v139, v9
    v_or3_b32 v18, v18, v138, v139
    v_xor_b32 v140, v140, v6
    v_xor_b32 v141, v141, v7
    v_or3_b32 v18, v18, v140, v141
    v_xor_b32 v142, v142, v8
    v_xor_b32 v143, v143, v9
    v_or3_b32 v18, v18, v142, v143
    v_and_b32 v18, s28, v18
    v_cmp_ne_u32 vcc, 0, v18
    s_cbranch_vccz LB_ok6
    s_sub_u32 s81, s81, 1
    s_cmp_lg_u32 s81, 0
    s_cbranch_scc1 LB_rl6
    s_branch LB_ok6
LB_re7:
    s_mov_b32 s81, 0x40000
LB_rl7:
    s_add_u32 s24, s6, s20
    buffer_load_dwordx4 v[240:243], v0, s[60:63], s24 offen sc1
    s_add_u32 s25, s9, s20
    buffer_load_dwordx4 v[244:247], v0, s[60:63], s25 offen sc1
    s_add_u32 s24, s12, s20
    buffer_load_dwordx4 v[248:251], v0, s[60:63], s24 offen sc1
    s_add_u32 s25, s15, s20
    buffer_load_dwordx4 v[252:255], v0, s[60:63], s25 offen sc1
    s_waitcnt vmcnt(0)
    v_xor_b32 v240, v240, v6
    v_xor_b32 v241, v241, v7
    v_or_b32 v18, v240, v241
    v_xor_b32 v242, v242, v8
    v_xor_b32 v243, v243, v9
    v_or3_b32 v18, v18, v242, v243
    v_xor_b32 v244, v244, v6
    v_xor_b32 v245, v245, v7
    v_or3_b32 v18, v18, v244, v245
    v_xor_b32 v246, v246, v8
    v_xor_b32 v247, v247, v9
    v_or3_b32 v18, v18, v246, v247
    v_xor_b32 v248, v248, v6
    v_xor_b32 v249, v249, v7
    v_or3_b32 v18, v18, v248, v249
    v_xor_b32 v250, v250, v8
    v_xor_b32 v251, v251, v9
    v_or3_b32 v18, v18, v250, v251
    v_xor_b32 v252, v252, v6
    v_xor_b32 v253, v253, v7
    v_or3_b32 v18, v18, v252, v253
    v_xor_b32 v254, v254, v8
    v_xor_b32 v255, v255, v9
    v_or3_b32 v18, v18, v254, v255
    v_and_b32 v18, s28, v18
    v_cmp_ne_u32 vcc, 0, v18
    s_cbranch_vccz LB_ok7
    s_sub_u32 s81, s81, 1
    s_cmp_lg_u32 s81, 0
    s_cbranch_scc1 LB_rl7
    s_branch LB_ok7
LB_re8:
    s_mov_b32 s81, 0x40000
LB_rl8:
    s_add_u32 s24, s6, s21
    buffer_load_dwordx4 v[32:35], v0, s[60:63], s24 offen sc1
    s_add_u32 s25, s9, s21
    buffer_load_dwordx4 v[36:39], v0, s[60:63], s25 offen sc1
    s_add_u32 s24, s12, s21
    buffer_load_dwordx4 v[40:43], v0, s[60:63], s24 offen sc1
    s_add_u32 s25, s15, s21
    buffer_load_dwordx4 v[44:47], v0, s[60:63], s25 offen sc1
    s_waitcnt vmcnt(0)
    v_xor_b32 v32, v32, v6
    v_xor_b32 v33, v33, v7
    v_or_b32 v18, v32, v33
    v_xor_b32 v34, v34, v8
    v_xor_b32 v35, v35, v9
    v_or3_b32 v18, v18, v34, v35
    v_xor_b32 v36, v36, v6
    v_xor_b32 v37, v37, v7
    v_or3_b32 v18, v18, v36, v37
    v_xor_b32 v38, v38, v8
    v_xor_b32 v39, v39, v9
    v_or3_b32 v18, v18, v38, v39
    v_xor_b32 v40, v40, v6
    v_xor_b32 v41, v41, v7
    v_or3_b32 v18, v18, v40, v41
    v_xor_b32 v42, v42, v8
    v_xor_b32 v43, v43, v9
    v_or3_b32 v18, v18, v42, v43
    v_xor_b32 v44, v44, v6
    v_xor_b32 v45, v45, v7
    v_or3_b32 v18, v18, v44, v45
    v_xor_b32 v46, v46, v8
    v_xor_b32 v47, v47, v9
    v_or3_b32 v18, v18, v46, v47
    v_and_b32 v18, s28, v18
    v_cmp_ne_u32 vcc, 0, v18
    s_cbranch_vccz LB_ok8
    s_sub_u32 s81, s81, 1
    s_cmp_lg_u32 s81, 0
    s_cbranch_scc1 LB_rl8
    s_branch LB_ok8
LB_re9:
    s_mov_b32 s81, 0x40000
LB_rl9:
    s_add_u32 s24, s6, s22
    buffer_load_dwordx4 v[48:51], v0, s[60:63], s24 offen sc1
    s_add_u32 s25, s9, s22
    buffer_load_dwordx4 v[52:55], v0, s[60:63], s25 offen sc1
    s_add_u32 s24, s12, s22
    buffer_load_dwordx4 v[56:59], v0, s[60:63], s24 offen sc1
    s_add_u32 s25, s15, s22
    buffer_load_dwordx4 v[60:63], v0, s[60:63], s25 offen sc1
    s_waitcnt vmcnt(0)
    v_xor_b32 v48, v48, v6
    v_xor_b32 v49, v49, v7
    v_or_b32 v18, v48, v49
    v_xor_b32 v50, v50, v8
    v_xor_b32 v51, v51, v9
    v_or3_b32 v18, v18, v50, v51
    v_xor_b32 v52, v52, v6
    v_xor_b32 v53, v53, v7
    v_or3_b32 v18, v18, v52, v53
    v_xor_b32 v54, v54, v8
    v_xor_b32 v55, v55, v9
    v_or3_b32 v18, v18, v54, v55
    v_xor_b32 v56, v56, v6
    v_xor_b32 v57, v57, v7
    v_or3_b32 v18, v18, v56, v57
    v_xor_b32 v58, v58, v8
    v_xor_b32 v59, v59, v9
    v_or3_b32 v18, v18, v58, v59
    v_xor_b32 v60, v60, v6
    v_xor_b32 v61, v61, v7
    v_or3_b32 v18, v18, v60, v61
    v_xor_b32 v62, v62, v8
    v_xor_b32 v63, v63, v9
    v_or3_b32 v18, v18, v62, v63
    v_and_b32 v18, s28, v18
    v_cmp_ne_u32 vcc, 0, v18
    s_cbranch_vccz LB_ok9
    s_sub_u32 s81, s81, 1
    s_cmp_lg_u32 s81, 0
    s_cbranch_scc1 LB_rl9
    s_branch LB_ok9
LB_re10:
    s_mov_b32 s81, 0x40000
LB_rl10:
    s_add_u32 s24, s5, s23
    buffer_load_dwordx4 v[64:67], v0, s[60:63], s24 offen sc1
    s_add_u32 s25, s8, s23
    buffer_load_dwordx4 v[68:71], v0, s[60:63], s25 offen sc1
    s_add_u32 s24, s11, s23
    buffer_load_dwordx4 v[72:75], v0, s[60:63], s24 offen sc1
    s_add_u32 s25, s14, s23
    buffer_load_dwordx4 v[76:79], v0, s[60:63], s25 offen sc1
    s_waitcnt vmcnt(0)
    v_xor_b32 v64, v64, v6
    v_xor_b32 v65, v65, v7
    v_or_b32 v18, v64, v65
    v_xor_b32 v66, v66, v8
    v_xor_b32 v67, v67, v9
    v_or3_b32 v18, v18, v66, v67
    v_xor_b32 v68, v68, v6
    v_xor_b32 v69, v69, v7
    v_or3_b32 v18, v18, v68, v69
    v_xor_b32 v70, v70, v8
    v_xor_b32 v71, v71, v9
    v_or3_b32 v18, v18, v70, v71
    v_xor_b32 v72, v72, v6
    v_xor_b32 v73, v73, v7
    v_or3_b32 v18, v18, v72, v73
    v_xor_b32 v74, v74, v8
    v_xor_b32 v75, v75, v9
    v_or3_b32 v18, v18, v74, v75
    v_xor_b32 v76, v76, v6
    v_xor_b32 v77, v77, v7
    v_or3_b32 v18, v18, v76, v77
    v_xor_b32 v78, v78, v8
    v_xor_b32 v79, v79, v9
    v_or3_b32 v18, v18, v78, v79
    v_and_b32 v18, s28, v18
    v_cmp_ne_u32 vcc, 0, v18
    s_cbranch_vccz LB_ok10
    s_sub_u32 s81, s81, 1
    s_cmp_lg_u32 s81, 0
    s_cbranch_scc1 LB_rl10
    s_branch LB_ok10
LB_re11:
    s_mov_b32 s81, 0x40000
LB_rl11:
    s_add_u32 s24, s6, s23
    buffer_load_dwordx4 v[80:83], v0, s[60:63], s24 offen sc1
    s_add_u32 s25, s9, s23
    buffer_load_dwordx4 v[84:87], v0, s[60:63], s25 offen sc1
    s_add_u32 s24, s12, s23
    buffer_load_dwordx4 v[88:91], v0, s[60:63], s24 offen sc1
    s_add_u32 s25, s15, s23
    buffer_load_dwordx4 v[92:95], v0, s[60:63], s25 offen sc1
    s_waitcnt vmcnt(0)
    v_xor_b32 v80, v80, v6
    v_xor_b32 v81, v81, v7
    v_or_b32 v18, v80, v81
    v_xor_b32 v82, v82, v8
    v_xor_b32 v83, v83, v9
    v_or3_b32 v18, v18, v82, v83
    v_xor_b32 v84, v84, v6
    v_xor_b32 v85, v85, v7
    v_or3_b32 v18, v18, v84, v85
    v_xor_b32 v86, v86, v8
    v_xor_b32 v87, v87, v9
    v_or3_b32 v18, v18, v86, v87
    v_xor_b32 v88, v88, v6
    v_xor_b32 v89, v89, v7
    v_or3_b32 v18, v18, v88, v89
    v_xor_b32 v90, v90, v8
    v_xor_b32 v91, v91, v9
    v_or3_b32 v18, v18, v90, v91
    v_xor_b32 v92, v92, v6
    v_xor_b32 v93, v93, v7
    v_or3_b32 v18, v18, v92, v93
    v_xor_b32 v94, v94, v8
    v_xor_b32 v95, v95, v9
    v_or3_b32 v18, v18, v94, v95
    v_and_b32 v18, s28, v18
    v_cmp_ne_u32 vcc, 0, v18
    s_cbranch_vccz LB_ok11
    s_sub_u32 s81, s81, 1
    s_cmp_lg_u32 s81, 0
    s_cbranch_scc1 LB_rl11
    s_branch LB_ok11
LB_restat:
    s_mov_b32 s81, 0x40000
    s_waitcnt lgkmcnt(0)
LB_rsl:
    global_load_dwordx2 v[180:181], v15, s[46:47] offset:0 sc1
    global_load_dwordx2 v[182:183], v15, s[46:47] offset:1024 sc1
    global_load_dwordx2 v[184:185], v15, s[46:47] offset:2048 sc1
    global_load_dwordx2 v[186:187], v15, s[46:47] offset:3072 sc1
    global_load_dwordx2 v[188:189], v24, s[46:47] offset:0 sc1
    global_load_dwordx2 v[190:191], v15, s[46:47] offset:256 sc1
    global_load_dwordx2 v[192:193], v15, s[46:47] offset:1280 sc1
    global_load_dwordx2 v[194:195], v15, s[46:47] offset:2304 sc1
    global_load_dwordx2 v[196:197], v15, s[46:47] offset:3328 sc1
    global_load_dwordx2 v[198:199], v24, s[46:47] offset:256 sc1
    s_waitcnt vmcnt(0)
    v_max3_u32 v28, v180, v181, v182
    v_max3_u32 v28, v28, v183, v184
    v_max3_u32 v28, v28, v185, v186
    v_max3_u32 v28, v28, v187, v188
    v_max3_u32 v28, v28, v189, v190
    v_max3_u32 v28, v28, v191, v192
    v_max3_u32 v28, v28, v193, v194
    v_max3_u32 v28, v28, v195, v196
    v_max3_u32 v28, v28, v197, v198
    v_max_u32 v28, v28, v199
    v_add_f32 v180, v180, v182
    v_add_f32 v184, v184, v186
    v_add_f32 v180, v180, v188
    v_add_f32 v180, v180, v184
    v_mov_b32 v182, v180
    v_add_f32 v181, v181, v183
    v_add_f32 v185, v185, v187
    v_add_f32 v181, v181, v189
    v_add_f32 v181, v181, v185
    v_mov_b32 v183, v181
    v_add_f32 v190, v190, v192
    v_add_f32 v194, v194, v196
    v_add_f32 v190, v190, v198
    v_add_f32 v190, v190, v194
    v_mov_b32 v192, v190
    v_add_f32 v191, v191, v193
    v_add_f32 v195, v195, v197
    v_add_f32 v191, v191, v199
    v_add_f32 v191, v191, v195
    v_mov_b32 v193, v191
    v_permlane32_swap_b32 v180, v182
    v_permlane32_swap_b32 v181, v183
    v_permlane32_swap_b32 v190, v192
    v_permlane32_swap_b32 v191, v193
    v_add_f32 v180, v180, v182
    v_add_f32 v181, v181, v183
    v_mul_f32 v180, 0xbacccccd, v180
    v_mul_f32 v181, 0x3acccccd, v181
    v_fma_f32 v181, -v180, v180, v181
    v_max_f32 v181, 0, v181
    v_cvt_pk_bf16_f32 v181, v180, v181
    v_lshlrev_b32 v232, 16, v181
    v_and_b32 v181, s77, v181
    v_add_f32 v181, 0x3727c5ac, v181
    v_cvt_pk_bf16_f32 v181, v181, v181
    v_and_b32 v181, s77, v181
    v_sqrt_f32 v181, v181
    v_mov_b32 v234, v232
    v_cvt_pk_bf16_f32 v181, v181, v181
    v_and_b32 v181, s77, v181
    v_rcp_f32 v233, v181
    v_mul_f32 v240, v181, v181
    v_mul_f32 v240, 0x3f7f4f87, v240
    v_mul_f32 v233, 0xbfb8aa3b, v233
    v_mov_b32 v241, v240
    v_mov_b32 v235, v233
    v_add_f32 v190, v190, v192
    v_add_f32 v191, v191, v193
    v_mul_f32 v190, 0xbacccccd, v190
    v_mul_f32 v191, 0x3acccccd, v191
    v_fma_f32 v191, -v190, v190, v191
    v_max_f32 v191, 0, v191
    v_cvt_pk_bf16_f32 v191, v190, v191
    v_lshlrev_b32 v236, 16, v191
    v_and_b32 v191, s77, v191
    v_add_f32 v191, 0x3727c5ac, v191
    v_cvt_pk_bf16_f32 v191, v191, v191
    v_and_b32 v191, s77, v191
    v_sqrt_f32 v191, v191
    v_mov_b32 v238, v236
    v_cvt_pk_bf16_f32 v191, v191, v191
    v_and_b32 v191, s77, v191
    v_rcp_f32 v237, v191
    v_mul_f32 v242, v191, v191
    v_mul_f32 v242, 0x3f7f4f87, v242
    v_mul_f32 v237, 0xbfb8aa3b, v237
    v_mov_b32 v243, v242
    v_mov_b32 v239, v237
    v_permlane16_swap_b32 v232, v234
    v_permlane16_swap_b32 v240, v241
    v_permlane16_swap_b32 v233, v235
    v_permlane16_swap_b32 v236, v238
    v_permlane16_swap_b32 v242, v243
    v_permlane16_swap_b32 v237, v239
    v_cmp_eq_u32 vcc, -1, v28
    s_cbranch_vccz LB_g1
    s_sub_u32 s81, s81, 1
    s_cmp_lg_u32 s81, 0
    s_cbranch_scc1 LB_rsl
    s_branch LB_g1

L_code_end:
    s_endpgm
.section .rodata,"a"
.p2align 6
.amdhsa_kernel kA_kernel
  .amdhsa_next_free_vgpr 168
  .amdhsa_next_free_sgpr 102
  .amdhsa_accum_offset 168
  .amdhsa_group_segment_fixed_size 0
  .amdhsa_kernarg_size 128
  .amdhsa_user_sgpr_count 2
  .amdhsa_user_sgpr_kernarg_segment_ptr 1
  .amdhsa_system_sgpr_workgroup_id_x 1
.end_amdhsa_kernel

.section .rodata,"a"
.p2align 6
.amdhsa_kernel kB_kernel
  .amdhsa_next_free_vgpr 512
  .amdhsa_next_free_sgpr 102
  .amdhsa_accum_offset 256
  .amdhsa_group_segment_fixed_size 0
  .amdhsa_kernarg_size 128
  .amdhsa_user_sgpr_count 2
  .amdhsa_user_sgpr_kernarg_segment_ptr 1
  .amdhsa_system_sgpr_workgroup_id_x 1
.end_amdhsa_kernel
```
